```python
import torch

def _softmax(x, axis=-1):
    return torch.softmax(x, dim=axis)
def _gelu(x):
    return torch.nn.functional.gelu(x, approximate="tanh")
def _silu(x):
    return torch.nn.functional.silu(x)
def _sigmoid(x):
    return torch.sigmoid(x)
def _layernorm(x, axis=-1, eps=1e-5):
    m = x.mean(dim=axis, keepdim=True)
    v = x.var(dim=axis, keepdim=True, unbiased=False)
    return (x - m) / torch.sqrt(v + eps)
def _scatter_add(tgt, idx, src, axis=0):
    return tgt.clone().index_add_(axis, idx, src)
def _segment_sum(src, seg, n):
    out = torch.zeros((n,) + src.shape[1:], dtype=src.dtype)
    return out.index_add_(0, seg, src)
def _pad(x, pw):
    flat = tuple(v for pair in reversed(pw) for v in pair)
    return torch.nn.functional.pad(x, flat)

kernel_name = 'standalone__gqa_softmax__near_ridge'

def setup_inputs():

    _w = (lambda a: (lambda t: t.to(torch.bfloat16) if t.is_floating_point() else t)(torch.as_tensor(a)))
    B, Hq, Hkv, Sq, Sk, D = 8, 32, 16, 208, 2048, 128
    return {
        "q": _w((lambda *s: torch.randn(*s, dtype=torch.bfloat16) * 0.8)(B, Hq, Sq, D)),
        "k": _w((lambda *s: torch.randn(*s, dtype=torch.bfloat16) * 0.8)(B, Hkv, Sk, D)),
        "v": _w((lambda *s: torch.randn(*s, dtype=torch.bfloat16) * 0.05)(B, Hkv, Sk, D)),
    }

def reference(q, k, v):
    B, Hq, Sq, D = q.shape
    Hkv = k.shape[1]
    rep = Hq // Hkv
    k = (lambda x, n, axis: torch.repeat_interleave(x, n, dim=axis))(k, rep, axis=1)
    v = (lambda x, n, axis: torch.repeat_interleave(x, n, dim=axis))(v, rep, axis=1)
    scale = D ** -0.5
    scores = torch.einsum("bhqd,bhkd->bhqk", q, k) * scale
    p = _softmax(scores, axis=-1)
    return torch.einsum("bhqk,bhkd->bhqd", p, v)
```

```asm
; @launch grid=(256,1,1) block=(256,1,1) lds=163840
.amdgcn_target "amdgcn-amd-amdhsa--gfx950"
.text
.globl standalone__gqa_softmax__near_ridge_kernel
.p2align 8
.type standalone__gqa_softmax__near_ridge_kernel,@function
standalone__gqa_softmax__near_ridge_kernel:
    s_cmp_ge_u32 s2, 256
    s_cbranch_scc1 L_end
    s_load_dwordx8 s[4:11], s[0:1], 0
    s_getpc_b64 s[64:65]
L_pc100:
    s_bfe_u32 s93, s2, 0x30003
    v_lshrrev_b32_e64 v100, 3, v0
    s_mul_i32 s93, s93, ((L_end-L_setup)/1024+1)*4*32
    s_add_u32 s93, s93, L_setup-L_pc100
    s_add_u32 s64, s64, s93
    s_addc_u32 s65, s65, 0
    v_mul_u32_u24 v100, ((L_end-L_setup)/1024+1)*4, v100
    v_add_co_u32 v100, vcc, s64, v100
    v_mov_b32 v101, s65
    s_nop 0
    v_addc_co_u32 v101, vcc, 0, v101, vcc
    global_load_dword a252, v[100:101], off
    v_lshrrev_b32 v213, 6, v0
    v_and_b32 v212, 63, v0
    v_readfirstlane_b32 s36, v213
    s_and_b32 s93, s2, 7
    s_lshr_b32 s94, s2, 4
    s_lshl3_add_u32 s93, s94, s93
    v_bfe_u32 v213, v212, 2, 2
    v_lshlrev_b32_e64 v217, 8, v213
    s_bfe_u32 s94, s2, 0x10003
    s_lshl1_add_u32 s94, s93, s94
    v_lshrrev_b32 v214, 4, v212
    v_lshl_add_u32 v217, v214, 6, v217
    s_mul_i32 s3, s94, 53248
    s_lshl_b32 s93, s93, 19
    s_lshl_b32 s37, s36, 13
    v_and_b32_e64 v215, 3, v212
    v_lshl_add_u32 v217, v215, 4, v217
    v_add_u32 v6, s37, v217
    v_xor_b32 v7, 16, v6
    v_xor_b32 v8, 32, v6
    v_xor_b32 v9, 48, v6
    s_mul_i32 s95, s36, 1040
    v_xor_b32_e64 v92, s95, v217
    s_mov_b32 s90, 524288
    s_mov_b32 s91, 0x00020000
    s_mov_b32 s14, 53248
    s_mov_b32 s15, 0x00020000
    s_mov_b32 s94, 4096
    s_add_u32 m0, s37, 0
    s_waitcnt lgkmcnt(0)
    s_add_u32 s88, s6, s93
    s_addc_u32 s89, s7, 0
    buffer_load_dwordx4 v6, s[88:91], 0 offen nt lds
    buffer_load_dwordx4 v7, s[88:91], 0 offen offset:1024 nt lds
    buffer_load_dwordx4 v8, s[88:91], 0 offen offset:2048 nt lds
    buffer_load_dwordx4 v9, s[88:91], 0 offen offset:3072 nt lds
    s_add_u32 m0, s37, 4096
    s_nop 0
    buffer_load_dwordx4 v6, s[88:91], s94 offen nt lds
    buffer_load_dwordx4 v7, s[88:91], s94 offen offset:1024 nt lds
    buffer_load_dwordx4 v8, s[88:91], s94 offen offset:2048 nt lds
    buffer_load_dwordx4 v9, s[88:91], s94 offen offset:3072 nt lds
    s_add_u32 s12, s4, s3
    s_addc_u32 s13, s5, 0
    s_mov_b32 s95, 49152
    buffer_load_dwordx4 v[12:15], v92, s[12:15], s95 offen nt
    s_mov_b32 s95, 0
    buffer_load_dwordx4 v[16:19], v92, s[12:15], s95 offen nt
    s_mov_b32 s95, 12288
    buffer_load_dwordx4 v[20:23], v92, s[12:15], s95 offen nt
    s_mov_b32 s95, 24576
    buffer_load_dwordx4 v[24:27], v92, s[12:15], s95 offen nt
    s_mov_b32 s95, 36864
    buffer_load_dwordx4 v[28:31], v92, s[12:15], s95 offen nt
    s_mov_b32 s95, 4096
    buffer_load_dwordx4 v[44:47], v92, s[12:15], s95 offen nt
    s_mov_b32 s95, 16384
    buffer_load_dwordx4 v[48:51], v92, s[12:15], s95 offen nt
    s_mov_b32 s95, 28672
    buffer_load_dwordx4 v[52:55], v92, s[12:15], s95 offen nt
    s_mov_b32 s95, 40960
    buffer_load_dwordx4 v[56:59], v92, s[12:15], s95 offen nt
L_setup:
    v_lshlrev_b32_e64 v4, 10, v214
    v_lshl_add_u32 v4, v213, 6, v4
    v_lshl_add_u32 v4, v215, 4, v4
    v_lshlrev_b32_e64 v3, 10, v213
    v_lshl_add_u32 v3, v215, 6, v3
    v_and_b32 v11, 15, v212
    v_lshlrev_b32 v11, 8, v11
    v_lshl_add_u32 v11, v214, 4, v11
    v_bfe_u32 v215, v212, 4, 1
    v_mul_u32_u24 v216, 3, v215
    v_lshrrev_b32 v214, 5, v212
    v_xor_b32 v216, v216, v214
    v_xor_b32 v213, v213, v216
    v_lshl_add_u32 v3, v213, 4, v3
    v_add_u32_e64 v1, s37, v3
    v_xor_b32 v97, 0x2000, v1
    v_lshlrev_b32_e64 v10, 4, v212
    s_add_u32 s101, s37, 32768
    s_add_u32 s38, s37, 65536
    s_add_u32 s39, s37, 98304
    s_mov_b32 s92, 32768
    v_add_u32 v2, s101, v4
    v_xor_b32 v98, 0x2000, v2
    s_add_u32 s24, s8, s93
    s_addc_u32 s25, s9, 0
    s_add_u32 s32, s10, s3
    s_addc_u32 s33, s11, 0
    s_add_u32 s16, s88, 32768
    s_addc_u32 s17, s89, 0
    s_add_u32 s20, s88, 36864
    s_addc_u32 s21, s89, 0
    s_add_u32 s28, s24, 4096
    s_addc_u32 s29, s25, 0
    s_mov_b32 s26, 524288
    s_mov_b32 s27, 0x00020000
    s_mov_b32 s34, 53248
    s_mov_b32 s35, 0x00020000
    s_mov_b32 s18, 491520
    s_mov_b32 s19, 0x00020000
    s_mov_b32 s22, 487424
    s_mov_b32 s23, 0x00020000
    s_mov_b32 s30, 520192
    s_mov_b32 s31, 0x00020000
    s_mov_b32 s63, 0x4e800000
    s_mov_b32 s100, s39
    s_lshl_b32 s96, s36, 11
    s_add_u32 s96, s96, 131072
    s_mov_b32 s98, 0x3e0293ee
    s_mov_b32 s99, 0x3e0293ee
    s_lshl_b32 s94, s36, 10
    s_add_u32 s94, s94, 98304
    v_add_u32 v93, s94, v10
    v_bfe_i32 v213, v212, 1, 1
    v_and_b32 v215, 0x3f803f80, v213
    v_xor_b32 v213, 0x3f803f80, v215
    s_nop 0
    s_nop 0
    s_nop 0
    s_nop 0
    v_accvgpr_write_b32 a240, v213
    v_accvgpr_write_b32 a241, v213
    v_accvgpr_write_b32 a242, v213
    v_accvgpr_write_b32 a243, v213
    v_accvgpr_write_b32 a244, v215
    v_accvgpr_write_b32 a245, v215
    v_accvgpr_write_b32 a246, v215
    v_accvgpr_write_b32 a247, v215
    v_bfe_i32 v213, v212, 0, 1
    v_and_b32 v213, 0xaaaa, v213
    v_xor_b32 v5, 0x4444, v213
    v_mov_b32 v240, 0
    v_mov_b32 v241, 0
    v_mov_b32 v242, 0
    v_mov_b32 v243, 0
    v_mov_b32 v244, 0
    v_mov_b32 v245, 0
    v_mov_b32 v246, 0
    v_mov_b32 v247, 0
    v_mov_b32 v248, 0
    v_mov_b32 v249, 0
    v_mov_b32 v250, 0
    v_mov_b32 v251, 0
    v_mov_b32 v252, 0
    v_mov_b32 v253, 0
    v_mov_b32 v254, 0
    v_mov_b32 v255, 0
    s_and_b32 s94, s36, 1
    s_lshr_b32 s93, s36, 1
    s_lshl1_add_u32 s93, s94, s93
    s_mul_i32 s97, s93, 12288
    s_lshl_b32 s93, s93, 12
    s_add_u32 s93, s93, 98304
    v_add_u32_e64 v94, s93, v3
    v_xor_b32 v95, 0x1000, v94
    v_add_u32 v96, 0x1c000, v3
    s_add_u32 s60, s97, 4096
    s_add_u32 s61, s97, 8192
    s_lshl_b32 s62, s36, 6
    s_add_u32 s62, s62, 49152
    s_waitcnt vmcnt(8)
    ds_read_b128 a[176:179], v1
    ds_read_b128 a[180:183], v1 offset:256
    ds_read_b128 a[184:187], v1 offset:512
    ds_read_b128 a[188:191], v1 offset:768
    ds_read_b128 a[204:207], v1 offset:4864
    ds_read_b128 a[200:203], v1 offset:4608
    ds_read_b128 a[196:199], v1 offset:4352
    ds_read_b128 a[192:195], v1 offset:4096
    s_add_u32 m0, s37, 32768
    s_nop 0
    buffer_load_dwordx4 v6, s[24:27], 0 offen nt lds
    v_lshlrev_b32 v100, 16, v12
    v_and_b32 v101, 0xffff0000, v12
    v_lshlrev_b32_e64 v102, 16, v13
    v_and_b32 v103, 0xffff0000, v13
    v_lshlrev_b32_e64 v104, 16, v14
    v_and_b32 v105, 0xffff0000, v14
    v_lshlrev_b32_e64 v106, 16, v15
    v_and_b32 v107, 0xffff0000, v15
    v_pk_mul_f32 v[100:101], v[100:101], s[98:99]
    buffer_load_dwordx4 v6, s[24:27], 0 offen offset:1024 nt lds
    v_pk_mul_f32 v[102:103], v[102:103], s[98:99]
    v_pk_mul_f32 v[104:105], v[104:105], s[98:99]
    v_pk_mul_f32 v[106:107], v[106:107], s[98:99]
    v_cvt_pk_bf16_f32 v12, v100, v101
    v_cvt_pk_bf16_f32 v13, v102, v103
    v_cvt_pk_bf16_f32 v14, v104, v105
    v_cvt_pk_bf16_f32 v15, v106, v107
    ds_write_b128 v93, v[12:15] offset:16384
    s_waitcnt vmcnt(9)
    buffer_load_dwordx4 v6, s[24:27], 0 offen offset:2048 nt lds
    v_lshlrev_b32 v100, 16, v16
    v_and_b32 v101, 0xffff0000, v16
    v_lshlrev_b32_e64 v102, 16, v17
    v_and_b32 v103, 0xffff0000, v17
    v_lshlrev_b32_e64 v104, 16, v18
    v_and_b32 v105, 0xffff0000, v18
    v_lshlrev_b32_e64 v106, 16, v19
    v_and_b32 v107, 0xffff0000, v19
    v_pk_mul_f32 v[100:101], v[100:101], s[98:99]
    buffer_load_dwordx4 v6, s[24:27], 0 offen offset:3072 nt lds
    s_add_u32 m0, s37, 36864
    v_pk_mul_f32 v[102:103], v[102:103], s[98:99]
    v_pk_mul_f32 v[104:105], v[104:105], s[98:99]
    v_pk_mul_f32 v[106:107], v[106:107], s[98:99]
    v_cvt_pk_bf16_f32 v16, v100, v101
    v_cvt_pk_bf16_f32 v17, v102, v103
    v_cvt_pk_bf16_f32 v18, v104, v105
    v_cvt_pk_bf16_f32 v19, v106, v107
    ds_write_b128 v93, v[16:19]
    s_waitcnt vmcnt(10)
    buffer_load_dwordx4 v6, s[28:31], 0 offen nt lds
    v_lshlrev_b32 v100, 16, v20
    v_and_b32 v101, 0xffff0000, v20
    v_lshlrev_b32_e64 v102, 16, v21
    v_and_b32 v103, 0xffff0000, v21
    v_lshlrev_b32_e64 v104, 16, v22
    v_and_b32 v105, 0xffff0000, v22
    v_lshlrev_b32_e64 v106, 16, v23
    v_and_b32 v107, 0xffff0000, v23
    v_pk_mul_f32 v[100:101], v[100:101], s[98:99]
    buffer_load_dwordx4 v6, s[28:31], 0 offen offset:1024 nt lds
    v_pk_mul_f32 v[102:103], v[102:103], s[98:99]
    v_pk_mul_f32 v[104:105], v[104:105], s[98:99]
    v_pk_mul_f32 v[106:107], v[106:107], s[98:99]
    v_cvt_pk_bf16_f32 v20, v100, v101
    v_cvt_pk_bf16_f32 v21, v102, v103
    v_cvt_pk_bf16_f32 v22, v104, v105
    v_cvt_pk_bf16_f32 v23, v106, v107
    ds_write_b128 v93, v[20:23] offset:4096
    s_waitcnt vmcnt(11)
    buffer_load_dwordx4 v6, s[28:31], 0 offen offset:2048 nt lds
    v_lshlrev_b32 v100, 16, v24
    v_and_b32 v101, 0xffff0000, v24
    v_lshlrev_b32_e64 v102, 16, v25
    v_and_b32 v103, 0xffff0000, v25
    v_lshlrev_b32_e64 v104, 16, v26
    v_and_b32 v105, 0xffff0000, v26
    v_lshlrev_b32_e64 v106, 16, v27
    v_and_b32 v107, 0xffff0000, v27
    v_pk_mul_f32 v[100:101], v[100:101], s[98:99]
    v_pk_mul_f32 v[102:103], v[102:103], s[98:99]
    v_pk_mul_f32 v[104:105], v[104:105], s[98:99]
    v_pk_mul_f32 v[106:107], v[106:107], s[98:99]
    v_cvt_pk_bf16_f32 v24, v100, v101
    v_cvt_pk_bf16_f32 v25, v102, v103
    v_cvt_pk_bf16_f32 v26, v104, v105
    v_cvt_pk_bf16_f32 v27, v106, v107
    ds_write_b128 v93, v[24:27] offset:8192
    s_waitcnt vmcnt(11)
    buffer_load_dwordx4 v6, s[28:31], 0 offen offset:3072 nt lds
    v_lshlrev_b32 v100, 16, v28
    v_and_b32 v101, 0xffff0000, v28
    v_lshlrev_b32_e64 v102, 16, v29
    v_and_b32 v103, 0xffff0000, v29
    v_lshlrev_b32_e64 v104, 16, v30
    v_and_b32 v105, 0xffff0000, v30
    v_lshlrev_b32_e64 v106, 16, v31
    v_and_b32 v107, 0xffff0000, v31
    v_pk_mul_f32 v[100:101], v[100:101], s[98:99]
    v_pk_mul_f32 v[102:103], v[102:103], s[98:99]
    v_pk_mul_f32 v[104:105], v[104:105], s[98:99]
    v_pk_mul_f32 v[106:107], v[106:107], s[98:99]
    v_cvt_pk_bf16_f32 v28, v100, v101
    v_cvt_pk_bf16_f32 v29, v102, v103
    v_cvt_pk_bf16_f32 v30, v104, v105
    v_cvt_pk_bf16_f32 v31, v106, v107
    ds_write_b128 v93, v[28:31] offset:12288
    s_waitcnt lgkmcnt(0)
    s_barrier
    ds_read_b128 a[96:99], v96
    ds_read_b128 a[100:103], v96 offset:256
    ds_read_b128 a[104:107], v96 offset:512
    ds_read_b128 a[108:111], v96 offset:768
    ds_read_b128 a[48:51], v95
    ds_read_b128 a[52:55], v95 offset:256
    ds_read_b128 a[56:59], v95 offset:512
    ds_read_b128 a[60:63], v95 offset:768
    ds_read_b128 v[108:111], v97
    ds_read_b128 v[112:115], v97 offset:256
    ds_read_b128 v[116:119], v97 offset:512
    ds_read_b128 v[120:123], v97 offset:768
    s_waitcnt lgkmcnt(11)
    v_mfma_f32_16x16x32_bf16 v[196:199], a[176:179], a[96:99], 0
    ds_read_b128 v[136:139], v97 offset:4864
    ds_read_b128 v[132:135], v97 offset:4608
    s_waitcnt lgkmcnt(12)
    v_mfma_f32_16x16x32_bf16 v[196:199], a[180:183], a[100:103], v[196:199]
    ds_read_b128 v[128:131], v97 offset:4352
    ds_read_b128 v[124:127], v97 offset:4096
    s_waitcnt lgkmcnt(13)
    v_mfma_f32_16x16x32_bf16 v[196:199], a[184:187], a[104:107], v[196:199]
    ds_read_b128 a[0:3], v94
    ds_read_b128 a[4:7], v94 offset:256
    s_waitcnt lgkmcnt(14)
    v_mfma_f32_16x16x32_bf16 v[196:199], a[188:191], a[108:111], v[196:199]
    ds_read_b128 a[8:11], v94 offset:512
    ds_read_b128 a[12:15], v94 offset:768
    v_mfma_f32_16x16x32_bf16 v[200:203], a[204:207], a[108:111], 0
    s_waitcnt vmcnt(11)
    v_lshlrev_b32 v100, 16, v44
    v_mfma_f32_16x16x32_bf16 v[200:203], a[200:203], a[104:107], v[200:203]
    v_and_b32 v101, 0xffff0000, v44
    v_lshlrev_b32_e64 v102, 16, v45
    v_mfma_f32_16x16x32_bf16 v[200:203], a[196:199], a[100:103], v[200:203]
    v_and_b32 v103, 0xffff0000, v45
    v_lshlrev_b32_e64 v104, 16, v46
    v_and_b32 v105, 0xffff0000, v46
    v_exp_f32_e64 v196, v196
    v_mfma_f32_16x16x32_bf16 v[200:203], a[192:195], a[96:99], v[200:203]
    v_lshlrev_b32_e64 v106, 16, v47
    v_and_b32 v107, 0xffff0000, v47
    v_mul_f32_e64 v100, s98, v100
    v_exp_f32 v197, v197
    s_waitcnt lgkmcnt(12)
    v_mfma_f32_16x16x32_bf16 v[204:207], a[176:179], a[48:51], 0
    v_mul_f32 v101, s98, v101
    v_mul_f32 v102, s98, v102
    v_mul_f32 v103, s98, v103
    v_exp_f32 v198, v198
    v_mfma_f32_16x16x32_bf16 v[204:207], a[180:183], a[52:55], v[204:207]
    v_mul_f32 v104, s98, v104
    v_mul_f32 v105, s98, v105
    v_mul_f32 v106, s98, v106
    v_exp_f32 v199, v199
    v_mfma_f32_16x16x32_bf16 v[204:207], a[184:187], a[56:59], v[204:207]
    v_mul_f32_e64 v107, s98, v107
    v_cvt_pk_bf16_f32 v44, v100, v101
    v_cvt_pk_bf16_f32 v45, v102, v103
    v_exp_f32_e64 v200, v200
    v_mfma_f32_16x16x32_bf16 v[204:207], a[188:191], a[60:63], v[204:207]
    v_cvt_pk_bf16_f32 v46, v104, v105
    v_cvt_pk_bf16_f32 v47, v106, v107
    ds_write_b128 v93, v[44:47] offset:32768
    v_exp_f32_e64 v201, v201
    v_mfma_f32_16x16x32_bf16 v[208:211], a[204:207], a[60:63], 0
    s_waitcnt vmcnt(10)
    v_lshlrev_b32 v100, 16, v48
    v_and_b32 v101, 0xffff0000, v48
    v_lshlrev_b32 v102, 16, v49
    v_exp_f32 v202, v202
    v_mfma_f32_16x16x32_bf16 v[208:211], a[200:203], a[56:59], v[208:211]
    v_and_b32 v103, 0xffff0000, v49
    v_lshlrev_b32_e64 v104, 16, v50
    v_and_b32 v105, 0xffff0000, v50
    v_exp_f32_e64 v203, v203
    v_mfma_f32_16x16x32_bf16 v[208:211], a[196:199], a[52:55], v[208:211]
    v_cvt_pk_bf16_f32 v12, v196, v197
    v_cvt_pk_bf16_f32 v13, v198, v199
    v_cvt_pk_bf16_f32 v14, v200, v201
    v_cvt_pk_bf16_f32 v15, v202, v203
    v_lshlrev_b32_e64 v106, 16, v51
    v_and_b32 v107, 0xffff0000, v51
    v_mul_f32_e64 v100, s98, v100
    v_mul_f32 v101, s98, v101
    v_exp_f32 v204, v204
    v_mfma_f32_16x16x32_bf16 v[208:211], a[192:195], a[48:51], v[208:211]
    v_mul_f32 v102, s98, v102
    v_mul_f32 v103, s98, v103
    v_mul_f32_e64 v104, s98, v104
    v_exp_f32 v205, v205
    s_waitcnt lgkmcnt(9)
    v_mfma_f32_16x16x32_bf16 v[24:27], v[108:111], a[48:51], 0
    v_mul_f32 v105, s98, v105
    v_mul_f32 v106, s98, v106
    v_mul_f32 v107, s98, v107
    v_exp_f32 v206, v206
    v_mfma_f32_16x16x32_bf16 v[24:27], v[112:115], a[52:55], v[24:27]
    v_cvt_pk_bf16_f32 v48, v100, v101
    v_cvt_pk_bf16_f32 v49, v102, v103
    v_cvt_pk_bf16_f32 v50, v104, v105
    v_exp_f32_e64 v207, v207
    v_mfma_f32_16x16x32_bf16 v[24:27], v[116:119], a[56:59], v[24:27]
    v_cvt_pk_bf16_f32 v51, v106, v107
    ds_write_b128 v93, v[48:51] offset:36864
    s_waitcnt vmcnt(9)
    v_lshlrev_b32 v100, 16, v52
    v_exp_f32_e64 v208, v208
    v_mfma_f32_16x16x32_bf16 v[24:27], v[120:123], a[60:63], v[24:27]
    v_and_b32 v101, 0xffff0000, v52
    v_lshlrev_b32_e64 v102, 16, v53
    v_and_b32 v103, 0xffff0000, v53
    v_exp_f32 v209, v209
    s_waitcnt lgkmcnt(6)
    v_mfma_f32_16x16x32_bf16 v[28:31], v[136:139], a[60:63], 0
    v_lshlrev_b32_e64 v104, 16, v54
    v_and_b32 v105, 0xffff0000, v54
    v_lshlrev_b32 v106, 16, v55
    v_exp_f32 v210, v210
    v_mfma_f32_16x16x32_bf16 v[28:31], v[132:135], a[56:59], v[28:31]
    v_and_b32 v107, 0xffff0000, v55
    v_mul_f32_e64 v100, s98, v100
    v_mul_f32 v101, s98, v101
    v_exp_f32 v211, v211
    v_mfma_f32_16x16x32_bf16 v[28:31], v[128:131], a[52:55], v[28:31]
    v_cvt_pk_bf16_f32 v16, v204, v205
    v_cvt_pk_bf16_f32 v17, v206, v207
    v_cvt_pk_bf16_f32 v18, v208, v209
    v_cvt_pk_bf16_f32 v19, v210, v211
    v_mul_f32 v102, s98, v102
    v_mul_f32 v103, s98, v103
    v_mul_f32 v104, s98, v104
    v_exp_f32 v24, v24
    v_mfma_f32_16x16x32_bf16 v[28:31], v[124:127], a[48:51], v[28:31]
    v_mul_f32 v105, s98, v105
    v_mul_f32 v106, s98, v106
    v_mul_f32_e64 v107, s98, v107
    v_cvt_pk_bf16_f32 v52, v100, v101
    v_exp_f32 v25, v25
    s_waitcnt lgkmcnt(2)
    v_mfma_f32_16x16x32_bf16 v[32:35], a[176:179], a[0:3], 0
    v_cvt_pk_bf16_f32 v53, v102, v103
    v_cvt_pk_bf16_f32 v54, v104, v105
    v_cvt_pk_bf16_f32 v55, v106, v107
    v_exp_f32_e64 v26, v26
    v_mfma_f32_16x16x32_bf16 v[32:35], a[180:183], a[4:7], v[32:35]
    ds_write_b128 v93, v[52:55] offset:40960
    s_waitcnt vmcnt(8)
    v_lshlrev_b32 v100, 16, v56
    v_and_b32 v101, 0xffff0000, v56
    v_exp_f32_e64 v27, v27
    v_mfma_f32_16x16x32_bf16 v[32:35], a[184:187], a[8:11], v[32:35]
    v_lshlrev_b32_e64 v102, 16, v57
    v_and_b32 v103, 0xffff0000, v57
    v_lshlrev_b32 v104, 16, v58
    v_exp_f32 v28, v28
    v_mfma_f32_16x16x32_bf16 v[32:35], a[188:191], a[12:15], v[32:35]
    v_and_b32 v105, 0xffff0000, v58
    v_lshlrev_b32_e64 v106, 16, v59
    v_and_b32 v107, 0xffff0000, v59
    v_exp_f32_e64 v29, v29
    v_mfma_f32_16x16x32_bf16 v[36:39], a[204:207], a[12:15], 0
    v_mul_f32 v100, s98, v100
    v_mul_f32 v101, s98, v101
    v_mul_f32 v102, s98, v102
    v_exp_f32 v30, v30
    v_mfma_f32_16x16x32_bf16 v[36:39], a[200:203], a[8:11], v[36:39]
    v_mul_f32 v103, s98, v103
    v_mul_f32 v104, s98, v104
    v_mul_f32 v105, s98, v105
    v_exp_f32 v32, v32
    v_exp_f32_e64 v31, v31
    v_mfma_f32_16x16x32_bf16 v[36:39], a[196:199], a[4:7], v[36:39]
    v_cvt_pk_bf16_f32 v20, v24, v25
    v_cvt_pk_bf16_f32 v21, v26, v27
    v_cvt_pk_bf16_f32 v22, v28, v29
    v_cvt_pk_bf16_f32 v23, v30, v31
    v_mul_f32 v106, s98, v106
    v_mul_f32 v107, s98, v107
    v_cvt_pk_bf16_f32 v56, v100, v101
    v_exp_f32_e64 v33, v33
    s_mov_b32 s95, 8192
    buffer_load_dwordx4 v[76:79], v92, s[12:15], s95 offen nt
    v_mfma_f32_16x16x32_bf16 v[36:39], a[192:195], a[0:3], v[36:39]
    v_cvt_pk_bf16_f32 v57, v102, v103
    v_cvt_pk_bf16_f32 v58, v104, v105
    v_cvt_pk_bf16_f32 v59, v106, v107
    v_exp_f32_e64 v34, v34
    v_mfma_f32_16x16x32_bf16 v[68:71], v[108:111], a[0:3], 0
    ds_write_b128 v93, v[56:59] offset:45056
    v_exp_f32_e64 v35, v35
    v_mfma_f32_16x16x32_bf16 v[68:71], v[112:115], a[4:7], v[68:71]
    v_exp_f32_e64 v36, v36
    s_mov_b32 s95, 20480
    buffer_load_dwordx4 v[80:83], v92, s[12:15], s95 offen nt
    v_mfma_f32_16x16x32_bf16 v[68:71], v[116:119], a[8:11], v[68:71]
    v_exp_f32_e64 v37, v37
    s_waitcnt lgkmcnt(0)
    s_barrier
    ds_read_b128 a[64:67], v95 offset:32768
    ds_read_b128 a[68:71], v95 offset:33024
    v_mfma_f32_16x16x32_bf16 v[68:71], v[120:123], a[12:15], v[68:71]
    v_exp_f32_e64 v38, v38
    ds_read_b128 a[72:75], v95 offset:33280
    ds_read_b128 a[76:79], v95 offset:33536
    v_mfma_f32_16x16x32_bf16 v[72:75], v[136:139], a[12:15], 0
    v_exp_f32_e64 v39, v39
    s_mov_b32 s95, 32768
    buffer_load_dwordx4 v[84:87], v92, s[12:15], s95 offen nt
    ds_read_b128 a[16:19], v94 offset:32768
    ds_read_b128 a[20:23], v94 offset:33024
    v_mfma_f32_16x16x32_bf16 v[72:75], v[132:135], a[8:11], v[72:75]
    v_cvt_pk_bf16_f32 v212, v32, v33
    v_cvt_pk_bf16_f32 v213, v34, v35
    v_cvt_pk_bf16_f32 v214, v36, v37
    v_cvt_pk_bf16_f32 v215, v38, v39
    ds_read_b128 a[24:27], v94 offset:33280
    ds_read_b128 a[28:31], v94 offset:33536
    v_mfma_f32_16x16x32_bf16 v[72:75], v[128:131], a[4:7], v[72:75]
    v_exp_f32_e64 v68, v68
    v_mfma_f32_16x16x32_bf16 v[72:75], v[124:127], a[0:3], v[72:75]
    v_exp_f32_e64 v69, v69
    s_mov_b32 s95, 45056
    buffer_load_dwordx4 v[88:91], v92, s[12:15], s95 offen nt
    s_waitcnt lgkmcnt(4)
    v_mfma_f32_16x16x32_bf16 v[228:231], a[176:179], a[64:67], 0
    v_exp_f32 v70, v70
    v_mfma_f32_16x16x32_bf16 v[228:231], a[180:183], a[68:71], v[228:231]
    v_exp_f32_e64 v71, v71
    v_mfma_f32_16x16x32_bf16 v[228:231], a[184:187], a[72:75], v[228:231]
    v_exp_f32_e64 v72, v72
    v_mfma_f32_16x16x32_bf16 v[228:231], a[188:191], a[76:79], v[228:231]
    v_exp_f32_e64 v73, v73
    v_mfma_f32_16x16x32_bf16 v[232:235], a[204:207], a[76:79], 0
    v_exp_f32_e64 v74, v74
    v_mfma_f32_16x16x32_bf16 v[232:235], a[200:203], a[72:75], v[232:235]
    v_exp_f32_e64 v75, v75
    s_add_u32 m0, s37, 65536
    v_mfma_f32_16x16x32_bf16 v[232:235], a[196:199], a[68:71], v[232:235]
    v_cvt_pk_bf16_f32 v216, v68, v69
    v_cvt_pk_bf16_f32 v217, v70, v71
    v_cvt_pk_bf16_f32 v218, v72, v73
    v_cvt_pk_bf16_f32 v219, v74, v75
    v_exp_f32_e64 v228, v228
    v_mfma_f32_16x16x32_bf16 v[232:235], a[192:195], a[64:67], v[232:235]
    v_exp_f32_e64 v229, v229
    v_mfma_f32_16x16x32_bf16 v[196:199], v[108:111], a[64:67], 0
    v_exp_f32_e64 v230, v230
    buffer_load_dwordx4 v6, s[16:19], 0 offen nt lds
    v_mfma_f32_16x16x32_bf16 v[196:199], v[112:115], a[68:71], v[196:199]
    v_exp_f32_e64 v231, v231
    v_mfma_f32_16x16x32_bf16 v[196:199], v[116:119], a[72:75], v[196:199]
    v_cvt_pk_bf16_f32 v60, v228, v229
    v_cvt_pk_bf16_f32 v61, v230, v231
    v_exp_f32_e64 v232, v232
    v_mfma_f32_16x16x32_bf16 v[196:199], v[120:123], a[76:79], v[196:199]
    v_exp_f32_e64 v233, v233
    v_mfma_f32_16x16x32_bf16 v[200:203], v[136:139], a[76:79], 0
    v_exp_f32_e64 v234, v234
    v_mfma_f32_16x16x32_bf16 v[200:203], v[132:135], a[72:75], v[200:203]
    v_exp_f32_e64 v235, v235
    v_mfma_f32_16x16x32_bf16 v[200:203], v[128:131], a[68:71], v[200:203]
    v_cvt_pk_bf16_f32 v62, v232, v233
    v_cvt_pk_bf16_f32 v63, v234, v235
    v_exp_f32_e64 v196, v196
    v_mfma_f32_16x16x32_bf16 v[200:203], v[124:127], a[64:67], v[200:203]
    v_exp_f32 v197, v197
    s_waitcnt lgkmcnt(0)
    v_mfma_f32_16x16x32_bf16 v[204:207], a[176:179], a[16:19], 0
    v_exp_f32_e64 v198, v198
    buffer_load_dwordx4 v7, s[16:19], 0 offen offset:1024 nt lds
    v_mfma_f32_16x16x32_bf16 v[204:207], a[180:183], a[20:23], v[204:207]
    v_exp_f32_e64 v199, v199
    v_mfma_f32_16x16x32_bf16 v[204:207], a[184:187], a[24:27], v[204:207]
    v_cvt_pk_bf16_f32 v64, v196, v197
    v_cvt_pk_bf16_f32 v65, v198, v199
    v_exp_f32_e64 v200, v200
    v_mfma_f32_16x16x32_bf16 v[204:207], a[188:191], a[28:31], v[204:207]
    v_exp_f32_e64 v201, v201
    v_mfma_f32_16x16x32_bf16 v[208:211], a[204:207], a[28:31], 0
    v_exp_f32_e64 v202, v202
    v_mfma_f32_16x16x32_bf16 v[208:211], a[200:203], a[24:27], v[208:211]
    v_exp_f32_e64 v203, v203
    buffer_load_dwordx4 v8, s[16:19], 0 offen offset:2048 nt lds
    v_mfma_f32_16x16x32_bf16 v[208:211], a[196:199], a[20:23], v[208:211]
    v_cvt_pk_bf16_f32 v66, v200, v201
    v_cvt_pk_bf16_f32 v67, v202, v203
    v_exp_f32 v204, v204
    v_exp_f32 v205, v205
    v_exp_f32_e64 v206, v206
    v_mfma_f32_16x16x32_bf16 v[208:211], a[192:195], a[16:19], v[208:211]
    v_exp_f32_e64 v207, v207
    v_mfma_f32_16x16x32_bf16 v[24:27], v[108:111], a[16:19], 0
    v_cvt_pk_bf16_f32 v220, v204, v205
    v_cvt_pk_bf16_f32 v221, v206, v207
    v_mfma_f32_16x16x32_bf16 v[24:27], v[112:115], a[20:23], v[24:27]
    v_subrev_u32 v94, 0x18000, v94
    v_subrev_u32 v95, 0x18000, v95
    v_mfma_f32_16x16x32_bf16 v[24:27], v[116:119], a[24:27], v[24:27]
    v_exp_f32 v208, v208
    v_exp_f32 v209, v209
    v_exp_f32 v210, v210
    v_mfma_f32_16x16x32_bf16 v[24:27], v[120:123], a[28:31], v[24:27]
    s_waitcnt vmcnt(7)
    ds_read_b64_tr_b16 v[140:141], v2
    ds_read_b64_tr_b16 v[142:143], v2 offset:4096
    ds_read_b64_tr_b16 v[144:145], v2 offset:8
    ds_read_b64_tr_b16 v[146:147], v2 offset:4104
    ds_read_b64_tr_b16 v[148:149], v2 offset:256
    ds_read_b64_tr_b16 v[150:151], v2 offset:4352
    ds_read_b64_tr_b16 v[152:153], v2 offset:264
    ds_read_b64_tr_b16 v[154:155], v2 offset:4360
    ds_read_b64_tr_b16 v[156:157], v2 offset:512
    ds_read_b64_tr_b16 v[158:159], v2 offset:4608
    ds_read_b64_tr_b16 v[160:161], v2 offset:520
    ds_read_b64_tr_b16 v[162:163], v2 offset:4616
    ds_read_b64_tr_b16 a[248:249], v2 offset:768
    ds_read_b64_tr_b16 a[250:251], v2 offset:4864
    ds_read_b64_tr_b16 a[252:253], v2 offset:776
    ds_read_b64_tr_b16 a[254:255], v2 offset:4872
    s_barrier
    v_exp_f32 v211, v211
    v_mfma_f32_16x16x32_bf16 v[28:31], v[136:139], a[28:31], 0
    v_cvt_pk_bf16_f32 v222, v208, v209
    v_cvt_pk_bf16_f32 v223, v210, v211
    ds_read_b64_tr_b16 v[164:165], v98
    ds_read_b64_tr_b16 v[166:167], v98 offset:4096
    v_mfma_f32_16x16x32_bf16 v[28:31], v[132:135], a[24:27], v[28:31]
    ds_read_b64_tr_b16 v[168:169], v98 offset:8
    ds_read_b64_tr_b16 v[170:171], v98 offset:4104
    buffer_load_dwordx4 v9, s[16:19], 0 offen offset:3072 nt lds
    v_mfma_f32_16x16x32_bf16 v[28:31], v[128:131], a[20:23], v[28:31]
    ds_read_b64_tr_b16 v[172:173], v98 offset:256
    ds_read_b64_tr_b16 v[174:175], v98 offset:4352
    v_mfma_f32_16x16x32_bf16 v[28:31], v[124:127], a[16:19], v[28:31]
    ds_read_b64_tr_b16 v[176:177], v98 offset:264
    ds_read_b64_tr_b16 v[178:179], v98 offset:4360
    v_mfma_f32_16x16x32_bf16 v[252:255], a[240:243], v[12:15], v[252:255]
    ds_read_b64_tr_b16 v[180:181], v98 offset:512
    ds_read_b64_tr_b16 v[182:183], v98 offset:4608
    s_waitcnt lgkmcnt(15)
    v_mfma_f32_16x16x32_bf16 a[208:211], v[140:143], v[12:15], 0
    ds_read_b64_tr_b16 v[184:185], v98 offset:520
    ds_read_b64_tr_b16 v[186:187], v98 offset:4616
    s_add_u32 m0, s37, 69632
    v_mfma_f32_16x16x32_bf16 a[212:215], v[144:147], v[12:15], 0
    ds_read_b64_tr_b16 v[188:189], v98 offset:768
    ds_read_b64_tr_b16 v[190:191], v98 offset:4864
    v_mfma_f32_16x16x32_bf16 a[216:219], v[148:151], v[12:15], 0
    ds_read_b64_tr_b16 v[192:193], v98 offset:776
    ds_read_b64_tr_b16 v[194:195], v98 offset:4872
    v_mfma_f32_16x16x32_bf16 a[220:223], v[152:155], v[12:15], 0
    v_subrev_u32 v93, 0x18000, v93
    buffer_load_dwordx4 v6, s[20:23], 0 offen nt lds
    s_waitcnt lgkmcnt(15)
    v_mfma_f32_16x16x32_bf16 a[224:227], v[156:159], v[12:15], 0
    v_exp_f32_e64 v24, v24
    v_mfma_f32_16x16x32_bf16 a[228:231], v[160:163], v[12:15], 0
    v_exp_f32_e64 v25, v25
    v_mfma_f32_16x16x32_bf16 a[232:235], a[248:251], v[12:15], 0
    v_exp_f32_e64 v26, v26
    v_mfma_f32_16x16x32_bf16 a[236:239], a[252:255], v[12:15], 0
    v_exp_f32_e64 v27, v27
    v_smfmac_f32_16x16x64_bf16 v[240:243], a[244:247], v[16:23], v5
    v_cvt_pk_bf16_f32 v224, v24, v25
    v_mfma_f32_16x16x32_bf16 a[112:115], v[140:143], v[16:19], 0
    v_cvt_pk_bf16_f32 v225, v26, v27
    s_waitcnt lgkmcnt(8)
    v_mfma_f32_16x16x32_bf16 a[112:115], v[164:167], v[20:23], a[112:115]
    v_exp_f32 v28, v28
    buffer_load_dwordx4 v7, s[20:23], 0 offen offset:1024 nt lds
    v_mfma_f32_16x16x32_bf16 a[116:119], v[144:147], v[16:19], 0
    v_exp_f32_e64 v29, v29
    v_mfma_f32_16x16x32_bf16 a[116:119], v[168:171], v[20:23], a[116:119]
    v_exp_f32_e64 v30, v30
    v_mfma_f32_16x16x32_bf16 a[120:123], v[148:151], v[16:19], 0
    v_exp_f32_e64 v31, v31
    v_mfma_f32_16x16x32_bf16 a[120:123], v[172:175], v[20:23], a[120:123]
    v_cvt_pk_bf16_f32 v226, v28, v29
    v_cvt_pk_bf16_f32 v227, v30, v31
    v_mfma_f32_16x16x32_bf16 a[124:127], v[152:155], v[16:19], 0
    v_add_u32 v1, s38, v3
    v_add_u32 v2, s39, v4
    v_mfma_f32_16x16x32_bf16 a[124:127], v[176:179], v[20:23], a[124:127]
    buffer_load_dwordx4 v8, s[20:23], 0 offen offset:2048 nt lds
    v_mfma_f32_16x16x32_bf16 a[128:131], v[156:159], v[16:19], 0
    s_waitcnt lgkmcnt(0)
    v_mfma_f32_16x16x32_bf16 a[128:131], v[180:183], v[20:23], a[128:131]
    s_waitcnt vmcnt(10)
    v_lshlrev_b32_e64 v100, 16, v76
    v_mfma_f32_16x16x32_bf16 a[132:135], v[160:163], v[16:19], 0
    v_and_b32 v101, 0xffff0000, v76
    v_lshlrev_b32_e64 v102, 16, v77
    v_mfma_f32_16x16x32_bf16 a[132:135], v[184:187], v[20:23], a[132:135]
    v_and_b32 v103, 0xffff0000, v77
    v_lshlrev_b32_e64 v104, 16, v78
    v_mfma_f32_16x16x32_bf16 a[136:139], a[248:251], v[16:19], 0
    v_and_b32 v105, 0xffff0000, v78
    v_lshlrev_b32_e64 v106, 16, v79
    v_mfma_f32_16x16x32_bf16 a[136:139], v[188:191], v[20:23], a[136:139]
    v_and_b32 v107, 0xffff0000, v79
    v_mul_f32_e64 v100, s98, v100
    v_mfma_f32_16x16x32_bf16 a[140:143], a[252:255], v[16:19], 0
    v_mul_f32 v101, s98, v101
    v_mul_f32 v102, s98, v102
    v_mfma_f32_16x16x32_bf16 a[140:143], v[192:195], v[20:23], a[140:143]
    v_mul_f32 v103, s98, v103
    v_mul_f32 v104, s98, v104
    buffer_load_dwordx4 v9, s[20:23], 0 offen offset:3072 nt lds
    v_smfmac_f32_16x16x64_bf16 v[240:243], a[240:243], v[212:219], v5
    v_mul_f32_e64 v105, s98, v105
    v_mfma_f32_16x16x32_bf16 v[12:15], v[140:143], v[212:215], 0
    v_mul_f32 v106, s98, v106
    v_mul_f32 v107, s98, v107
    v_mfma_f32_16x16x32_bf16 v[12:15], v[164:167], v[216:219], v[12:15]
    v_cvt_pk_bf16_f32 v76, v100, v101
    v_cvt_pk_bf16_f32 v77, v102, v103
    v_mfma_f32_16x16x32_bf16 v[16:19], v[144:147], v[212:215], 0
    v_cvt_pk_bf16_f32 v78, v104, v105
    v_cvt_pk_bf16_f32 v79, v106, v107
    s_add_u32 m0, s37, 98304
    v_mfma_f32_16x16x32_bf16 v[16:19], v[168:171], v[216:219], v[16:19]
    ds_write_b128 v93, v[76:79]
    v_mfma_f32_16x16x32_bf16 v[20:23], v[148:151], v[212:215], 0
    s_waitcnt vmcnt(10)
    v_lshlrev_b32 v100, 16, v80
    v_and_b32 v101, 0xffff0000, v80
    v_mfma_f32_16x16x32_bf16 v[20:23], v[172:175], v[216:219], v[20:23]
    v_lshlrev_b32_e64 v102, 16, v81
    v_and_b32 v103, 0xffff0000, v81
    buffer_load_dwordx4 v6, s[24:27], s92 offen nt lds
    v_mfma_f32_16x16x32_bf16 v[24:27], v[152:155], v[212:215], 0
    v_lshlrev_b32_e64 v104, 16, v82
    v_and_b32 v105, 0xffff0000, v82
    v_mfma_f32_16x16x32_bf16 v[24:27], v[176:179], v[216:219], v[24:27]
    v_lshlrev_b32_e64 v106, 16, v83
    v_and_b32 v107, 0xffff0000, v83
    v_mfma_f32_16x16x32_bf16 v[28:31], v[156:159], v[212:215], 0
    v_mul_f32 v100, s98, v100
    v_mul_f32 v101, s98, v101
    v_mfma_f32_16x16x32_bf16 v[28:31], v[180:183], v[216:219], v[28:31]
    v_mul_f32 v102, s98, v102
    v_mul_f32 v103, s98, v103
    v_mfma_f32_16x16x32_bf16 v[32:35], v[160:163], v[212:215], 0
    v_mul_f32 v104, s98, v104
    v_mul_f32 v105, s98, v105
    v_mfma_f32_16x16x32_bf16 v[32:35], v[184:187], v[216:219], v[32:35]
    v_mul_f32 v106, s98, v106
    v_mul_f32 v107, s98, v107
    v_mfma_f32_16x16x32_bf16 v[36:39], a[248:251], v[212:215], 0
    v_cvt_pk_bf16_f32 v80, v100, v101
    v_cvt_pk_bf16_f32 v81, v102, v103
    buffer_load_dwordx4 v6, s[24:27], s92 offen offset:1024 nt lds
    v_mfma_f32_16x16x32_bf16 v[36:39], v[188:191], v[216:219], v[36:39]
    v_cvt_pk_bf16_f32 v82, v104, v105
    v_cvt_pk_bf16_f32 v83, v106, v107
    v_mfma_f32_16x16x32_bf16 v[40:43], a[252:255], v[212:215], 0
    ds_write_b128 v93, v[80:83] offset:4096
    v_mfma_f32_16x16x32_bf16 v[40:43], v[192:195], v[216:219], v[40:43]
    s_waitcnt vmcnt(11)
    v_lshlrev_b32 v100, 16, v84
    v_smfmac_f32_16x16x64_bf16 v[244:247], a[244:247], v[60:67], v5
    v_and_b32 v101, 0xffff0000, v84
    v_mfma_f32_16x16x32_bf16 a[144:147], v[140:143], v[60:63], 0
    v_lshlrev_b32_e64 v102, 16, v85
    v_and_b32 v103, 0xffff0000, v85
    v_mfma_f32_16x16x32_bf16 a[144:147], v[164:167], v[64:67], a[144:147]
    v_lshlrev_b32_e64 v104, 16, v86
    v_and_b32 v105, 0xffff0000, v86
    v_mfma_f32_16x16x32_bf16 a[148:151], v[144:147], v[60:63], 0
    v_lshlrev_b32_e64 v106, 16, v87
    v_and_b32 v107, 0xffff0000, v87
    buffer_load_dwordx4 v6, s[24:27], s92 offen offset:2048 nt lds
    v_mfma_f32_16x16x32_bf16 a[148:151], v[168:171], v[64:67], a[148:151]
    v_mul_f32 v100, s98, v100
    v_mul_f32 v101, s98, v101
    v_mfma_f32_16x16x32_bf16 a[152:155], v[148:151], v[60:63], 0
    v_mul_f32 v102, s98, v102
    v_mul_f32 v103, s98, v103
    v_mfma_f32_16x16x32_bf16 a[152:155], v[172:175], v[64:67], a[152:155]
    v_mul_f32 v104, s98, v104
    v_mul_f32 v105, s98, v105
    v_mfma_f32_16x16x32_bf16 a[156:159], v[152:155], v[60:63], 0
    v_mul_f32 v106, s98, v106
    v_mul_f32 v107, s98, v107
    v_mfma_f32_16x16x32_bf16 a[156:159], v[176:179], v[64:67], a[156:159]
    v_cvt_pk_bf16_f32 v84, v100, v101
    v_cvt_pk_bf16_f32 v85, v102, v103
    v_mfma_f32_16x16x32_bf16 a[160:163], v[156:159], v[60:63], 0
    v_cvt_pk_bf16_f32 v86, v104, v105
    v_cvt_pk_bf16_f32 v87, v106, v107
    v_mfma_f32_16x16x32_bf16 a[160:163], v[180:183], v[64:67], a[160:163]
    ds_write_b128 v93, v[84:87] offset:8192
    buffer_load_dwordx4 v6, s[24:27], s92 offen offset:3072 nt lds
    v_mfma_f32_16x16x32_bf16 a[164:167], v[160:163], v[60:63], 0
    s_waitcnt vmcnt(12)
    v_lshlrev_b32 v100, 16, v88
    v_mfma_f32_16x16x32_bf16 a[164:167], v[184:187], v[64:67], a[164:167]
    v_and_b32 v101, 0xffff0000, v88
    v_lshlrev_b32_e64 v102, 16, v89
    v_mfma_f32_16x16x32_bf16 a[168:171], a[248:251], v[60:63], 0
    v_and_b32 v103, 0xffff0000, v89
    v_lshlrev_b32_e64 v104, 16, v90
    v_mfma_f32_16x16x32_bf16 a[168:171], v[188:191], v[64:67], a[168:171]
    v_and_b32 v105, 0xffff0000, v90
    v_lshlrev_b32_e64 v106, 16, v91
    s_add_u32 m0, s37, 102400
    v_mfma_f32_16x16x32_bf16 a[172:175], a[252:255], v[60:63], 0
    v_and_b32 v107, 0xffff0000, v91
    v_mul_f32_e64 v100, s98, v100
    v_mfma_f32_16x16x32_bf16 a[172:175], v[192:195], v[64:67], a[172:175]
    v_mul_f32 v101, s98, v101
    v_mul_f32 v102, s98, v102
    v_smfmac_f32_16x16x64_bf16 v[244:247], a[240:243], v[220:227], v5
    v_mul_f32_e64 v103, s98, v103
    buffer_load_dwordx4 v6, s[28:31], s92 offen nt lds
    v_mfma_f32_16x16x32_bf16 v[44:47], v[140:143], v[220:223], 0
    v_mul_f32 v104, s98, v104
    v_mul_f32 v105, s98, v105
    v_mfma_f32_16x16x32_bf16 v[44:47], v[164:167], v[224:227], v[44:47]
    v_mul_f32 v106, s98, v106
    v_mul_f32 v107, s98, v107
    v_mfma_f32_16x16x32_bf16 v[48:51], v[144:147], v[220:223], 0
    v_cvt_pk_bf16_f32 v88, v100, v101
    v_cvt_pk_bf16_f32 v89, v102, v103
    v_mfma_f32_16x16x32_bf16 v[48:51], v[168:171], v[224:227], v[48:51]
    v_cvt_pk_bf16_f32 v90, v104, v105
    v_cvt_pk_bf16_f32 v91, v106, v107
    v_mfma_f32_16x16x32_bf16 v[52:55], v[148:151], v[220:223], 0
    ds_write_b128 v93, v[88:91] offset:12288
    v_mfma_f32_16x16x32_bf16 v[52:55], v[172:175], v[224:227], v[52:55]
    v_add_f32 v242, v242, v243
    v_add_f32 v246, v246, v247
    v_mfma_f32_16x16x32_bf16 v[56:59], v[152:155], v[220:223], 0
    buffer_load_dwordx4 v6, s[28:31], s92 offen offset:1024 nt lds
    v_mfma_f32_16x16x32_bf16 v[56:59], v[176:179], v[224:227], v[56:59]
    s_waitcnt lgkmcnt(0)
    s_barrier
    ds_read_b128 a[80:83], v95
    ds_read_b128 a[84:87], v95 offset:256
    v_mfma_f32_16x16x32_bf16 v[60:63], v[156:159], v[220:223], 0
    ds_read_b128 a[88:91], v95 offset:512
    ds_read_b128 a[92:95], v95 offset:768
    v_mfma_f32_16x16x32_bf16 v[60:63], v[180:183], v[224:227], v[60:63]
    ds_read_b128 a[32:35], v94
    ds_read_b128 a[36:39], v94 offset:256
    v_mfma_f32_16x16x32_bf16 v[64:67], v[160:163], v[220:223], 0
    ds_read_b128 a[40:43], v94 offset:512
    ds_read_b128 a[44:47], v94 offset:768
    v_mfma_f32_16x16x32_bf16 v[64:67], v[184:187], v[224:227], v[64:67]
    v_mfma_f32_16x16x32_bf16 v[68:71], a[248:251], v[220:223], 0
    v_mfma_f32_16x16x32_bf16 v[68:71], v[188:191], v[224:227], v[68:71]
    buffer_load_dwordx4 v6, s[28:31], s92 offen offset:2048 nt lds
    v_mfma_f32_16x16x32_bf16 v[72:75], a[252:255], v[220:223], 0
    v_mfma_f32_16x16x32_bf16 v[72:75], v[192:195], v[224:227], v[72:75]
    s_waitcnt lgkmcnt(4)
    v_mfma_f32_16x16x32_bf16 v[196:199], a[176:179], a[80:83], 0
    v_mfma_f32_16x16x32_bf16 v[196:199], a[180:183], a[84:87], v[196:199]
    v_mfma_f32_16x16x32_bf16 v[196:199], a[184:187], a[88:91], v[196:199]
    v_mfma_f32_16x16x32_bf16 v[196:199], a[188:191], a[92:95], v[196:199]
    buffer_load_dwordx4 v6, s[28:31], s92 offen offset:3072 nt lds
    v_mfma_f32_16x16x32_bf16 v[200:203], a[204:207], a[92:95], 0
    s_nop 0
    s_nop 0
    v_mfma_f32_16x16x32_bf16 v[200:203], a[200:203], a[88:91], v[200:203]
    s_nop 0
    s_nop 0
    v_mfma_f32_16x16x32_bf16 v[200:203], a[196:199], a[84:87], v[200:203]
    s_nop 0
    v_mfma_f32_16x16x32_bf16 v[200:203], a[192:195], a[80:83], v[200:203]
    s_add_u32 m0, s37, 131072
    s_waitcnt lgkmcnt(0)
    v_mfma_f32_16x16x32_bf16 v[204:207], a[176:179], a[32:35], 0
    v_exp_f32 v196, v196
    v_mfma_f32_16x16x32_bf16 v[204:207], a[180:183], a[36:39], v[204:207]
    v_exp_f32_e64 v197, v197
    v_mfma_f32_16x16x32_bf16 v[204:207], a[184:187], a[40:43], v[204:207]
    v_exp_f32_e64 v198, v198
    v_mfma_f32_16x16x32_bf16 v[204:207], a[188:191], a[44:47], v[204:207]
    v_exp_f32_e64 v199, v199
    v_mfma_f32_16x16x32_bf16 v[208:211], a[204:207], a[44:47], 0
    v_exp_f32_e64 v200, v200
    buffer_load_dwordx4 v6, s[16:19], s92 offen nt lds
    v_mfma_f32_16x16x32_bf16 v[208:211], a[200:203], a[40:43], v[208:211]
    v_exp_f32_e64 v201, v201
    v_mfma_f32_16x16x32_bf16 v[208:211], a[196:199], a[36:39], v[208:211]
    v_exp_f32_e64 v202, v202
    v_mfma_f32_16x16x32_bf16 v[208:211], a[192:195], a[32:35], v[208:211]
    v_cvt_pk_bf16_f32 v212, v196, v197
    v_cvt_pk_bf16_f32 v213, v198, v199
    v_mfma_f32_16x16x32_bf16 v[220:223], v[108:111], a[32:35], 0
    v_exp_f32_e64 v203, v203
    v_mfma_f32_16x16x32_bf16 v[220:223], v[112:115], a[36:39], v[220:223]
    v_cvt_pk_bf16_f32 v214, v200, v201
    v_cvt_pk_bf16_f32 v215, v202, v203
    v_mfma_f32_16x16x32_bf16 v[220:223], v[116:119], a[40:43], v[220:223]
    s_barrier
    buffer_load_dwordx4 v7, s[16:19], s92 offen offset:1024 nt lds
    v_mfma_f32_16x16x32_bf16 v[220:223], v[120:123], a[44:47], v[220:223]
    v_exp_f32 v204, v204
    v_mfma_f32_16x16x32_bf16 v[224:227], v[136:139], a[44:47], 0
    v_exp_f32_e64 v205, v205
    v_mfma_f32_16x16x32_bf16 v[224:227], v[132:135], a[40:43], v[224:227]
    v_exp_f32_e64 v206, v206
    v_mfma_f32_16x16x32_bf16 v[224:227], v[128:131], a[36:39], v[224:227]
    v_exp_f32_e64 v207, v207
    v_mfma_f32_16x16x32_bf16 v[224:227], v[124:127], a[32:35], v[224:227]
    v_cvt_pk_bf16_f32 v228, v204, v205
    v_cvt_pk_bf16_f32 v229, v206, v207
    v_mfma_f32_16x16x32_bf16 v[248:251], a[244:247], v[212:215], v[248:251]
    v_exp_f32_e64 v208, v208
    v_mfma_f32_16x16x32_bf16 a[176:179], v[140:143], v[212:215], 0
    v_exp_f32_e64 v220, v220
    v_mfma_f32_16x16x32_bf16 a[180:183], v[144:147], v[212:215], 0
    v_exp_f32_e64 v209, v209
    v_mfma_f32_16x16x32_bf16 a[184:187], v[148:151], v[212:215], 0
    v_exp_f32_e64 v221, v221
    v_mfma_f32_16x16x32_bf16 a[188:191], v[152:155], v[212:215], 0
    v_exp_f32_e64 v210, v210
    buffer_load_dwordx4 v8, s[16:19], s92 offen offset:2048 nt lds
    v_mfma_f32_16x16x32_bf16 a[192:195], v[156:159], v[212:215], 0
    v_exp_f32_e64 v222, v222
    v_mfma_f32_16x16x32_bf16 a[196:199], v[160:163], v[212:215], 0
    v_exp_f32_e64 v211, v211
    v_mfma_f32_16x16x32_bf16 a[200:203], a[248:251], v[212:215], 0
    v_exp_f32_e64 v223, v223
    v_mfma_f32_16x16x32_bf16 a[204:207], a[252:255], v[212:215], 0
    v_cvt_pk_bf16_f32 v230, v208, v209
    v_cvt_pk_bf16_f32 v231, v210, v211
    v_mfma_f32_16x16x32_bf16 v[204:207], v[108:111], a[80:83], 0
    s_waitcnt vmcnt(11)
    ds_read_b128 v[108:111], v1
    v_mfma_f32_16x16x32_bf16 v[204:207], v[112:115], a[84:87], v[204:207]
    v_exp_f32 v224, v224
    v_mfma_f32_16x16x32_bf16 v[204:207], v[116:119], a[88:91], v[204:207]
    ds_read_b128 v[112:115], v1 offset:256
    v_exp_f32_e64 v225, v225
    v_mfma_f32_16x16x32_bf16 v[204:207], v[120:123], a[92:95], v[204:207]
    ds_read_b128 v[116:119], v1 offset:512
    v_exp_f32 v226, v226
    v_mov_b32 v251, 0
    v_mfma_f32_16x16x32_bf16 v[208:211], v[136:139], a[92:95], 0
    ds_read_b128 v[120:123], v1 offset:768
    v_cvt_pk_bf16_f32 v232, v220, v221
    v_cvt_pk_bf16_f32 v233, v222, v223
    v_exp_f32_e64 v227, v227
    v_mfma_f32_16x16x32_bf16 v[208:211], v[132:135], a[88:91], v[208:211]
    ds_read_b128 v[136:139], v1 offset:4864
    v_cvt_pk_bf16_f32 v234, v224, v225
    v_cvt_pk_bf16_f32 v235, v226, v227
    v_mfma_f32_16x16x32_bf16 v[208:211], v[128:131], a[84:87], v[208:211]
    ds_read_b128 v[132:135], v1 offset:4608
    buffer_load_dwordx4 v9, s[16:19], s92 offen offset:3072 nt lds
    v_mfma_f32_16x16x32_bf16 v[208:211], v[124:127], a[80:83], v[208:211]
    ds_read_b128 v[128:131], v1 offset:4352
    s_add_u32 m0, s37, 135168
    v_smfmac_f32_16x16x64_bf16 v[248:251], a[240:243], v[228:235], v5
    ds_read_b128 v[124:127], v1 offset:4096
    v_mfma_f32_16x16x32_bf16 v[76:79], v[140:143], v[228:231], 0
    v_mfma_f32_16x16x32_bf16 v[76:79], v[164:167], v[232:235], v[76:79]
    buffer_load_dwordx4 v6, s[20:23], s92 offen nt lds
    v_mfma_f32_16x16x32_bf16 v[80:83], v[144:147], v[228:231], 0
    v_exp_f32_e64 v204, v204
    v_mfma_f32_16x16x32_bf16 v[80:83], v[168:171], v[232:235], v[80:83]
    v_exp_f32_e64 v205, v205
    v_mfma_f32_16x16x32_bf16 v[84:87], v[148:151], v[228:231], 0
    v_exp_f32_e64 v206, v206
    v_mfma_f32_16x16x32_bf16 v[84:87], v[172:175], v[232:235], v[84:87]
    v_exp_f32_e64 v207, v207
    v_mfma_f32_16x16x32_bf16 v[88:91], v[152:155], v[228:231], 0
    v_cvt_pk_bf16_f32 v236, v204, v205
    v_cvt_pk_bf16_f32 v237, v206, v207
    v_mfma_f32_16x16x32_bf16 v[88:91], v[176:179], v[232:235], v[88:91]
    buffer_load_dwordx4 v7, s[20:23], s92 offen offset:1024 nt lds
    s_waitcnt lgkmcnt(0)
    v_mfma_f32_16x16x32_bf16 v[196:199], v[108:111], a[48:51], 0
    v_exp_f32 v208, v208
    v_mfma_f32_16x16x32_bf16 v[196:199], v[112:115], a[52:55], v[196:199]
    v_exp_f32_e64 v209, v209
    v_mfma_f32_16x16x32_bf16 v[196:199], v[116:119], a[56:59], v[196:199]
    v_exp_f32_e64 v210, v210
    v_mfma_f32_16x16x32_bf16 v[196:199], v[120:123], a[60:63], v[196:199]
    v_exp_f32_e64 v211, v211
    v_mfma_f32_16x16x32_bf16 v[200:203], v[136:139], a[60:63], 0
    v_cvt_pk_bf16_f32 v238, v208, v209
    v_cvt_pk_bf16_f32 v239, v210, v211
    v_mfma_f32_16x16x32_bf16 v[200:203], v[132:135], a[56:59], v[200:203]
    v_xor_b32 v1, 0x2000, v1
    s_nop 0
    v_mfma_f32_16x16x32_bf16 v[200:203], v[128:131], a[52:55], v[200:203]
    v_exp_f32 v196, v196
    v_mfma_f32_16x16x32_bf16 v[200:203], v[124:127], a[48:51], v[200:203]
    v_exp_f32_e64 v197, v197
    v_mfma_f32_16x16x32_bf16 v[92:95], v[156:159], v[228:231], 0
    v_exp_f32_e64 v198, v198
    v_mfma_f32_16x16x32_bf16 v[92:95], v[180:183], v[232:235], v[92:95]
    v_exp_f32_e64 v199, v199
    v_mfma_f32_16x16x32_bf16 v[96:99], v[160:163], v[228:231], 0
    v_cvt_pk_bf16_f32 v220, v196, v197
    v_cvt_pk_bf16_f32 v221, v198, v199
    buffer_load_dwordx4 v8, s[20:23], s92 offen offset:2048 nt lds
    v_mfma_f32_16x16x32_bf16 v[96:99], v[184:187], v[232:235], v[96:99]
    v_exp_f32_e64 v200, v200
    v_mfma_f32_16x16x32_bf16 v[100:103], a[248:251], v[228:231], 0
    v_exp_f32_e64 v201, v201
    v_mfma_f32_16x16x32_bf16 v[100:103], v[188:191], v[232:235], v[100:103]
    v_exp_f32_e64 v202, v202
    v_mfma_f32_16x16x32_bf16 v[104:107], a[252:255], v[228:231], 0
    v_exp_f32_e64 v203, v203
    v_mfma_f32_16x16x32_bf16 v[104:107], v[192:195], v[232:235], v[104:107]
    v_cvt_pk_bf16_f32 v222, v200, v201
    v_cvt_pk_bf16_f32 v223, v202, v203
    v_mfma_f32_16x16x32_bf16 v[204:207], v[108:111], a[64:67], 0
    v_mfma_f32_16x16x32_bf16 v[204:207], v[112:115], a[68:71], v[204:207]
    v_mfma_f32_16x16x32_bf16 v[204:207], v[116:119], a[72:75], v[204:207]
    buffer_load_dwordx4 v9, s[20:23], s92 offen offset:3072 nt lds
    v_mfma_f32_16x16x32_bf16 v[204:207], v[120:123], a[76:79], v[204:207]
    s_add_u32 s92, s92, 32768
    v_mfma_f32_16x16x32_bf16 v[208:211], v[136:139], a[76:79], 0
    s_nop 0
    s_nop 0
    v_mfma_f32_16x16x32_bf16 v[208:211], v[132:135], a[72:75], v[208:211]
    s_nop 0
    s_nop 0
    v_mfma_f32_16x16x32_bf16 v[208:211], v[128:131], a[68:71], v[208:211]
    s_nop 0
    s_add_u32 m0, s37, 0
    v_mfma_f32_16x16x32_bf16 v[208:211], v[124:127], a[64:67], v[208:211]
    v_exp_f32_e64 v204, v204
    v_mfma_f32_16x16x32_bf16 v[196:199], v[108:111], a[80:83], 0
    v_exp_f32_e64 v205, v205
    v_mfma_f32_16x16x32_bf16 v[196:199], v[112:115], a[84:87], v[196:199]
    v_exp_f32_e64 v206, v206
    v_mfma_f32_16x16x32_bf16 v[196:199], v[116:119], a[88:91], v[196:199]
    v_exp_f32_e64 v207, v207
    buffer_load_dwordx4 v6, s[24:27], s92 offen nt lds
    v_mfma_f32_16x16x32_bf16 v[196:199], v[120:123], a[92:95], v[196:199]
    v_cvt_pk_bf16_f32 v224, v204, v205
    v_cvt_pk_bf16_f32 v225, v206, v207
    v_mfma_f32_16x16x32_bf16 v[200:203], v[136:139], a[92:95], 0
    v_exp_f32_e64 v208, v208
    v_mfma_f32_16x16x32_bf16 v[200:203], v[132:135], a[88:91], v[200:203]
    v_exp_f32_e64 v209, v209
    v_mfma_f32_16x16x32_bf16 v[200:203], v[128:131], a[84:87], v[200:203]
    v_exp_f32_e64 v210, v210
    v_mfma_f32_16x16x32_bf16 v[200:203], v[124:127], a[80:83], v[200:203]
    v_exp_f32_e64 v211, v211
    v_mfma_f32_16x16x32_bf16 v[212:215], v[108:111], a[96:99], 0
    v_cvt_pk_bf16_f32 v226, v208, v209
    v_cvt_pk_bf16_f32 v227, v210, v211
    v_mfma_f32_16x16x32_bf16 v[212:215], v[112:115], a[100:103], v[212:215]
    v_exp_f32_e64 v196, v196
    v_mfma_f32_16x16x32_bf16 v[212:215], v[116:119], a[104:107], v[212:215]
    v_exp_f32_e64 v197, v197
    buffer_load_dwordx4 v6, s[24:27], s92 offen offset:1024 nt lds
    v_mfma_f32_16x16x32_bf16 v[212:215], v[120:123], a[108:111], v[212:215]
    v_exp_f32_e64 v198, v198
    v_mfma_f32_16x16x32_bf16 v[216:219], v[136:139], a[108:111], 0
    v_exp_f32_e64 v199, v199
    v_mfma_f32_16x16x32_bf16 v[216:219], v[132:135], a[104:107], v[216:219]
    v_cvt_pk_bf16_f32 v232, v196, v197
    v_cvt_pk_bf16_f32 v233, v198, v199
    v_mfma_f32_16x16x32_bf16 v[216:219], v[128:131], a[100:103], v[216:219]
    v_exp_f32_e64 v200, v200
    v_mfma_f32_16x16x32_bf16 v[216:219], v[124:127], a[96:99], v[216:219]
    v_exp_f32 v201, v201
    v_mfma_f32_16x16x32_bf16 v[204:207], v[108:111], a[0:3], 0
    s_waitcnt vmcnt(10)
    ds_read_b64_tr_b16 v[140:141], v2
    v_mfma_f32_16x16x32_bf16 v[204:207], v[112:115], a[4:7], v[204:207]
    ds_read_b64_tr_b16 v[142:143], v2 offset:4096
    ds_read_b64_tr_b16 v[144:145], v2 offset:8
    v_mfma_f32_16x16x32_bf16 v[204:207], v[116:119], a[8:11], v[204:207]
    ds_read_b64_tr_b16 v[146:147], v2 offset:4104
    ds_read_b64_tr_b16 v[148:149], v2 offset:256
    buffer_load_dwordx4 v6, s[24:27], s92 offen offset:2048 nt lds
    v_mfma_f32_16x16x32_bf16 v[204:207], v[120:123], a[12:15], v[204:207]
    ds_read_b64_tr_b16 v[150:151], v2 offset:4352
    ds_read_b64_tr_b16 v[152:153], v2 offset:264
    v_mfma_f32_16x16x32_bf16 v[208:211], v[136:139], a[12:15], 0
    ds_read_b64_tr_b16 v[154:155], v2 offset:4360
    ds_read_b64_tr_b16 v[156:157], v2 offset:512
    v_mfma_f32_16x16x32_bf16 v[208:211], v[132:135], a[8:11], v[208:211]
    ds_read_b64_tr_b16 v[158:159], v2 offset:4608
    ds_read_b64_tr_b16 v[160:161], v2 offset:520
    v_mfma_f32_16x16x32_bf16 v[208:211], v[128:131], a[4:7], v[208:211]
    ds_read_b64_tr_b16 v[162:163], v2 offset:4616
    ds_read_b64_tr_b16 a[248:249], v2 offset:768
    v_mfma_f32_16x16x32_bf16 v[208:211], v[124:127], a[0:3], v[208:211]
    ds_read_b64_tr_b16 a[250:251], v2 offset:4864
    ds_read_b64_tr_b16 a[252:253], v2 offset:776
    v_mfma_f32_16x16x32_bf16 v[240:243], a[244:247], v[220:223], v[240:243]
    ds_read_b64_tr_b16 a[254:255], v2 offset:4872
    s_waitcnt lgkmcnt(8)
    v_mfma_f32_16x16x32_bf16 a[112:115], v[140:143], v[220:223], a[112:115]
    v_exp_f32 v202, v202
    v_mfma_f32_16x16x32_bf16 a[116:119], v[144:147], v[220:223], a[116:119]
    v_exp_f32_e64 v203, v203
    buffer_load_dwordx4 v6, s[24:27], s92 offen offset:3072 nt lds
    v_mfma_f32_16x16x32_bf16 a[120:123], v[148:151], v[220:223], a[120:123]
    v_cvt_pk_bf16_f32 v234, v200, v201
    v_cvt_pk_bf16_f32 v235, v202, v203
    v_mfma_f32_16x16x32_bf16 a[124:127], v[152:155], v[220:223], a[124:127]
    v_mov_b32 v243, 0
    s_waitcnt lgkmcnt(0)
    v_mfma_f32_16x16x32_bf16 a[128:131], v[156:159], v[220:223], a[128:131]
    v_exp_f32_e64 v212, v212
    v_mfma_f32_16x16x32_bf16 a[132:135], v[160:163], v[220:223], a[132:135]
    v_exp_f32_e64 v213, v213
    v_mfma_f32_16x16x32_bf16 a[136:139], a[248:251], v[220:223], a[136:139]
    v_exp_f32_e64 v214, v214
    s_add_u32 m0, s37, 4096
    v_mfma_f32_16x16x32_bf16 a[140:143], a[252:255], v[220:223], a[140:143]
    v_exp_f32_e64 v215, v215
    v_mfma_f32_16x16x32_bf16 v[196:199], v[108:111], a[16:19], 0
    v_exp_f32_e64 v216, v216
    v_mfma_f32_16x16x32_bf16 v[196:199], v[112:115], a[20:23], v[196:199]
    v_exp_f32_e64 v217, v217
    buffer_load_dwordx4 v6, s[28:31], s92 offen nt lds
    v_mfma_f32_16x16x32_bf16 v[196:199], v[116:119], a[24:27], v[196:199]
    v_exp_f32_e64 v218, v218
    v_mfma_f32_16x16x32_bf16 v[196:199], v[120:123], a[28:31], v[196:199]
    v_cvt_pk_bf16_f32 v228, v212, v213
    v_cvt_pk_bf16_f32 v229, v214, v215
    v_mfma_f32_16x16x32_bf16 v[200:203], v[136:139], a[28:31], 0
    v_exp_f32_e64 v219, v219
    v_mfma_f32_16x16x32_bf16 v[200:203], v[132:135], a[24:27], v[200:203]
    v_cvt_pk_bf16_f32 v230, v216, v217
    v_cvt_pk_bf16_f32 v231, v218, v219
    v_mfma_f32_16x16x32_bf16 v[200:203], v[128:131], a[20:23], v[200:203]
    v_exp_f32_e64 v204, v204
    v_mfma_f32_16x16x32_bf16 v[200:203], v[124:127], a[16:19], v[200:203]
    v_exp_f32_e64 v205, v205
    v_mfma_f32_16x16x32_bf16 v[244:247], a[244:247], v[224:227], v[244:247]
    v_exp_f32_e64 v206, v206
    v_mfma_f32_16x16x32_bf16 a[144:147], v[140:143], v[224:227], a[144:147]
    v_exp_f32_e64 v207, v207
    buffer_load_dwordx4 v6, s[28:31], s92 offen offset:1024 nt lds
    v_mfma_f32_16x16x32_bf16 a[148:151], v[144:147], v[224:227], a[148:151]
    v_cvt_pk_bf16_f32 v212, v204, v205
    v_cvt_pk_bf16_f32 v213, v206, v207
    v_mfma_f32_16x16x32_bf16 a[152:155], v[148:151], v[224:227], a[152:155]
    v_exp_f32_e64 v208, v208
    v_mfma_f32_16x16x32_bf16 a[156:159], v[152:155], v[224:227], a[156:159]
    v_mov_b32_e64 v247, 0
    v_xor_b32 v2, 0x2000, v2
    v_mfma_f32_16x16x32_bf16 a[160:163], v[156:159], v[224:227], a[160:163]
    v_exp_f32_e64 v209, v209
    v_mfma_f32_16x16x32_bf16 a[164:167], v[160:163], v[224:227], a[164:167]
    v_exp_f32_e64 v210, v210
    v_mfma_f32_16x16x32_bf16 a[168:171], a[248:251], v[224:227], a[168:171]
    v_exp_f32_e64 v211, v211
    v_mfma_f32_16x16x32_bf16 a[172:175], a[252:255], v[224:227], a[172:175]
    v_cvt_pk_bf16_f32 v214, v208, v209
    v_cvt_pk_bf16_f32 v215, v210, v211
    v_mfma_f32_16x16x32_bf16 v[252:255], a[240:243], v[228:231], v[252:255]
    v_exp_f32_e64 v196, v196
    buffer_load_dwordx4 v6, s[28:31], s92 offen offset:2048 nt lds
    v_mfma_f32_16x16x32_bf16 a[208:211], v[140:143], v[228:231], a[208:211]
    v_exp_f32_e64 v197, v197
    v_mfma_f32_16x16x32_bf16 a[212:215], v[144:147], v[228:231], a[212:215]
    v_exp_f32_e64 v198, v198
    v_mfma_f32_16x16x32_bf16 a[216:219], v[148:151], v[228:231], a[216:219]
    v_exp_f32_e64 v199, v199
    v_mfma_f32_16x16x32_bf16 a[220:223], v[152:155], v[228:231], a[220:223]
    v_cvt_pk_bf16_f32 v220, v196, v197
    v_cvt_pk_bf16_f32 v221, v198, v199
    v_mfma_f32_16x16x32_bf16 a[224:227], v[156:159], v[228:231], a[224:227]
    v_exp_f32_e64 v200, v200
    v_mfma_f32_16x16x32_bf16 a[228:231], v[160:163], v[228:231], a[228:231]
    v_exp_f32_e64 v201, v201
    v_mfma_f32_16x16x32_bf16 a[232:235], a[248:251], v[228:231], a[232:235]
    v_cvt_pk_bf16_f32 v222, v200, v201
    buffer_load_dwordx4 v6, s[28:31], s92 offen offset:3072 nt lds
    v_mfma_f32_16x16x32_bf16 a[236:239], a[252:255], v[228:231], a[236:239]
    v_exp_f32 v202, v202
    v_mfma_f32_16x16x32_bf16 v[204:207], v[108:111], a[32:35], 0
    s_barrier
    ds_read_b128 v[108:111], v1
    v_mfma_f32_16x16x32_bf16 v[204:207], v[112:115], a[36:39], v[204:207]
    ds_read_b128 v[112:115], v1 offset:256
    v_mfma_f32_16x16x32_bf16 v[204:207], v[116:119], a[40:43], v[204:207]
    ds_read_b128 v[116:119], v1 offset:512
    v_mfma_f32_16x16x32_bf16 v[204:207], v[120:123], a[44:47], v[204:207]
    ds_read_b128 v[120:123], v1 offset:768
    v_mfma_f32_16x16x32_bf16 v[208:211], v[136:139], a[44:47], 0
    ds_read_b128 v[136:139], v1 offset:4864
    s_add_u32 m0, s37, 32768
    v_mfma_f32_16x16x32_bf16 v[208:211], v[132:135], a[40:43], v[208:211]
    ds_read_b128 v[132:135], v1 offset:4608
    v_mfma_f32_16x16x32_bf16 v[208:211], v[128:131], a[36:39], v[208:211]
    ds_read_b128 v[128:131], v1 offset:4352
    v_mfma_f32_16x16x32_bf16 v[208:211], v[124:127], a[32:35], v[208:211]
    ds_read_b128 v[124:127], v1 offset:4096
    buffer_load_dwordx4 v6, s[16:19], s92 offen nt lds
    v_smfmac_f32_16x16x64_bf16 v[248:251], a[244:247], v[232:239], v5
    v_mfma_f32_16x16x32_bf16 a[176:179], v[164:167], v[236:239], a[176:179]
    ds_read_b64_tr_b16 v[164:165], v2
    ds_read_b64_tr_b16 v[166:167], v2 offset:4096
    v_mfma_f32_16x16x32_bf16 a[176:179], v[140:143], v[232:235], a[176:179]
    v_exp_f32_e64 v203, v203
    v_mfma_f32_16x16x32_bf16 a[180:183], v[168:171], v[236:239], a[180:183]
    ds_read_b64_tr_b16 v[168:169], v2 offset:8
    ds_read_b64_tr_b16 v[170:171], v2 offset:4104
    v_mfma_f32_16x16x32_bf16 a[180:183], v[144:147], v[232:235], a[180:183]
    v_cvt_pk_bf16_f32 v223, v202, v203
    buffer_load_dwordx4 v7, s[16:19], s92 offen offset:1024 nt lds
    v_mfma_f32_16x16x32_bf16 a[184:187], v[172:175], v[236:239], a[184:187]
    ds_read_b64_tr_b16 v[172:173], v2 offset:256
    ds_read_b64_tr_b16 v[174:175], v2 offset:4352
    v_mfma_f32_16x16x32_bf16 a[184:187], v[148:151], v[232:235], a[184:187]
    v_exp_f32_e64 v204, v204
    v_mfma_f32_16x16x32_bf16 a[188:191], v[176:179], v[236:239], a[188:191]
    ds_read_b64_tr_b16 v[176:177], v2 offset:264
    ds_read_b64_tr_b16 v[178:179], v2 offset:4360
    v_mfma_f32_16x16x32_bf16 a[188:191], v[152:155], v[232:235], a[188:191]
    v_exp_f32 v205, v205
    s_nop 0
    v_cvt_pk_bf16_f32 v228, v204, v205
    s_waitcnt lgkmcnt(8)
    v_mfma_f32_16x16x32_bf16 v[196:199], v[108:111], a[0:3], 0
    v_exp_f32 v206, v206
    v_mfma_f32_16x16x32_bf16 v[196:199], v[112:115], a[4:7], v[196:199]
    v_exp_f32_e64 v207, v207
    v_mfma_f32_16x16x32_bf16 v[196:199], v[116:119], a[8:11], v[196:199]
    v_cvt_pk_bf16_f32 v229, v206, v207
    v_mfma_f32_16x16x32_bf16 v[196:199], v[120:123], a[12:15], v[196:199]
    v_exp_f32_e64 v208, v208
    v_mfma_f32_16x16x32_bf16 v[200:203], v[136:139], a[12:15], 0
    v_exp_f32_e64 v209, v209
    v_mfma_f32_16x16x32_bf16 v[200:203], v[132:135], a[8:11], v[200:203]
    v_exp_f32_e64 v210, v210
    v_mfma_f32_16x16x32_bf16 v[200:203], v[128:131], a[4:7], v[200:203]
    v_exp_f32_e64 v211, v211
    buffer_load_dwordx4 v8, s[16:19], s92 offen offset:2048 nt lds
    v_mfma_f32_16x16x32_bf16 v[200:203], v[124:127], a[0:3], v[200:203]
    v_exp_f32_e64 v196, v196
    v_mfma_f32_16x16x32_bf16 a[192:195], v[180:183], v[236:239], a[192:195]
    ds_read_b64_tr_b16 v[180:181], v2 offset:512
    ds_read_b64_tr_b16 v[182:183], v2 offset:4608
    v_mfma_f32_16x16x32_bf16 a[192:195], v[156:159], v[232:235], a[192:195]
    v_exp_f32_e64 v197, v197
    v_mfma_f32_16x16x32_bf16 a[196:199], v[184:187], v[236:239], a[196:199]
    ds_read_b64_tr_b16 v[184:185], v2 offset:520
    ds_read_b64_tr_b16 v[186:187], v2 offset:4616
    v_mfma_f32_16x16x32_bf16 a[196:199], v[160:163], v[232:235], a[196:199]
    v_exp_f32_e64 v198, v198
    v_mfma_f32_16x16x32_bf16 a[200:203], v[188:191], v[236:239], a[200:203]
    ds_read_b64_tr_b16 v[188:189], v2 offset:768
    ds_read_b64_tr_b16 v[190:191], v2 offset:4864
    v_mfma_f32_16x16x32_bf16 a[200:203], a[248:251], v[232:235], a[200:203]
    v_exp_f32_e64 v199, v199
    v_mfma_f32_16x16x32_bf16 a[204:207], v[192:195], v[236:239], a[204:207]
    ds_read_b64_tr_b16 v[192:193], v2 offset:776
    ds_read_b64_tr_b16 v[194:195], v2 offset:4872
    v_mfma_f32_16x16x32_bf16 a[204:207], a[252:255], v[232:235], a[204:207]
    v_cvt_pk_bf16_f32 v230, v208, v209
    v_cvt_pk_bf16_f32 v231, v210, v211
    v_mfma_f32_16x16x32_bf16 v[204:207], v[108:111], a[16:19], 0
    v_exp_f32_e64 v200, v200
    v_mfma_f32_16x16x32_bf16 v[204:207], v[112:115], a[20:23], v[204:207]
    v_exp_f32_e64 v201, v201
    v_mfma_f32_16x16x32_bf16 v[204:207], v[116:119], a[24:27], v[204:207]
    v_exp_f32_e64 v202, v202
    v_mfma_f32_16x16x32_bf16 v[204:207], v[120:123], a[28:31], v[204:207]
    v_cvt_pk_bf16_f32 v216, v196, v197
    v_cvt_pk_bf16_f32 v217, v198, v199
    v_mfma_f32_16x16x32_bf16 v[208:211], v[136:139], a[28:31], 0
    v_exp_f32_e64 v203, v203
    v_mfma_f32_16x16x32_bf16 v[208:211], v[132:135], a[24:27], v[208:211]
    v_cvt_pk_bf16_f32 v218, v200, v201
    v_cvt_pk_bf16_f32 v219, v202, v203
    v_mfma_f32_16x16x32_bf16 v[208:211], v[128:131], a[20:23], v[208:211]
    buffer_load_dwordx4 v9, s[16:19], s92 offen offset:3072 nt lds
    v_mfma_f32_16x16x32_bf16 v[208:211], v[124:127], a[16:19], v[208:211]
    s_waitcnt lgkmcnt(0)
    s_barrier
    v_smfmac_f32_16x16x64_bf16 v[240:243], a[240:243], v[212:219], v5
    s_add_u32 m0, s37, 36864
    v_mfma_f32_16x16x32_bf16 v[12:15], v[140:143], v[212:215], v[12:15]
    buffer_load_dwordx4 v6, s[20:23], s92 offen nt lds
    v_mfma_f32_16x16x32_bf16 v[12:15], v[164:167], v[216:219], v[12:15]
    v_exp_f32_e64 v204, v204
    v_mfma_f32_16x16x32_bf16 v[16:19], v[144:147], v[212:215], v[16:19]
    v_exp_f32_e64 v205, v205
    v_mfma_f32_16x16x32_bf16 v[16:19], v[168:171], v[216:219], v[16:19]
    v_exp_f32_e64 v206, v206
    v_mfma_f32_16x16x32_bf16 v[20:23], v[148:151], v[212:215], v[20:23]
    v_mfma_f32_16x16x32_bf16 v[20:23], v[172:175], v[216:219], v[20:23]
    v_exp_f32_e64 v207, v207
    v_mfma_f32_16x16x32_bf16 v[24:27], v[152:155], v[212:215], v[24:27]
    v_cvt_pk_bf16_f32 v224, v204, v205
    v_cvt_pk_bf16_f32 v225, v206, v207
    v_mfma_f32_16x16x32_bf16 v[24:27], v[176:179], v[216:219], v[24:27]
    v_exp_f32_e64 v208, v208
    v_mfma_f32_16x16x32_bf16 v[196:199], v[108:111], a[32:35], 0
    buffer_load_dwordx4 v7, s[20:23], s92 offen offset:1024 nt lds
    v_mfma_f32_16x16x32_bf16 v[196:199], v[112:115], a[36:39], v[196:199]
    v_exp_f32_e64 v209, v209
    v_mfma_f32_16x16x32_bf16 v[196:199], v[116:119], a[40:43], v[196:199]
    v_exp_f32_e64 v210, v210
    v_mfma_f32_16x16x32_bf16 v[196:199], v[120:123], a[44:47], v[196:199]
    v_exp_f32_e64 v211, v211
    v_mfma_f32_16x16x32_bf16 v[200:203], v[136:139], a[44:47], 0
    v_mfma_f32_16x16x32_bf16 v[200:203], v[132:135], a[40:43], v[200:203]
    v_cvt_pk_bf16_f32 v226, v208, v209
    v_mfma_f32_16x16x32_bf16 v[200:203], v[128:131], a[36:39], v[200:203]
    v_cvt_pk_bf16_f32 v227, v210, v211
    s_add_u32 s93, s39, 32768
    v_mfma_f32_16x16x32_bf16 v[200:203], v[124:127], a[32:35], v[200:203]
    v_exp_f32_e64 v196, v196
    v_mfma_f32_16x16x32_bf16 v[28:31], v[156:159], v[212:215], v[28:31]
    buffer_load_dwordx4 v8, s[20:23], s92 offen offset:2048 nt lds
    v_mfma_f32_16x16x32_bf16 v[28:31], v[180:183], v[216:219], v[28:31]
    v_exp_f32_e64 v197, v197
    v_mfma_f32_16x16x32_bf16 v[32:35], v[160:163], v[212:215], v[32:35]
    v_exp_f32_e64 v198, v198
    v_mfma_f32_16x16x32_bf16 v[32:35], v[184:187], v[216:219], v[32:35]
    v_exp_f32_e64 v199, v199
    v_mfma_f32_16x16x32_bf16 v[36:39], a[248:251], v[212:215], v[36:39]
    v_mfma_f32_16x16x32_bf16 v[36:39], v[188:191], v[216:219], v[36:39]
    v_cvt_pk_bf16_f32 v232, v196, v197
    v_cvt_pk_bf16_f32 v233, v198, v199
    v_mfma_f32_16x16x32_bf16 v[40:43], a[252:255], v[212:215], v[40:43]
    v_exp_f32_e64 v200, v200
    v_mfma_f32_16x16x32_bf16 v[40:43], v[192:195], v[216:219], v[40:43]
    v_exp_f32_e64 v201, v201
    v_mfma_f32_16x16x32_bf16 v[204:207], v[108:111], a[48:51], 0
    buffer_load_dwordx4 v9, s[20:23], s92 offen offset:3072 nt lds
    v_mfma_f32_16x16x32_bf16 v[204:207], v[112:115], a[52:55], v[204:207]
    v_exp_f32_e64 v202, v202
    v_mfma_f32_16x16x32_bf16 v[204:207], v[116:119], a[56:59], v[204:207]
    v_exp_f32_e64 v203, v203
    v_mfma_f32_16x16x32_bf16 v[204:207], v[120:123], a[60:63], v[204:207]
    v_cvt_pk_bf16_f32 v234, v200, v201
    v_cvt_pk_bf16_f32 v235, v202, v203
    v_mfma_f32_16x16x32_bf16 v[208:211], v[136:139], a[60:63], 0
    s_add_u32 s92, s92, 32768
    v_mfma_f32_16x16x32_bf16 v[208:211], v[132:135], a[56:59], v[208:211]
    s_cmp_lt_u32 s93, 163840
    s_cselect_b32 s38, s93, s37
    v_mfma_f32_16x16x32_bf16 v[208:211], v[128:131], a[52:55], v[208:211]
    v_exp_f32 v204, v204
    v_mfma_f32_16x16x32_bf16 v[208:211], v[124:127], a[48:51], v[208:211]
    v_exp_f32_e64 v205, v205
    v_smfmac_f32_16x16x64_bf16 v[244:247], a[240:243], v[220:227], v5
    v_cvt_pk_bf16_f32 v212, v204, v205
    v_mfma_f32_16x16x32_bf16 v[44:47], v[140:143], v[220:223], v[44:47]
    v_exp_f32_e64 v206, v206
    v_mfma_f32_16x16x32_bf16 v[44:47], v[164:167], v[224:227], v[44:47]
    v_exp_f32_e64 v207, v207
    v_mfma_f32_16x16x32_bf16 v[48:51], v[144:147], v[220:223], v[48:51]
    v_cvt_pk_bf16_f32 v213, v206, v207
    s_add_u32 m0, s37, 65536
    v_mfma_f32_16x16x32_bf16 v[48:51], v[168:171], v[224:227], v[48:51]
    v_exp_f32_e64 v208, v208
    v_mfma_f32_16x16x32_bf16 v[52:55], v[148:151], v[220:223], v[52:55]
    v_exp_f32_e64 v209, v209
    v_mfma_f32_16x16x32_bf16 v[52:55], v[172:175], v[224:227], v[52:55]
    v_add_u32_e64 v1, s38, v3
    v_cvt_pk_bf16_f32 v214, v208, v209
    v_mfma_f32_16x16x32_bf16 v[56:59], v[152:155], v[220:223], v[56:59]
    v_exp_f32_e64 v210, v210
    v_mfma_f32_16x16x32_bf16 v[56:59], v[176:179], v[224:227], v[56:59]
    v_exp_f32_e64 v211, v211
    v_mfma_f32_16x16x32_bf16 v[196:199], v[108:111], a[64:67], 0
    v_cvt_pk_bf16_f32 v215, v210, v211
    s_add_u32 s93, s38, 32768
    v_mfma_f32_16x16x32_bf16 v[196:199], v[112:115], a[68:71], v[196:199]
    s_cmp_lt_u32 s93, 163840
    s_cselect_b32 s39, s93, s37
    v_mfma_f32_16x16x32_bf16 v[196:199], v[116:119], a[72:75], v[196:199]
    v_add_u32 v2, s39, v4
    v_mfma_f32_16x16x32_bf16 v[196:199], v[120:123], a[76:79], v[196:199]
    buffer_load_dwordx4 v6, s[24:27], s92 offen nt lds
    v_mfma_f32_16x16x32_bf16 v[200:203], v[136:139], a[76:79], 0
    s_nop 0
    s_nop 0
    v_mfma_f32_16x16x32_bf16 v[200:203], v[132:135], a[72:75], v[200:203]
    s_nop 0
    s_nop 0
    v_mfma_f32_16x16x32_bf16 v[200:203], v[128:131], a[68:71], v[200:203]
    buffer_load_dwordx4 v6, s[24:27], s92 offen offset:1024 nt lds
    v_mfma_f32_16x16x32_bf16 v[200:203], v[124:127], a[64:67], v[200:203]
    v_exp_f32_e64 v196, v196
    v_mfma_f32_16x16x32_bf16 v[60:63], v[156:159], v[220:223], v[60:63]
    v_exp_f32_e64 v197, v197
    v_mfma_f32_16x16x32_bf16 v[60:63], v[180:183], v[224:227], v[60:63]
    v_exp_f32_e64 v198, v198
    v_mfma_f32_16x16x32_bf16 v[64:67], v[160:163], v[220:223], v[64:67]
    v_exp_f32_e64 v199, v199
    v_mfma_f32_16x16x32_bf16 v[64:67], v[184:187], v[224:227], v[64:67]
    v_exp_f32_e64 v200, v200
    v_mfma_f32_16x16x32_bf16 v[68:71], a[248:251], v[220:223], v[68:71]
    v_exp_f32_e64 v201, v201
    v_mfma_f32_16x16x32_bf16 v[68:71], v[188:191], v[224:227], v[68:71]
    v_exp_f32_e64 v202, v202
    v_mfma_f32_16x16x32_bf16 v[72:75], a[252:255], v[220:223], v[72:75]
    v_cvt_pk_bf16_f32 v220, v196, v197
    v_cvt_pk_bf16_f32 v221, v198, v199
    v_mfma_f32_16x16x32_bf16 v[72:75], v[192:195], v[224:227], v[72:75]
    v_exp_f32 v203, v203
    v_mfma_f32_16x16x32_bf16 v[204:207], v[108:111], a[80:83], 0
    s_waitcnt vmcnt(18)
    ds_read_b128 v[108:111], v1
    v_cvt_pk_bf16_f32 v222, v200, v201
    v_mfma_f32_16x16x32_bf16 v[204:207], v[112:115], a[84:87], v[204:207]
    ds_read_b128 v[112:115], v1 offset:256
    v_cvt_pk_bf16_f32 v223, v202, v203
    v_mfma_f32_16x16x32_bf16 v[204:207], v[116:119], a[88:91], v[204:207]
    ds_read_b128 v[116:119], v1 offset:512
    buffer_load_dwordx4 v6, s[24:27], s92 offen offset:2048 nt lds
    v_mfma_f32_16x16x32_bf16 v[204:207], v[120:123], a[92:95], v[204:207]
    ds_read_b128 v[120:123], v1 offset:768
    v_mfma_f32_16x16x32_bf16 v[208:211], v[136:139], a[92:95], 0
    ds_read_b128 v[136:139], v1 offset:4864
    v_mfma_f32_16x16x32_bf16 v[208:211], v[132:135], a[88:91], v[208:211]
    ds_read_b128 v[132:135], v1 offset:4608
    v_mfma_f32_16x16x32_bf16 v[208:211], v[128:131], a[84:87], v[208:211]
    ds_read_b128 v[128:131], v1 offset:4352
    v_mfma_f32_16x16x32_bf16 v[208:211], v[124:127], a[80:83], v[208:211]
    ds_read_b128 v[124:127], v1 offset:4096
    v_smfmac_f32_16x16x64_bf16 v[248:251], a[240:243], v[228:235], v5
    v_mfma_f32_16x16x32_bf16 v[76:79], v[140:143], v[228:231], v[76:79]
    buffer_load_dwordx4 v6, s[24:27], s92 offen offset:3072 nt lds
    v_mfma_f32_16x16x32_bf16 v[76:79], v[164:167], v[232:235], v[76:79]
    s_waitcnt vmcnt(12)
    ds_read_b64_tr_b16 v[140:141], v2
    ds_read_b64_tr_b16 v[142:143], v2 offset:4096
    v_mfma_f32_16x16x32_bf16 v[80:83], v[144:147], v[228:231], v[80:83]
    v_exp_f32 v204, v204
    s_add_u32 m0, s37, 69632
    v_mfma_f32_16x16x32_bf16 v[80:83], v[168:171], v[232:235], v[80:83]
    v_exp_f32_e64 v205, v205
    v_mfma_f32_16x16x32_bf16 v[84:87], v[148:151], v[228:231], v[84:87]
    v_exp_f32_e64 v206, v206
    v_mfma_f32_16x16x32_bf16 v[84:87], v[172:175], v[232:235], v[84:87]
    v_exp_f32_e64 v207, v207
    v_mfma_f32_16x16x32_bf16 v[88:91], v[152:155], v[228:231], v[88:91]
    ds_read_b64_tr_b16 v[144:145], v2 offset:8
    ds_read_b64_tr_b16 v[146:147], v2 offset:4104
    v_mfma_f32_16x16x32_bf16 v[88:91], v[176:179], v[232:235], v[88:91]
    s_waitcnt lgkmcnt(4)
    v_mfma_f32_16x16x32_bf16 v[196:199], v[108:111], a[48:51], 0
    v_cvt_pk_bf16_f32 v236, v204, v205
    v_cvt_pk_bf16_f32 v237, v206, v207
    v_mfma_f32_16x16x32_bf16 v[196:199], v[112:115], a[52:55], v[196:199]
    v_exp_f32 v208, v208
    v_mfma_f32_16x16x32_bf16 v[196:199], v[116:119], a[56:59], v[196:199]
    v_exp_f32_e64 v209, v209
    v_mfma_f32_16x16x32_bf16 v[196:199], v[120:123], a[60:63], v[196:199]
    ds_read_b64_tr_b16 v[148:149], v2 offset:256
    ds_read_b64_tr_b16 v[150:151], v2 offset:4352
    v_mfma_f32_16x16x32_bf16 v[200:203], v[136:139], a[60:63], 0
    v_exp_f32_e64 v210, v210
    v_mfma_f32_16x16x32_bf16 v[200:203], v[132:135], a[56:59], v[200:203]
    buffer_load_dwordx4 v6, s[28:31], s92 offen nt lds
    v_mfma_f32_16x16x32_bf16 v[200:203], v[128:131], a[52:55], v[200:203]
    v_exp_f32_e64 v211, v211
    buffer_load_dwordx4 v6, s[28:31], s92 offen offset:1024 nt lds
    v_mfma_f32_16x16x32_bf16 v[200:203], v[124:127], a[48:51], v[200:203]
    v_exp_f32_e64 v196, v196
    v_mfma_f32_16x16x32_bf16 v[92:95], v[156:159], v[228:231], v[92:95]
    v_exp_f32_e64 v197, v197
    v_mfma_f32_16x16x32_bf16 v[92:95], v[180:183], v[232:235], v[92:95]
    v_exp_f32_e64 v198, v198
    v_mfma_f32_16x16x32_bf16 v[96:99], v[160:163], v[228:231], v[96:99]
    v_exp_f32_e64 v199, v199
    v_mfma_f32_16x16x32_bf16 v[96:99], v[184:187], v[232:235], v[96:99]
    ds_read_b64_tr_b16 v[152:153], v2 offset:264
    ds_read_b64_tr_b16 v[154:155], v2 offset:4360
    v_mfma_f32_16x16x32_bf16 v[100:103], a[248:251], v[228:231], v[100:103]
    v_cvt_pk_bf16_f32 v238, v208, v209
    v_cvt_pk_bf16_f32 v239, v210, v211
    v_mfma_f32_16x16x32_bf16 v[100:103], v[188:191], v[232:235], v[100:103]
    v_exp_f32_e64 v200, v200
    v_mfma_f32_16x16x32_bf16 v[104:107], a[252:255], v[228:231], v[104:107]
    v_exp_f32_e64 v201, v201
    v_mfma_f32_16x16x32_bf16 v[104:107], v[192:195], v[232:235], v[104:107]
    v_exp_f32_e64 v202, v202
    v_mfma_f32_16x16x32_bf16 v[204:207], v[108:111], a[64:67], 0
    v_cvt_pk_bf16_f32 v216, v196, v197
    v_cvt_pk_bf16_f32 v217, v198, v199
    v_mfma_f32_16x16x32_bf16 v[204:207], v[112:115], a[68:71], v[204:207]
    v_exp_f32 v203, v203
    v_mfma_f32_16x16x32_bf16 v[204:207], v[116:119], a[72:75], v[204:207]
    v_cvt_pk_bf16_f32 v218, v200, v201
    v_cvt_pk_bf16_f32 v219, v202, v203
    v_mfma_f32_16x16x32_bf16 v[204:207], v[120:123], a[76:79], v[204:207]
    ds_read_b64_tr_b16 v[156:157], v2 offset:512
    ds_read_b64_tr_b16 v[158:159], v2 offset:4608
    v_mfma_f32_16x16x32_bf16 v[208:211], v[136:139], a[76:79], 0
    v_xor_b32 v1, 0x2000, v1
    s_nop 0
    v_mfma_f32_16x16x32_bf16 v[208:211], v[132:135], a[72:75], v[208:211]
    buffer_load_dwordx4 v6, s[28:31], s92 offen offset:2048 nt lds
    v_mfma_f32_16x16x32_bf16 v[208:211], v[128:131], a[68:71], v[208:211]
    ds_read_b64_tr_b16 v[160:161], v2 offset:520
    ds_read_b64_tr_b16 v[162:163], v2 offset:4616
    buffer_load_dwordx4 v6, s[28:31], s92 offen offset:3072 nt lds
    v_mfma_f32_16x16x32_bf16 v[208:211], v[124:127], a[64:67], v[208:211]
    v_exp_f32 v204, v204
    v_smfmac_f32_16x16x64_bf16 v[240:243], a[244:247], v[212:219], v5
    s_waitcnt lgkmcnt(4)
    v_mfma_f32_16x16x32_bf16 a[112:115], v[164:167], v[212:215], a[112:115]
    ds_read_b64_tr_b16 a[248:249], v2 offset:768
    ds_read_b64_tr_b16 a[250:251], v2 offset:4864
    v_mfma_f32_16x16x32_bf16 a[112:115], v[140:143], v[216:219], a[112:115]
    v_exp_f32_e64 v205, v205
    v_mfma_f32_16x16x32_bf16 a[116:119], v[168:171], v[212:215], a[116:119]
    ds_read_b64_tr_b16 a[252:253], v2 offset:776
    ds_read_b64_tr_b16 a[254:255], v2 offset:4872
    v_mfma_f32_16x16x32_bf16 a[116:119], v[144:147], v[216:219], a[116:119]
    v_exp_f32_e64 v206, v206
    v_mfma_f32_16x16x32_bf16 a[120:123], v[172:175], v[212:215], a[120:123]
    v_exp_f32_e64 v207, v207
    v_mfma_f32_16x16x32_bf16 a[120:123], v[148:151], v[216:219], a[120:123]
    v_exp_f32_e64 v208, v208
    v_mfma_f32_16x16x32_bf16 a[124:127], v[176:179], v[212:215], a[124:127]
    v_exp_f32_e64 v209, v209
    v_mfma_f32_16x16x32_bf16 a[124:127], v[152:155], v[216:219], a[124:127]
    v_exp_f32_e64 v210, v210
    v_mfma_f32_16x16x32_bf16 v[196:199], v[108:111], a[80:83], 0
    v_cvt_pk_bf16_f32 v224, v204, v205
    v_cvt_pk_bf16_f32 v225, v206, v207
    v_mfma_f32_16x16x32_bf16 v[196:199], v[112:115], a[84:87], v[196:199]
    v_cvt_pk_bf16_f32 v226, v208, v209
    s_add_u32 m0, s37, 98304
    v_mfma_f32_16x16x32_bf16 v[196:199], v[116:119], a[88:91], v[196:199]
    v_exp_f32_e64 v211, v211
    v_mfma_f32_16x16x32_bf16 v[196:199], v[120:123], a[92:95], v[196:199]
    v_cvt_pk_bf16_f32 v227, v210, v211
    v_mfma_f32_16x16x32_bf16 v[200:203], v[136:139], a[92:95], 0
    buffer_load_dwordx4 v6, s[16:19], s92 offen nt lds
    v_mfma_f32_16x16x32_bf16 v[200:203], v[132:135], a[88:91], v[200:203]
    s_nop 0
    s_nop 0
    v_mfma_f32_16x16x32_bf16 v[200:203], v[128:131], a[84:87], v[200:203]
    s_nop 0
    v_mfma_f32_16x16x32_bf16 v[200:203], v[124:127], a[80:83], v[200:203]
    v_xor_b32 v2, 0x2000, v2
    s_waitcnt lgkmcnt(0)
    v_mfma_f32_16x16x32_bf16 a[128:131], v[180:183], v[212:215], a[128:131]
    v_exp_f32_e64 v196, v196
    v_mfma_f32_16x16x32_bf16 a[128:131], v[156:159], v[216:219], a[128:131]
    v_exp_f32_e64 v197, v197
    v_mfma_f32_16x16x32_bf16 a[132:135], v[184:187], v[212:215], a[132:135]
    v_exp_f32_e64 v198, v198
    v_mfma_f32_16x16x32_bf16 a[132:135], v[160:163], v[216:219], a[132:135]
    v_exp_f32_e64 v199, v199
    v_mfma_f32_16x16x32_bf16 a[136:139], v[188:191], v[212:215], a[136:139]
    v_cvt_pk_bf16_f32 v232, v196, v197
    v_cvt_pk_bf16_f32 v233, v198, v199
    v_mfma_f32_16x16x32_bf16 a[136:139], a[248:251], v[216:219], a[136:139]
    v_exp_f32_e64 v200, v200
    v_mfma_f32_16x16x32_bf16 a[140:143], v[192:195], v[212:215], a[140:143]
    v_exp_f32_e64 v201, v201
    v_mfma_f32_16x16x32_bf16 a[140:143], a[252:255], v[216:219], a[140:143]
    v_exp_f32_e64 v202, v202
    v_mfma_f32_16x16x32_bf16 v[212:215], v[108:111], a[96:99], 0
    v_exp_f32_e64 v203, v203
    v_mfma_f32_16x16x32_bf16 v[212:215], v[112:115], a[100:103], v[212:215]
    v_cvt_pk_bf16_f32 v234, v200, v201
    v_cvt_pk_bf16_f32 v235, v202, v203
    v_mfma_f32_16x16x32_bf16 v[212:215], v[116:119], a[104:107], v[212:215]
    buffer_load_dwordx4 v7, s[16:19], s92 offen offset:1024 nt lds
    v_mfma_f32_16x16x32_bf16 v[212:215], v[120:123], a[108:111], v[212:215]
    v_mfma_f32_16x16x32_bf16 v[216:219], v[136:139], a[108:111], 0
    buffer_load_dwordx4 v8, s[16:19], s92 offen offset:2048 nt lds
    v_mfma_f32_16x16x32_bf16 v[216:219], v[132:135], a[104:107], v[216:219]
    s_nop 0
    s_nop 0
    v_mfma_f32_16x16x32_bf16 v[216:219], v[128:131], a[100:103], v[216:219]
    s_nop 0
    s_nop 0
    v_mfma_f32_16x16x32_bf16 v[216:219], v[124:127], a[96:99], v[216:219]
    v_exp_f32_e64 v212, v212
    v_smfmac_f32_16x16x64_bf16 v[244:247], a[244:247], v[220:227], v5
    v_mfma_f32_16x16x32_bf16 a[144:147], v[164:167], v[220:223], a[144:147]
    v_exp_f32_e64 v213, v213
    v_mfma_f32_16x16x32_bf16 a[144:147], v[140:143], v[224:227], a[144:147]
    v_exp_f32_e64 v214, v214
    v_mfma_f32_16x16x32_bf16 a[148:151], v[168:171], v[220:223], a[148:151]
    v_exp_f32_e64 v215, v215
    v_mfma_f32_16x16x32_bf16 a[148:151], v[144:147], v[224:227], a[148:151]
    v_exp_f32_e64 v216, v216
    v_mfma_f32_16x16x32_bf16 a[152:155], v[172:175], v[220:223], a[152:155]
    v_exp_f32_e64 v217, v217
    v_mfma_f32_16x16x32_bf16 a[152:155], v[148:151], v[224:227], a[152:155]
    v_exp_f32_e64 v218, v218
    v_mfma_f32_16x16x32_bf16 a[156:159], v[176:179], v[220:223], a[156:159]
    v_cvt_pk_bf16_f32 v228, v212, v213
    v_cvt_pk_bf16_f32 v229, v214, v215
    v_mfma_f32_16x16x32_bf16 a[156:159], v[152:155], v[224:227], a[156:159]
    v_exp_f32_e64 v219, v219
    v_mfma_f32_16x16x32_bf16 v[204:207], v[108:111], a[0:3], 0
    v_cvt_pk_bf16_f32 v230, v216, v217
    v_cvt_pk_bf16_f32 v231, v218, v219
    v_mfma_f32_16x16x32_bf16 v[204:207], v[112:115], a[4:7], v[204:207]
    v_mfma_f32_16x16x32_bf16 v[204:207], v[116:119], a[8:11], v[204:207]
    v_mfma_f32_16x16x32_bf16 v[204:207], v[120:123], a[12:15], v[204:207]
    buffer_load_dwordx4 v9, s[16:19], s92 offen offset:3072 nt lds
    v_mfma_f32_16x16x32_bf16 v[208:211], v[136:139], a[12:15], 0
    s_nop 0
    s_nop 0
    v_mfma_f32_16x16x32_bf16 v[208:211], v[132:135], a[8:11], v[208:211]
    s_nop 0
    s_nop 0
    v_mfma_f32_16x16x32_bf16 v[208:211], v[128:131], a[4:7], v[208:211]
    v_exp_f32_e64 v204, v204
    v_mfma_f32_16x16x32_bf16 v[208:211], v[124:127], a[0:3], v[208:211]
    v_exp_f32_e64 v205, v205
    v_mfma_f32_16x16x32_bf16 v[252:255], a[240:243], v[228:231], v[252:255]
    v_exp_f32_e64 v206, v206
    v_mfma_f32_16x16x32_bf16 a[208:211], v[140:143], v[228:231], a[208:211]
    v_exp_f32_e64 v207, v207
    v_mfma_f32_16x16x32_bf16 a[212:215], v[144:147], v[228:231], a[212:215]
    v_cvt_pk_bf16_f32 v212, v204, v205
    v_cvt_pk_bf16_f32 v213, v206, v207
    v_mfma_f32_16x16x32_bf16 a[216:219], v[148:151], v[228:231], a[216:219]
    v_exp_f32_e64 v208, v208
    v_mfma_f32_16x16x32_bf16 a[220:223], v[152:155], v[228:231], a[220:223]
    v_exp_f32_e64 v209, v209
    v_mfma_f32_16x16x32_bf16 a[224:227], v[156:159], v[228:231], a[224:227]
    v_exp_f32_e64 v210, v210
    v_mfma_f32_16x16x32_bf16 a[228:231], v[160:163], v[228:231], a[228:231]
    v_exp_f32_e64 v211, v211
    v_mfma_f32_16x16x32_bf16 a[232:235], a[248:251], v[228:231], a[232:235]
    v_cvt_pk_bf16_f32 v214, v208, v209
    v_cvt_pk_bf16_f32 v215, v210, v211
    v_mfma_f32_16x16x32_bf16 a[236:239], a[252:255], v[228:231], a[236:239]
    s_add_u32 m0, s37, 102400
    v_mfma_f32_16x16x32_bf16 v[196:199], v[108:111], a[16:19], 0
    buffer_load_dwordx4 v6, s[20:23], s92 offen nt lds
    v_mfma_f32_16x16x32_bf16 v[196:199], v[112:115], a[20:23], v[196:199]
    v_mfma_f32_16x16x32_bf16 v[196:199], v[116:119], a[24:27], v[196:199]
    v_mfma_f32_16x16x32_bf16 v[196:199], v[120:123], a[28:31], v[196:199]
    buffer_load_dwordx4 v7, s[20:23], s92 offen offset:1024 nt lds
    v_mfma_f32_16x16x32_bf16 v[200:203], v[136:139], a[28:31], 0
    s_nop 0
    s_nop 0
    v_mfma_f32_16x16x32_bf16 v[200:203], v[132:135], a[24:27], v[200:203]
    s_nop 0
    s_nop 0
    v_mfma_f32_16x16x32_bf16 v[200:203], v[128:131], a[20:23], v[200:203]
    v_exp_f32_e64 v196, v196
    v_mfma_f32_16x16x32_bf16 v[200:203], v[124:127], a[16:19], v[200:203]
    v_exp_f32_e64 v197, v197
    v_mfma_f32_16x16x32_bf16 a[160:163], v[180:183], v[220:223], a[160:163]
    v_exp_f32_e64 v198, v198
    v_mfma_f32_16x16x32_bf16 a[160:163], v[156:159], v[224:227], a[160:163]
    v_exp_f32_e64 v199, v199
    v_mfma_f32_16x16x32_bf16 a[164:167], v[184:187], v[220:223], a[164:167]
    s_nop 0
    s_nop 0
    v_mfma_f32_16x16x32_bf16 a[164:167], v[160:163], v[224:227], a[164:167]
    v_exp_f32_e64 v200, v200
    v_mfma_f32_16x16x32_bf16 a[168:171], v[188:191], v[220:223], a[168:171]
    v_exp_f32_e64 v201, v201
    v_mfma_f32_16x16x32_bf16 a[168:171], a[248:251], v[224:227], a[168:171]
    v_exp_f32_e64 v202, v202
    v_mfma_f32_16x16x32_bf16 a[172:175], v[192:195], v[220:223], a[172:175]
    v_cvt_pk_bf16_f32 v220, v196, v197
    v_cvt_pk_bf16_f32 v221, v198, v199
    v_mfma_f32_16x16x32_bf16 a[172:175], a[252:255], v[224:227], a[172:175]
    v_exp_f32 v203, v203
    v_mfma_f32_16x16x32_bf16 v[204:207], v[108:111], a[32:35], 0
    s_barrier
    ds_read_b128 v[108:111], v1
    v_cvt_pk_bf16_f32 v222, v200, v201
    v_mfma_f32_16x16x32_bf16 v[204:207], v[112:115], a[36:39], v[204:207]
    ds_read_b128 v[112:115], v1 offset:256
    v_cvt_pk_bf16_f32 v223, v202, v203
    v_mfma_f32_16x16x32_bf16 v[204:207], v[116:119], a[40:43], v[204:207]
    ds_read_b128 v[116:119], v1 offset:512
    v_mfma_f32_16x16x32_bf16 v[204:207], v[120:123], a[44:47], v[204:207]
    ds_read_b128 v[120:123], v1 offset:768
    v_mfma_f32_16x16x32_bf16 v[208:211], v[136:139], a[44:47], 0
    ds_read_b128 v[136:139], v1 offset:4864
    v_mfma_f32_16x16x32_bf16 v[208:211], v[132:135], a[40:43], v[208:211]
    ds_read_b128 v[132:135], v1 offset:4608
    v_mfma_f32_16x16x32_bf16 v[208:211], v[128:131], a[36:39], v[208:211]
    ds_read_b128 v[128:131], v1 offset:4352
    v_mfma_f32_16x16x32_bf16 v[208:211], v[124:127], a[32:35], v[208:211]
    ds_read_b128 v[124:127], v1 offset:4096
    v_smfmac_f32_16x16x64_bf16 v[248:251], a[244:247], v[232:239], v5
    v_mfma_f32_16x16x32_bf16 a[176:179], v[164:167], v[236:239], a[176:179]
    ds_read_b64_tr_b16 v[164:165], v2
    ds_read_b64_tr_b16 v[166:167], v2 offset:4096
    v_mfma_f32_16x16x32_bf16 a[176:179], v[140:143], v[232:235], a[176:179]
    buffer_load_dwordx4 v8, s[20:23], s92 offen offset:2048 nt lds
    v_mfma_f32_16x16x32_bf16 a[180:183], v[168:171], v[236:239], a[180:183]
    ds_read_b64_tr_b16 v[168:169], v2 offset:8
    ds_read_b64_tr_b16 v[170:171], v2 offset:4104
    v_mfma_f32_16x16x32_bf16 a[180:183], v[144:147], v[232:235], a[180:183]
    v_exp_f32_e64 v204, v204
    v_mfma_f32_16x16x32_bf16 a[184:187], v[172:175], v[236:239], a[184:187]
    ds_read_b64_tr_b16 v[172:173], v2 offset:256
    ds_read_b64_tr_b16 v[174:175], v2 offset:4352
    v_mfma_f32_16x16x32_bf16 a[184:187], v[148:151], v[232:235], a[184:187]
    v_exp_f32_e64 v205, v205
    v_mfma_f32_16x16x32_bf16 a[188:191], v[176:179], v[236:239], a[188:191]
    ds_read_b64_tr_b16 v[176:177], v2 offset:264
    ds_read_b64_tr_b16 v[178:179], v2 offset:4360
    v_mfma_f32_16x16x32_bf16 a[188:191], v[152:155], v[232:235], a[188:191]
    v_cvt_pk_bf16_f32 v228, v204, v205
    s_waitcnt lgkmcnt(8)
    v_mfma_f32_16x16x32_bf16 v[196:199], v[108:111], a[0:3], 0
    v_exp_f32 v206, v206
    v_mfma_f32_16x16x32_bf16 v[196:199], v[112:115], a[4:7], v[196:199]
    v_exp_f32_e64 v207, v207
    v_mfma_f32_16x16x32_bf16 v[196:199], v[116:119], a[8:11], v[196:199]
    v_cvt_pk_bf16_f32 v229, v206, v207
    buffer_load_dwordx4 v9, s[20:23], s92 offen offset:3072 nt lds
    v_mfma_f32_16x16x32_bf16 v[196:199], v[120:123], a[12:15], v[196:199]
    v_exp_f32_e64 v208, v208
    s_add_u32 s92, s92, 32768
    v_mfma_f32_16x16x32_bf16 v[200:203], v[136:139], a[12:15], 0
    v_exp_f32 v209, v209
    s_mov_b32 m0, s38
    v_mfma_f32_16x16x32_bf16 v[200:203], v[132:135], a[8:11], v[200:203]
    v_exp_f32_e64 v210, v210
    v_mfma_f32_16x16x32_bf16 v[200:203], v[128:131], a[4:7], v[200:203]
    v_exp_f32_e64 v211, v211
    v_mfma_f32_16x16x32_bf16 v[200:203], v[124:127], a[0:3], v[200:203]
    v_exp_f32_e64 v196, v196
    v_mfma_f32_16x16x32_bf16 a[192:195], v[180:183], v[236:239], a[192:195]
    ds_read_b64_tr_b16 v[180:181], v2 offset:512
    ds_read_b64_tr_b16 v[182:183], v2 offset:4608
    v_mfma_f32_16x16x32_bf16 a[192:195], v[156:159], v[232:235], a[192:195]
    v_exp_f32_e64 v197, v197
    v_mfma_f32_16x16x32_bf16 a[196:199], v[184:187], v[236:239], a[196:199]
    ds_read_b64_tr_b16 v[184:185], v2 offset:520
    ds_read_b64_tr_b16 v[186:187], v2 offset:4616
    v_mfma_f32_16x16x32_bf16 a[196:199], v[160:163], v[232:235], a[196:199]
    v_exp_f32_e64 v198, v198
    v_mfma_f32_16x16x32_bf16 a[200:203], v[188:191], v[236:239], a[200:203]
    ds_read_b64_tr_b16 v[188:189], v2 offset:768
    ds_read_b64_tr_b16 v[190:191], v2 offset:4864
    v_mfma_f32_16x16x32_bf16 a[200:203], a[248:251], v[232:235], a[200:203]
    v_exp_f32_e64 v199, v199
    v_mfma_f32_16x16x32_bf16 a[204:207], v[192:195], v[236:239], a[204:207]
    ds_read_b64_tr_b16 v[192:193], v2 offset:776
    ds_read_b64_tr_b16 v[194:195], v2 offset:4872
    v_mfma_f32_16x16x32_bf16 a[204:207], a[252:255], v[232:235], a[204:207]
    v_cvt_pk_bf16_f32 v230, v208, v209
    v_cvt_pk_bf16_f32 v231, v210, v211
    v_mfma_f32_16x16x32_bf16 v[204:207], v[108:111], a[16:19], 0
    v_exp_f32_e64 v200, v200
    v_mfma_f32_16x16x32_bf16 v[204:207], v[112:115], a[20:23], v[204:207]
    v_exp_f32_e64 v201, v201
    v_mfma_f32_16x16x32_bf16 v[204:207], v[116:119], a[24:27], v[204:207]
    v_exp_f32_e64 v202, v202
    v_mfma_f32_16x16x32_bf16 v[204:207], v[120:123], a[28:31], v[204:207]
    v_cvt_pk_bf16_f32 v216, v196, v197
    v_cvt_pk_bf16_f32 v217, v198, v199
    v_mfma_f32_16x16x32_bf16 v[208:211], v[136:139], a[28:31], 0
    v_exp_f32_e64 v203, v203
    v_mfma_f32_16x16x32_bf16 v[208:211], v[132:135], a[24:27], v[208:211]
    v_cvt_pk_bf16_f32 v218, v200, v201
    v_cvt_pk_bf16_f32 v219, v202, v203
    v_mfma_f32_16x16x32_bf16 v[208:211], v[128:131], a[20:23], v[208:211]
    v_mfma_f32_16x16x32_bf16 v[208:211], v[124:127], a[16:19], v[208:211]
    s_waitcnt vmcnt(8) lgkmcnt(0)
    s_barrier
    v_smfmac_f32_16x16x64_bf16 v[240:243], a[240:243], v[212:219], v5
    v_mfma_f32_16x16x32_bf16 v[12:15], v[140:143], v[212:215], v[12:15]
    buffer_load_dwordx4 v6, s[24:27], s92 offen nt lds
    v_mfma_f32_16x16x32_bf16 v[12:15], v[164:167], v[216:219], v[12:15]
    v_exp_f32_e64 v204, v204
    v_mfma_f32_16x16x32_bf16 v[16:19], v[144:147], v[212:215], v[16:19]
    v_exp_f32_e64 v205, v205
    v_mfma_f32_16x16x32_bf16 v[16:19], v[168:171], v[216:219], v[16:19]
    v_exp_f32_e64 v206, v206
    v_mfma_f32_16x16x32_bf16 v[20:23], v[148:151], v[212:215], v[20:23]
    buffer_load_dwordx4 v6, s[24:27], s92 offen offset:1024 nt lds
    v_mfma_f32_16x16x32_bf16 v[20:23], v[172:175], v[216:219], v[20:23]
    v_exp_f32_e64 v207, v207
    v_mfma_f32_16x16x32_bf16 v[24:27], v[152:155], v[212:215], v[24:27]
    v_cvt_pk_bf16_f32 v224, v204, v205
    v_cvt_pk_bf16_f32 v225, v206, v207
    v_mfma_f32_16x16x32_bf16 v[24:27], v[176:179], v[216:219], v[24:27]
    v_exp_f32_e64 v208, v208
    v_mfma_f32_16x16x32_bf16 v[196:199], v[108:111], a[32:35], 0
    buffer_load_dwordx4 v6, s[24:27], s92 offen offset:2048 nt lds
    v_mfma_f32_16x16x32_bf16 v[196:199], v[112:115], a[36:39], v[196:199]
    v_exp_f32_e64 v209, v209
    v_mfma_f32_16x16x32_bf16 v[196:199], v[116:119], a[40:43], v[196:199]
    v_exp_f32_e64 v210, v210
    v_mfma_f32_16x16x32_bf16 v[196:199], v[120:123], a[44:47], v[196:199]
    v_exp_f32_e64 v211, v211
    v_mfma_f32_16x16x32_bf16 v[200:203], v[136:139], a[44:47], 0
    buffer_load_dwordx4 v6, s[24:27], s92 offen offset:3072 nt lds
    v_mfma_f32_16x16x32_bf16 v[200:203], v[132:135], a[40:43], v[200:203]
    s_add_u32 m0, m0, 4096
    v_cvt_pk_bf16_f32 v226, v208, v209
    v_mfma_f32_16x16x32_bf16 v[200:203], v[128:131], a[36:39], v[200:203]
    v_cvt_pk_bf16_f32 v227, v210, v211
    s_add_u32 s93, s39, 32768
    v_mfma_f32_16x16x32_bf16 v[200:203], v[124:127], a[32:35], v[200:203]
    v_exp_f32_e64 v196, v196
    v_mfma_f32_16x16x32_bf16 v[28:31], v[156:159], v[212:215], v[28:31]
    buffer_load_dwordx4 v6, s[28:31], s92 offen nt lds
    v_mfma_f32_16x16x32_bf16 v[28:31], v[180:183], v[216:219], v[28:31]
    v_exp_f32_e64 v197, v197
    v_mfma_f32_16x16x32_bf16 v[32:35], v[160:163], v[212:215], v[32:35]
    v_exp_f32_e64 v198, v198
    v_mfma_f32_16x16x32_bf16 v[32:35], v[184:187], v[216:219], v[32:35]
    v_exp_f32_e64 v199, v199
    v_mfma_f32_16x16x32_bf16 v[36:39], a[248:251], v[212:215], v[36:39]
    buffer_load_dwordx4 v6, s[28:31], s92 offen offset:1024 nt lds
    v_mfma_f32_16x16x32_bf16 v[36:39], v[188:191], v[216:219], v[36:39]
    v_cvt_pk_bf16_f32 v232, v196, v197
    v_cvt_pk_bf16_f32 v233, v198, v199
    v_mfma_f32_16x16x32_bf16 v[40:43], a[252:255], v[212:215], v[40:43]
    v_exp_f32_e64 v200, v200
    v_mfma_f32_16x16x32_bf16 v[40:43], v[192:195], v[216:219], v[40:43]
    v_exp_f32_e64 v201, v201
    v_mfma_f32_16x16x32_bf16 v[204:207], v[108:111], a[48:51], 0
    buffer_load_dwordx4 v6, s[28:31], s92 offen offset:2048 nt lds
    v_mfma_f32_16x16x32_bf16 v[204:207], v[112:115], a[52:55], v[204:207]
    v_exp_f32_e64 v202, v202
    v_mfma_f32_16x16x32_bf16 v[204:207], v[116:119], a[56:59], v[204:207]
    v_exp_f32_e64 v203, v203
    v_mfma_f32_16x16x32_bf16 v[204:207], v[120:123], a[60:63], v[204:207]
    v_cvt_pk_bf16_f32 v234, v200, v201
    v_cvt_pk_bf16_f32 v235, v202, v203
    v_mfma_f32_16x16x32_bf16 v[208:211], v[136:139], a[60:63], 0
    buffer_load_dwordx4 v6, s[28:31], s92 offen offset:3072 nt lds
    v_mfma_f32_16x16x32_bf16 v[208:211], v[132:135], a[56:59], v[208:211]
    s_cmp_lt_u32 s93, 163840
    s_cselect_b32 s38, s93, s37
    v_mfma_f32_16x16x32_bf16 v[208:211], v[128:131], a[52:55], v[208:211]
    v_exp_f32 v204, v204
    v_mfma_f32_16x16x32_bf16 v[208:211], v[124:127], a[48:51], v[208:211]
    v_exp_f32_e64 v205, v205
    v_smfmac_f32_16x16x64_bf16 v[244:247], a[240:243], v[220:227], v5
    v_cvt_pk_bf16_f32 v212, v204, v205
    v_mfma_f32_16x16x32_bf16 v[44:47], v[140:143], v[220:223], v[44:47]
    v_exp_f32_e64 v206, v206
    v_mfma_f32_16x16x32_bf16 v[44:47], v[164:167], v[224:227], v[44:47]
    v_exp_f32_e64 v207, v207
    v_mfma_f32_16x16x32_bf16 v[48:51], v[144:147], v[220:223], v[48:51]
    v_cvt_pk_bf16_f32 v213, v206, v207
    s_and_b32 m0, s39, 0x7fffffff
    v_mfma_f32_16x16x32_bf16 v[48:51], v[168:171], v[224:227], v[48:51]
    v_exp_f32_e64 v208, v208
    v_mfma_f32_16x16x32_bf16 v[52:55], v[148:151], v[220:223], v[52:55]
    v_exp_f32_e64 v209, v209
    v_mfma_f32_16x16x32_bf16 v[52:55], v[172:175], v[224:227], v[52:55]
    v_add_u32_e64 v1, s38, v3
    v_cvt_pk_bf16_f32 v214, v208, v209
    v_mfma_f32_16x16x32_bf16 v[56:59], v[152:155], v[220:223], v[56:59]
    v_exp_f32_e64 v210, v210
    v_mfma_f32_16x16x32_bf16 v[56:59], v[176:179], v[224:227], v[56:59]
    v_exp_f32_e64 v211, v211
    v_mfma_f32_16x16x32_bf16 v[196:199], v[108:111], a[64:67], 0
    v_cvt_pk_bf16_f32 v215, v210, v211
    s_add_u32 s93, s38, 32768
    v_mfma_f32_16x16x32_bf16 v[196:199], v[112:115], a[68:71], v[196:199]
    s_cmp_lt_u32 s93, 163840
    s_cselect_b32 s39, s93, s37
    v_mfma_f32_16x16x32_bf16 v[196:199], v[116:119], a[72:75], v[196:199]
    v_add_u32 v2, s39, v4
    v_mfma_f32_16x16x32_bf16 v[196:199], v[120:123], a[76:79], v[196:199]
    v_mfma_f32_16x16x32_bf16 v[200:203], v[136:139], a[76:79], 0
    s_nop 0
    s_nop 0
    v_mfma_f32_16x16x32_bf16 v[200:203], v[132:135], a[72:75], v[200:203]
    s_nop 0
    s_nop 0
    v_mfma_f32_16x16x32_bf16 v[200:203], v[128:131], a[68:71], v[200:203]
    buffer_load_dwordx4 v6, s[16:19], s92 offen nt lds
    v_mfma_f32_16x16x32_bf16 v[200:203], v[124:127], a[64:67], v[200:203]
    v_exp_f32_e64 v196, v196
    v_mfma_f32_16x16x32_bf16 v[60:63], v[156:159], v[220:223], v[60:63]
    v_exp_f32_e64 v197, v197
    v_mfma_f32_16x16x32_bf16 v[60:63], v[180:183], v[224:227], v[60:63]
    v_exp_f32_e64 v198, v198
    v_mfma_f32_16x16x32_bf16 v[64:67], v[160:163], v[220:223], v[64:67]
    v_exp_f32_e64 v199, v199
    v_mfma_f32_16x16x32_bf16 v[64:67], v[184:187], v[224:227], v[64:67]
    v_exp_f32_e64 v200, v200
    v_mfma_f32_16x16x32_bf16 v[68:71], a[248:251], v[220:223], v[68:71]
    v_exp_f32_e64 v201, v201
    v_mfma_f32_16x16x32_bf16 v[68:71], v[188:191], v[224:227], v[68:71]
    v_exp_f32_e64 v202, v202
    v_mfma_f32_16x16x32_bf16 v[72:75], a[252:255], v[220:223], v[72:75]
    v_cvt_pk_bf16_f32 v220, v196, v197
    v_cvt_pk_bf16_f32 v221, v198, v199
    v_mfma_f32_16x16x32_bf16 v[72:75], v[192:195], v[224:227], v[72:75]
    v_exp_f32_e64 v203, v203
    v_mfma_f32_16x16x32_bf16 v[204:207], v[108:111], a[80:83], 0
    ds_read_b128 v[108:111], v1
    v_cvt_pk_bf16_f32 v222, v200, v201
    v_mfma_f32_16x16x32_bf16 v[204:207], v[112:115], a[84:87], v[204:207]
    ds_read_b128 v[112:115], v1 offset:256
    v_cvt_pk_bf16_f32 v223, v202, v203
    v_mfma_f32_16x16x32_bf16 v[204:207], v[116:119], a[88:91], v[204:207]
    ds_read_b128 v[116:119], v1 offset:512
    v_mfma_f32_16x16x32_bf16 v[204:207], v[120:123], a[92:95], v[204:207]
    ds_read_b128 v[120:123], v1 offset:768
    v_mfma_f32_16x16x32_bf16 v[208:211], v[136:139], a[92:95], 0
    ds_read_b128 v[136:139], v1 offset:4864
    v_mfma_f32_16x16x32_bf16 v[208:211], v[132:135], a[88:91], v[208:211]
    ds_read_b128 v[132:135], v1 offset:4608
    v_mfma_f32_16x16x32_bf16 v[208:211], v[128:131], a[84:87], v[208:211]
    ds_read_b128 v[128:131], v1 offset:4352
    v_mfma_f32_16x16x32_bf16 v[208:211], v[124:127], a[80:83], v[208:211]
    ds_read_b128 v[124:127], v1 offset:4096
    v_smfmac_f32_16x16x64_bf16 v[248:251], a[240:243], v[228:235], v5
    v_mfma_f32_16x16x32_bf16 v[76:79], v[140:143], v[228:231], v[76:79]
    buffer_load_dwordx4 v7, s[16:19], s92 offen offset:1024 nt lds
    v_mfma_f32_16x16x32_bf16 v[76:79], v[164:167], v[232:235], v[76:79]
    ds_read_b64_tr_b16 v[140:141], v2
    ds_read_b64_tr_b16 v[142:143], v2 offset:4096
    v_mfma_f32_16x16x32_bf16 v[80:83], v[144:147], v[228:231], v[80:83]
    v_exp_f32_e64 v204, v204
    v_mfma_f32_16x16x32_bf16 v[80:83], v[168:171], v[232:235], v[80:83]
    v_exp_f32_e64 v205, v205
    v_mfma_f32_16x16x32_bf16 v[84:87], v[148:151], v[228:231], v[84:87]
    v_exp_f32_e64 v206, v206
    v_mfma_f32_16x16x32_bf16 v[84:87], v[172:175], v[232:235], v[84:87]
    v_exp_f32_e64 v207, v207
    v_mfma_f32_16x16x32_bf16 v[88:91], v[152:155], v[228:231], v[88:91]
    ds_read_b64_tr_b16 v[144:145], v2 offset:8
    ds_read_b64_tr_b16 v[146:147], v2 offset:4104
    v_mfma_f32_16x16x32_bf16 v[88:91], v[176:179], v[232:235], v[88:91]
L_loop:
    s_waitcnt lgkmcnt(4)
    v_mfma_f32_16x16x32_bf16 v[196:199], v[108:111], a[48:51], 0
    v_cvt_pk_bf16_f32 v236, v204, v205
    v_cvt_pk_bf16_f32 v237, v206, v207
    v_mfma_f32_16x16x32_bf16 v[196:199], v[112:115], a[52:55], v[196:199]
    v_exp_f32 v208, v208
    v_mfma_f32_16x16x32_bf16 v[196:199], v[116:119], a[56:59], v[196:199]
    v_exp_f32_e64 v209, v209
    v_mfma_f32_16x16x32_bf16 v[196:199], v[120:123], a[60:63], v[196:199]
    ds_read_b64_tr_b16 v[148:149], v2 offset:256
    ds_read_b64_tr_b16 v[150:151], v2 offset:4352
    v_mfma_f32_16x16x32_bf16 v[200:203], v[136:139], a[60:63], 0
    v_exp_f32_e64 v210, v210
    v_mfma_f32_16x16x32_bf16 v[200:203], v[132:135], a[56:59], v[200:203]
    buffer_load_dwordx4 v8, s[16:19], s92 offen offset:2048 nt lds
    v_mfma_f32_16x16x32_bf16 v[200:203], v[128:131], a[52:55], v[200:203]
    v_exp_f32_e64 v211, v211
    v_mfma_f32_16x16x32_bf16 v[200:203], v[124:127], a[48:51], v[200:203]
    v_exp_f32_e64 v196, v196
    v_mfma_f32_16x16x32_bf16 v[92:95], v[156:159], v[228:231], v[92:95]
    v_exp_f32_e64 v197, v197
    v_mfma_f32_16x16x32_bf16 v[92:95], v[180:183], v[232:235], v[92:95]
    v_exp_f32_e64 v198, v198
    v_mfma_f32_16x16x32_bf16 v[96:99], v[160:163], v[228:231], v[96:99]
    v_exp_f32_e64 v199, v199
    v_mfma_f32_16x16x32_bf16 v[96:99], v[184:187], v[232:235], v[96:99]
    ds_read_b64_tr_b16 v[152:153], v2 offset:264
    ds_read_b64_tr_b16 v[154:155], v2 offset:4360
    v_mfma_f32_16x16x32_bf16 v[100:103], a[248:251], v[228:231], v[100:103]
    v_cvt_pk_bf16_f32 v238, v208, v209
    v_cvt_pk_bf16_f32 v239, v210, v211
    v_mfma_f32_16x16x32_bf16 v[100:103], v[188:191], v[232:235], v[100:103]
    v_exp_f32_e64 v200, v200
    v_mfma_f32_16x16x32_bf16 v[104:107], a[252:255], v[228:231], v[104:107]
    v_exp_f32_e64 v201, v201
    v_mfma_f32_16x16x32_bf16 v[104:107], v[192:195], v[232:235], v[104:107]
    v_exp_f32_e64 v202, v202
    v_mfma_f32_16x16x32_bf16 v[204:207], v[108:111], a[64:67], 0
    v_cvt_pk_bf16_f32 v216, v196, v197
    v_cvt_pk_bf16_f32 v217, v198, v199
    v_mfma_f32_16x16x32_bf16 v[204:207], v[112:115], a[68:71], v[204:207]
    v_exp_f32_e64 v203, v203
    v_mfma_f32_16x16x32_bf16 v[204:207], v[116:119], a[72:75], v[204:207]
    v_cvt_pk_bf16_f32 v218, v200, v201
    v_cvt_pk_bf16_f32 v219, v202, v203
    v_mfma_f32_16x16x32_bf16 v[204:207], v[120:123], a[76:79], v[204:207]
    ds_read_b64_tr_b16 v[156:157], v2 offset:512
    ds_read_b64_tr_b16 v[158:159], v2 offset:4608
    v_mfma_f32_16x16x32_bf16 v[208:211], v[136:139], a[76:79], 0
    v_xor_b32 v1, 0x2000, v1
    s_nop 0
    v_mfma_f32_16x16x32_bf16 v[208:211], v[132:135], a[72:75], v[208:211]
    buffer_load_dwordx4 v9, s[16:19], s92 offen offset:3072 nt lds
    v_mfma_f32_16x16x32_bf16 v[208:211], v[128:131], a[68:71], v[208:211]
    ds_read_b64_tr_b16 v[160:161], v2 offset:520
    ds_read_b64_tr_b16 v[162:163], v2 offset:4616
    v_mfma_f32_16x16x32_bf16 v[208:211], v[124:127], a[64:67], v[208:211]
    v_exp_f32_e64 v204, v204
    v_smfmac_f32_16x16x64_bf16 v[240:243], a[244:247], v[212:219], v5
    s_waitcnt lgkmcnt(4)
    v_mfma_f32_16x16x32_bf16 a[112:115], v[164:167], v[212:215], a[112:115]
    ds_read_b64_tr_b16 a[248:249], v2 offset:768
    ds_read_b64_tr_b16 a[250:251], v2 offset:4864
    v_mfma_f32_16x16x32_bf16 a[112:115], v[140:143], v[216:219], a[112:115]
    v_exp_f32_e64 v205, v205
    v_mfma_f32_16x16x32_bf16 a[116:119], v[168:171], v[212:215], a[116:119]
    ds_read_b64_tr_b16 a[252:253], v2 offset:776
    ds_read_b64_tr_b16 a[254:255], v2 offset:4872
    v_mfma_f32_16x16x32_bf16 a[116:119], v[144:147], v[216:219], a[116:119]
    v_exp_f32_e64 v206, v206
    v_mfma_f32_16x16x32_bf16 a[120:123], v[172:175], v[212:215], a[120:123]
    v_exp_f32_e64 v207, v207
    v_mfma_f32_16x16x32_bf16 a[120:123], v[148:151], v[216:219], a[120:123]
    v_exp_f32_e64 v208, v208
    v_mfma_f32_16x16x32_bf16 a[124:127], v[176:179], v[212:215], a[124:127]
    v_exp_f32_e64 v209, v209
    v_mfma_f32_16x16x32_bf16 a[124:127], v[152:155], v[216:219], a[124:127]
    v_exp_f32_e64 v210, v210
    v_mfma_f32_16x16x32_bf16 v[196:199], v[108:111], a[80:83], 0
    v_cvt_pk_bf16_f32 v224, v204, v205
    v_cvt_pk_bf16_f32 v225, v206, v207
    v_mfma_f32_16x16x32_bf16 v[196:199], v[112:115], a[84:87], v[196:199]
    s_add_u32 m0, m0, 4096
    v_cvt_pk_bf16_f32 v226, v208, v209
    v_mfma_f32_16x16x32_bf16 v[196:199], v[116:119], a[88:91], v[196:199]
    v_exp_f32_e64 v211, v211
    v_mfma_f32_16x16x32_bf16 v[196:199], v[120:123], a[92:95], v[196:199]
    v_cvt_pk_bf16_f32 v227, v210, v211
    v_mfma_f32_16x16x32_bf16 v[200:203], v[136:139], a[92:95], 0
    buffer_load_dwordx4 v6, s[20:23], s92 offen nt lds
    v_mfma_f32_16x16x32_bf16 v[200:203], v[132:135], a[88:91], v[200:203]
    s_nop 0
    s_nop 0
    v_mfma_f32_16x16x32_bf16 v[200:203], v[128:131], a[84:87], v[200:203]
    s_nop 0
    v_mfma_f32_16x16x32_bf16 v[200:203], v[124:127], a[80:83], v[200:203]
    v_xor_b32 v2, 0x2000, v2
    s_waitcnt lgkmcnt(0)
    v_mfma_f32_16x16x32_bf16 a[128:131], v[180:183], v[212:215], a[128:131]
    v_exp_f32_e64 v196, v196
    v_mfma_f32_16x16x32_bf16 a[128:131], v[156:159], v[216:219], a[128:131]
    v_exp_f32_e64 v197, v197
    v_mfma_f32_16x16x32_bf16 a[132:135], v[184:187], v[212:215], a[132:135]
    v_exp_f32_e64 v198, v198
    v_mfma_f32_16x16x32_bf16 a[132:135], v[160:163], v[216:219], a[132:135]
    v_exp_f32_e64 v199, v199
    v_mfma_f32_16x16x32_bf16 a[136:139], v[188:191], v[212:215], a[136:139]
    v_cvt_pk_bf16_f32 v232, v196, v197
    v_cvt_pk_bf16_f32 v233, v198, v199
    v_mfma_f32_16x16x32_bf16 a[136:139], a[248:251], v[216:219], a[136:139]
    v_exp_f32_e64 v200, v200
    v_mfma_f32_16x16x32_bf16 a[140:143], v[192:195], v[212:215], a[140:143]
    v_exp_f32_e64 v201, v201
    v_mfma_f32_16x16x32_bf16 a[140:143], a[252:255], v[216:219], a[140:143]
    v_exp_f32_e64 v202, v202
    v_mfma_f32_16x16x32_bf16 v[212:215], v[108:111], a[96:99], 0
    v_exp_f32_e64 v203, v203
    v_mfma_f32_16x16x32_bf16 v[212:215], v[112:115], a[100:103], v[212:215]
    v_cvt_pk_bf16_f32 v234, v200, v201
    v_cvt_pk_bf16_f32 v235, v202, v203
    v_mfma_f32_16x16x32_bf16 v[212:215], v[116:119], a[104:107], v[212:215]
    v_mfma_f32_16x16x32_bf16 v[212:215], v[120:123], a[108:111], v[212:215]
    v_mfma_f32_16x16x32_bf16 v[216:219], v[136:139], a[108:111], 0
    buffer_load_dwordx4 v7, s[20:23], s92 offen offset:1024 nt lds
    v_mfma_f32_16x16x32_bf16 v[216:219], v[132:135], a[104:107], v[216:219]
    s_nop 0
    s_nop 0
    v_mfma_f32_16x16x32_bf16 v[216:219], v[128:131], a[100:103], v[216:219]
    s_nop 0
    s_nop 0
    v_mfma_f32_16x16x32_bf16 v[216:219], v[124:127], a[96:99], v[216:219]
    v_exp_f32_e64 v212, v212
    v_smfmac_f32_16x16x64_bf16 v[244:247], a[244:247], v[220:227], v5
    v_mfma_f32_16x16x32_bf16 a[144:147], v[164:167], v[220:223], a[144:147]
    v_exp_f32_e64 v213, v213
    v_mfma_f32_16x16x32_bf16 a[144:147], v[140:143], v[224:227], a[144:147]
    v_exp_f32_e64 v214, v214
    v_mfma_f32_16x16x32_bf16 a[148:151], v[168:171], v[220:223], a[148:151]
    v_exp_f32_e64 v215, v215
    v_mfma_f32_16x16x32_bf16 a[148:151], v[144:147], v[224:227], a[148:151]
    v_exp_f32_e64 v216, v216
    v_mfma_f32_16x16x32_bf16 a[152:155], v[172:175], v[220:223], a[152:155]
    v_exp_f32_e64 v217, v217
    v_mfma_f32_16x16x32_bf16 a[152:155], v[148:151], v[224:227], a[152:155]
    v_exp_f32_e64 v218, v218
    v_mfma_f32_16x16x32_bf16 a[156:159], v[176:179], v[220:223], a[156:159]
    v_cvt_pk_bf16_f32 v228, v212, v213
    v_cvt_pk_bf16_f32 v229, v214, v215
    v_mfma_f32_16x16x32_bf16 a[156:159], v[152:155], v[224:227], a[156:159]
    v_exp_f32_e64 v219, v219
    v_mfma_f32_16x16x32_bf16 v[204:207], v[108:111], a[0:3], 0
    v_cvt_pk_bf16_f32 v230, v216, v217
    v_cvt_pk_bf16_f32 v231, v218, v219
    v_mfma_f32_16x16x32_bf16 v[204:207], v[112:115], a[4:7], v[204:207]
    v_mfma_f32_16x16x32_bf16 v[204:207], v[116:119], a[8:11], v[204:207]
    v_mfma_f32_16x16x32_bf16 v[204:207], v[120:123], a[12:15], v[204:207]
    buffer_load_dwordx4 v8, s[20:23], s92 offen offset:2048 nt lds
    v_mfma_f32_16x16x32_bf16 v[208:211], v[136:139], a[12:15], 0
    s_nop 0
    s_nop 0
    v_mfma_f32_16x16x32_bf16 v[208:211], v[132:135], a[8:11], v[208:211]
    s_nop 0
    s_nop 0
    v_mfma_f32_16x16x32_bf16 v[208:211], v[128:131], a[4:7], v[208:211]
    v_exp_f32_e64 v204, v204
    v_mfma_f32_16x16x32_bf16 v[208:211], v[124:127], a[0:3], v[208:211]
    v_exp_f32_e64 v205, v205
    v_mfma_f32_16x16x32_bf16 v[252:255], a[240:243], v[228:231], v[252:255]
    v_exp_f32_e64 v206, v206
    v_mfma_f32_16x16x32_bf16 a[208:211], v[140:143], v[228:231], a[208:211]
    v_exp_f32_e64 v207, v207
    v_mfma_f32_16x16x32_bf16 a[212:215], v[144:147], v[228:231], a[212:215]
    v_cvt_pk_bf16_f32 v212, v204, v205
    v_cvt_pk_bf16_f32 v213, v206, v207
    v_mfma_f32_16x16x32_bf16 a[216:219], v[148:151], v[228:231], a[216:219]
    v_exp_f32_e64 v208, v208
    v_mfma_f32_16x16x32_bf16 a[220:223], v[152:155], v[228:231], a[220:223]
    v_exp_f32_e64 v209, v209
    v_mfma_f32_16x16x32_bf16 a[224:227], v[156:159], v[228:231], a[224:227]
    v_exp_f32_e64 v210, v210
    v_mfma_f32_16x16x32_bf16 a[228:231], v[160:163], v[228:231], a[228:231]
    v_exp_f32_e64 v211, v211
    v_mfma_f32_16x16x32_bf16 a[232:235], a[248:251], v[228:231], a[232:235]
    v_cvt_pk_bf16_f32 v214, v208, v209
    v_cvt_pk_bf16_f32 v215, v210, v211
    v_mfma_f32_16x16x32_bf16 a[236:239], a[252:255], v[228:231], a[236:239]
    v_mfma_f32_16x16x32_bf16 v[196:199], v[108:111], a[16:19], 0
    v_mfma_f32_16x16x32_bf16 v[196:199], v[112:115], a[20:23], v[196:199]
    v_mfma_f32_16x16x32_bf16 v[196:199], v[116:119], a[24:27], v[196:199]
    buffer_load_dwordx4 v9, s[20:23], s92 offen offset:3072 nt lds
    v_mfma_f32_16x16x32_bf16 v[196:199], v[120:123], a[28:31], v[196:199]
    s_add_u32 s92, s92, 32768
    v_mfma_f32_16x16x32_bf16 v[200:203], v[136:139], a[28:31], 0
    s_nop 0
    s_nop 0
    v_mfma_f32_16x16x32_bf16 v[200:203], v[132:135], a[24:27], v[200:203]
    s_nop 0
    s_nop 0
    v_mfma_f32_16x16x32_bf16 v[200:203], v[128:131], a[20:23], v[200:203]
    v_exp_f32_e64 v196, v196
    v_mfma_f32_16x16x32_bf16 v[200:203], v[124:127], a[16:19], v[200:203]
    v_exp_f32_e64 v197, v197
    v_mfma_f32_16x16x32_bf16 a[160:163], v[180:183], v[220:223], a[160:163]
    v_exp_f32_e64 v198, v198
    v_mfma_f32_16x16x32_bf16 a[160:163], v[156:159], v[224:227], a[160:163]
    v_exp_f32_e64 v199, v199
    v_mfma_f32_16x16x32_bf16 a[164:167], v[184:187], v[220:223], a[164:167]
    s_nop 0
    s_nop 0
    v_mfma_f32_16x16x32_bf16 a[164:167], v[160:163], v[224:227], a[164:167]
    v_exp_f32_e64 v200, v200
    v_mfma_f32_16x16x32_bf16 a[168:171], v[188:191], v[220:223], a[168:171]
    v_exp_f32_e64 v201, v201
    v_mfma_f32_16x16x32_bf16 a[168:171], a[248:251], v[224:227], a[168:171]
    v_exp_f32_e64 v202, v202
    v_mfma_f32_16x16x32_bf16 a[172:175], v[192:195], v[220:223], a[172:175]
    v_cvt_pk_bf16_f32 v220, v196, v197
    v_cvt_pk_bf16_f32 v221, v198, v199
    v_mfma_f32_16x16x32_bf16 a[172:175], a[252:255], v[224:227], a[172:175]
    v_exp_f32_e64 v203, v203
    v_mfma_f32_16x16x32_bf16 v[204:207], v[108:111], a[32:35], 0
    ds_read_b128 v[108:111], v1
    v_cvt_pk_bf16_f32 v222, v200, v201
    v_mfma_f32_16x16x32_bf16 v[204:207], v[112:115], a[36:39], v[204:207]
    ds_read_b128 v[112:115], v1 offset:256
    v_cvt_pk_bf16_f32 v223, v202, v203
    v_mfma_f32_16x16x32_bf16 v[204:207], v[116:119], a[40:43], v[204:207]
    ds_read_b128 v[116:119], v1 offset:512
    v_mfma_f32_16x16x32_bf16 v[204:207], v[120:123], a[44:47], v[204:207]
    ds_read_b128 v[120:123], v1 offset:768
    v_mfma_f32_16x16x32_bf16 v[208:211], v[136:139], a[44:47], 0
    ds_read_b128 v[136:139], v1 offset:4864
    v_mfma_f32_16x16x32_bf16 v[208:211], v[132:135], a[40:43], v[208:211]
    ds_read_b128 v[132:135], v1 offset:4608
    v_mfma_f32_16x16x32_bf16 v[208:211], v[128:131], a[36:39], v[208:211]
    ds_read_b128 v[128:131], v1 offset:4352
    v_mfma_f32_16x16x32_bf16 v[208:211], v[124:127], a[32:35], v[208:211]
    ds_read_b128 v[124:127], v1 offset:4096
    v_smfmac_f32_16x16x64_bf16 v[248:251], a[244:247], v[232:239], v5
    v_mfma_f32_16x16x32_bf16 a[176:179], v[164:167], v[236:239], a[176:179]
    ds_read_b64_tr_b16 v[164:165], v2
    ds_read_b64_tr_b16 v[166:167], v2 offset:4096
    v_mfma_f32_16x16x32_bf16 a[176:179], v[140:143], v[232:235], a[176:179]
    v_mfma_f32_16x16x32_bf16 a[180:183], v[168:171], v[236:239], a[180:183]
    ds_read_b64_tr_b16 v[168:169], v2 offset:8
    ds_read_b64_tr_b16 v[170:171], v2 offset:4104
    v_mfma_f32_16x16x32_bf16 a[180:183], v[144:147], v[232:235], a[180:183]
    v_exp_f32_e64 v204, v204
    v_mfma_f32_16x16x32_bf16 a[184:187], v[172:175], v[236:239], a[184:187]
    ds_read_b64_tr_b16 v[172:173], v2 offset:256
    ds_read_b64_tr_b16 v[174:175], v2 offset:4352
    v_mfma_f32_16x16x32_bf16 a[184:187], v[148:151], v[232:235], a[184:187]
    v_exp_f32_e64 v205, v205
    v_mfma_f32_16x16x32_bf16 a[188:191], v[176:179], v[236:239], a[188:191]
    ds_read_b64_tr_b16 v[176:177], v2 offset:264
    ds_read_b64_tr_b16 v[178:179], v2 offset:4360
    v_mfma_f32_16x16x32_bf16 a[188:191], v[152:155], v[232:235], a[188:191]
    v_cvt_pk_bf16_f32 v228, v204, v205
    s_waitcnt lgkmcnt(8)
    v_mfma_f32_16x16x32_bf16 v[196:199], v[108:111], a[0:3], 0
    v_exp_f32 v206, v206
    v_mfma_f32_16x16x32_bf16 v[196:199], v[112:115], a[4:7], v[196:199]
    v_exp_f32_e64 v207, v207
    v_mfma_f32_16x16x32_bf16 v[196:199], v[116:119], a[8:11], v[196:199]
    v_cvt_pk_bf16_f32 v229, v206, v207
    v_mfma_f32_16x16x32_bf16 v[196:199], v[120:123], a[12:15], v[196:199]
    v_exp_f32_e64 v208, v208
    v_mfma_f32_16x16x32_bf16 v[200:203], v[136:139], a[12:15], 0
    v_exp_f32_e64 v209, v209
    v_mfma_f32_16x16x32_bf16 v[200:203], v[132:135], a[8:11], v[200:203]
    v_exp_f32_e64 v210, v210
    v_mfma_f32_16x16x32_bf16 v[200:203], v[128:131], a[4:7], v[200:203]
    v_exp_f32_e64 v211, v211
    v_mfma_f32_16x16x32_bf16 v[200:203], v[124:127], a[0:3], v[200:203]
    v_exp_f32_e64 v196, v196
    v_mfma_f32_16x16x32_bf16 a[192:195], v[180:183], v[236:239], a[192:195]
    ds_read_b64_tr_b16 v[180:181], v2 offset:512
    ds_read_b64_tr_b16 v[182:183], v2 offset:4608
    v_mfma_f32_16x16x32_bf16 a[192:195], v[156:159], v[232:235], a[192:195]
    v_exp_f32_e64 v197, v197
    v_mfma_f32_16x16x32_bf16 a[196:199], v[184:187], v[236:239], a[196:199]
    ds_read_b64_tr_b16 v[184:185], v2 offset:520
    ds_read_b64_tr_b16 v[186:187], v2 offset:4616
    v_mfma_f32_16x16x32_bf16 a[196:199], v[160:163], v[232:235], a[196:199]
    v_exp_f32_e64 v198, v198
    v_mfma_f32_16x16x32_bf16 a[200:203], v[188:191], v[236:239], a[200:203]
    ds_read_b64_tr_b16 v[188:189], v2 offset:768
    ds_read_b64_tr_b16 v[190:191], v2 offset:4864
    v_mfma_f32_16x16x32_bf16 a[200:203], a[248:251], v[232:235], a[200:203]
    v_exp_f32_e64 v199, v199
    v_mfma_f32_16x16x32_bf16 a[204:207], v[192:195], v[236:239], a[204:207]
    ds_read_b64_tr_b16 v[192:193], v2 offset:776
    ds_read_b64_tr_b16 v[194:195], v2 offset:4872
    v_mfma_f32_16x16x32_bf16 a[204:207], a[252:255], v[232:235], a[204:207]
    v_cvt_pk_bf16_f32 v230, v208, v209
    v_cvt_pk_bf16_f32 v231, v210, v211
    v_mfma_f32_16x16x32_bf16 v[204:207], v[108:111], a[16:19], 0
    v_exp_f32_e64 v200, v200
    v_mfma_f32_16x16x32_bf16 v[204:207], v[112:115], a[20:23], v[204:207]
    v_exp_f32_e64 v201, v201
    v_mfma_f32_16x16x32_bf16 v[204:207], v[116:119], a[24:27], v[204:207]
    v_exp_f32_e64 v202, v202
    v_mfma_f32_16x16x32_bf16 v[204:207], v[120:123], a[28:31], v[204:207]
    v_cvt_pk_bf16_f32 v216, v196, v197
    v_cvt_pk_bf16_f32 v217, v198, v199
    v_mfma_f32_16x16x32_bf16 v[208:211], v[136:139], a[28:31], 0
    v_exp_f32_e64 v203, v203
    v_mfma_f32_16x16x32_bf16 v[208:211], v[132:135], a[24:27], v[208:211]
    v_cvt_pk_bf16_f32 v218, v200, v201
    v_cvt_pk_bf16_f32 v219, v202, v203
    v_mfma_f32_16x16x32_bf16 v[208:211], v[128:131], a[20:23], v[208:211]
    s_and_b32 m0, s38, 0x7fffffff
    v_mfma_f32_16x16x32_bf16 v[208:211], v[124:127], a[16:19], v[208:211]
    s_waitcnt vmcnt(8) lgkmcnt(0)
    s_barrier
    v_smfmac_f32_16x16x64_bf16 v[240:243], a[240:243], v[212:219], v5
    v_mfma_f32_16x16x32_bf16 v[12:15], v[140:143], v[212:215], v[12:15]
    buffer_load_dwordx4 v6, s[24:27], s92 offen nt lds
    v_mfma_f32_16x16x32_bf16 v[12:15], v[164:167], v[216:219], v[12:15]
    v_exp_f32_e64 v204, v204
    v_mfma_f32_16x16x32_bf16 v[16:19], v[144:147], v[212:215], v[16:19]
    v_exp_f32_e64 v205, v205
    v_mfma_f32_16x16x32_bf16 v[16:19], v[168:171], v[216:219], v[16:19]
    v_exp_f32_e64 v206, v206
    v_mfma_f32_16x16x32_bf16 v[20:23], v[148:151], v[212:215], v[20:23]
    buffer_load_dwordx4 v6, s[24:27], s92 offen offset:1024 nt lds
    v_mfma_f32_16x16x32_bf16 v[20:23], v[172:175], v[216:219], v[20:23]
    v_exp_f32_e64 v207, v207
    v_mfma_f32_16x16x32_bf16 v[24:27], v[152:155], v[212:215], v[24:27]
    v_cvt_pk_bf16_f32 v224, v204, v205
    v_cvt_pk_bf16_f32 v225, v206, v207
    v_mfma_f32_16x16x32_bf16 v[24:27], v[176:179], v[216:219], v[24:27]
    v_exp_f32_e64 v208, v208
    v_mfma_f32_16x16x32_bf16 v[196:199], v[108:111], a[32:35], 0
    buffer_load_dwordx4 v6, s[24:27], s92 offen offset:2048 nt lds
    v_mfma_f32_16x16x32_bf16 v[196:199], v[112:115], a[36:39], v[196:199]
    v_exp_f32_e64 v209, v209
    v_mfma_f32_16x16x32_bf16 v[196:199], v[116:119], a[40:43], v[196:199]
    v_exp_f32_e64 v210, v210
    v_mfma_f32_16x16x32_bf16 v[196:199], v[120:123], a[44:47], v[196:199]
    v_exp_f32_e64 v211, v211
    v_mfma_f32_16x16x32_bf16 v[200:203], v[136:139], a[44:47], 0
    buffer_load_dwordx4 v6, s[24:27], s92 offen offset:3072 nt lds
    v_mfma_f32_16x16x32_bf16 v[200:203], v[132:135], a[40:43], v[200:203]
    s_add_u32 m0, m0, 4096
    v_cvt_pk_bf16_f32 v226, v208, v209
    v_mfma_f32_16x16x32_bf16 v[200:203], v[128:131], a[36:39], v[200:203]
    v_cvt_pk_bf16_f32 v227, v210, v211
    s_add_u32 s93, s39, 32768
    v_mfma_f32_16x16x32_bf16 v[200:203], v[124:127], a[32:35], v[200:203]
    v_exp_f32_e64 v196, v196
    v_mfma_f32_16x16x32_bf16 v[28:31], v[156:159], v[212:215], v[28:31]
    buffer_load_dwordx4 v6, s[28:31], s92 offen nt lds
    v_mfma_f32_16x16x32_bf16 v[28:31], v[180:183], v[216:219], v[28:31]
    v_exp_f32_e64 v197, v197
    v_mfma_f32_16x16x32_bf16 v[32:35], v[160:163], v[212:215], v[32:35]
    v_exp_f32_e64 v198, v198
    v_mfma_f32_16x16x32_bf16 v[32:35], v[184:187], v[216:219], v[32:35]
    v_exp_f32_e64 v199, v199
    v_mfma_f32_16x16x32_bf16 v[36:39], a[248:251], v[212:215], v[36:39]
    buffer_load_dwordx4 v6, s[28:31], s92 offen offset:1024 nt lds
    v_mfma_f32_16x16x32_bf16 v[36:39], v[188:191], v[216:219], v[36:39]
    v_cvt_pk_bf16_f32 v232, v196, v197
    v_cvt_pk_bf16_f32 v233, v198, v199
    v_mfma_f32_16x16x32_bf16 v[40:43], a[252:255], v[212:215], v[40:43]
    v_exp_f32_e64 v200, v200
    v_mfma_f32_16x16x32_bf16 v[40:43], v[192:195], v[216:219], v[40:43]
    v_exp_f32_e64 v201, v201
    v_mfma_f32_16x16x32_bf16 v[204:207], v[108:111], a[48:51], 0
    buffer_load_dwordx4 v6, s[28:31], s92 offen offset:2048 nt lds
    v_mfma_f32_16x16x32_bf16 v[204:207], v[112:115], a[52:55], v[204:207]
    v_exp_f32_e64 v202, v202
    v_mfma_f32_16x16x32_bf16 v[204:207], v[116:119], a[56:59], v[204:207]
    v_exp_f32_e64 v203, v203
    v_mfma_f32_16x16x32_bf16 v[204:207], v[120:123], a[60:63], v[204:207]
    v_cvt_pk_bf16_f32 v234, v200, v201
    v_cvt_pk_bf16_f32 v235, v202, v203
    v_mfma_f32_16x16x32_bf16 v[208:211], v[136:139], a[60:63], 0
    buffer_load_dwordx4 v6, s[28:31], s92 offen offset:3072 nt lds
    v_mfma_f32_16x16x32_bf16 v[208:211], v[132:135], a[56:59], v[208:211]
    s_cmp_lt_u32 s93, 163840
    s_cselect_b32 s38, s93, s37
    v_mfma_f32_16x16x32_bf16 v[208:211], v[128:131], a[52:55], v[208:211]
    v_exp_f32 v204, v204
    v_mfma_f32_16x16x32_bf16 v[208:211], v[124:127], a[48:51], v[208:211]
    v_exp_f32_e64 v205, v205
    v_smfmac_f32_16x16x64_bf16 v[244:247], a[240:243], v[220:227], v5
    v_cvt_pk_bf16_f32 v212, v204, v205
    v_mfma_f32_16x16x32_bf16 v[44:47], v[140:143], v[220:223], v[44:47]
    v_exp_f32_e64 v206, v206
    v_mfma_f32_16x16x32_bf16 v[44:47], v[164:167], v[224:227], v[44:47]
    v_exp_f32_e64 v207, v207
    v_mfma_f32_16x16x32_bf16 v[48:51], v[144:147], v[220:223], v[48:51]
    v_cvt_pk_bf16_f32 v213, v206, v207
    s_and_b32 m0, s39, 0x7fffffff
    v_mfma_f32_16x16x32_bf16 v[48:51], v[168:171], v[224:227], v[48:51]
    v_exp_f32_e64 v208, v208
    v_mfma_f32_16x16x32_bf16 v[52:55], v[148:151], v[220:223], v[52:55]
    v_exp_f32_e64 v209, v209
    v_mfma_f32_16x16x32_bf16 v[52:55], v[172:175], v[224:227], v[52:55]
    v_add_u32_e64 v1, s38, v3
    v_cvt_pk_bf16_f32 v214, v208, v209
    v_mfma_f32_16x16x32_bf16 v[56:59], v[152:155], v[220:223], v[56:59]
    v_exp_f32_e64 v210, v210
    v_mfma_f32_16x16x32_bf16 v[56:59], v[176:179], v[224:227], v[56:59]
    v_exp_f32_e64 v211, v211
    v_mfma_f32_16x16x32_bf16 v[196:199], v[108:111], a[64:67], 0
    v_cvt_pk_bf16_f32 v215, v210, v211
    s_add_u32 s93, s38, 32768
    v_mfma_f32_16x16x32_bf16 v[196:199], v[112:115], a[68:71], v[196:199]
    s_cmp_lt_u32 s93, 163840
    s_cselect_b32 s39, s93, s37
    v_mfma_f32_16x16x32_bf16 v[196:199], v[116:119], a[72:75], v[196:199]
    v_add_u32 v2, s39, v4
    v_mfma_f32_16x16x32_bf16 v[196:199], v[120:123], a[76:79], v[196:199]
    v_mfma_f32_16x16x32_bf16 v[200:203], v[136:139], a[76:79], 0
    s_nop 0
    s_nop 0
    v_mfma_f32_16x16x32_bf16 v[200:203], v[132:135], a[72:75], v[200:203]
    s_nop 0
    s_nop 0
    v_mfma_f32_16x16x32_bf16 v[200:203], v[128:131], a[68:71], v[200:203]
    buffer_load_dwordx4 v6, s[16:19], s92 offen nt lds
    v_mfma_f32_16x16x32_bf16 v[200:203], v[124:127], a[64:67], v[200:203]
    v_exp_f32_e64 v196, v196
    v_mfma_f32_16x16x32_bf16 v[60:63], v[156:159], v[220:223], v[60:63]
    v_exp_f32_e64 v197, v197
    v_mfma_f32_16x16x32_bf16 v[60:63], v[180:183], v[224:227], v[60:63]
    v_exp_f32_e64 v198, v198
    v_mfma_f32_16x16x32_bf16 v[64:67], v[160:163], v[220:223], v[64:67]
    v_exp_f32_e64 v199, v199
    v_mfma_f32_16x16x32_bf16 v[64:67], v[184:187], v[224:227], v[64:67]
    v_exp_f32_e64 v200, v200
    v_mfma_f32_16x16x32_bf16 v[68:71], a[248:251], v[220:223], v[68:71]
    v_exp_f32_e64 v201, v201
    v_mfma_f32_16x16x32_bf16 v[68:71], v[188:191], v[224:227], v[68:71]
    v_exp_f32_e64 v202, v202
    v_mfma_f32_16x16x32_bf16 v[72:75], a[252:255], v[220:223], v[72:75]
    v_cvt_pk_bf16_f32 v220, v196, v197
    v_cvt_pk_bf16_f32 v221, v198, v199
    v_mfma_f32_16x16x32_bf16 v[72:75], v[192:195], v[224:227], v[72:75]
    v_exp_f32_e64 v203, v203
    v_mfma_f32_16x16x32_bf16 v[204:207], v[108:111], a[80:83], 0
    ds_read_b128 v[108:111], v1
    v_cvt_pk_bf16_f32 v222, v200, v201
    v_mfma_f32_16x16x32_bf16 v[204:207], v[112:115], a[84:87], v[204:207]
    ds_read_b128 v[112:115], v1 offset:256
    v_cvt_pk_bf16_f32 v223, v202, v203
    v_mfma_f32_16x16x32_bf16 v[204:207], v[116:119], a[88:91], v[204:207]
    ds_read_b128 v[116:119], v1 offset:512
    v_mfma_f32_16x16x32_bf16 v[204:207], v[120:123], a[92:95], v[204:207]
    ds_read_b128 v[120:123], v1 offset:768
    v_mfma_f32_16x16x32_bf16 v[208:211], v[136:139], a[92:95], 0
    ds_read_b128 v[136:139], v1 offset:4864
    v_mfma_f32_16x16x32_bf16 v[208:211], v[132:135], a[88:91], v[208:211]
    ds_read_b128 v[132:135], v1 offset:4608
    v_mfma_f32_16x16x32_bf16 v[208:211], v[128:131], a[84:87], v[208:211]
    ds_read_b128 v[128:131], v1 offset:4352
    v_mfma_f32_16x16x32_bf16 v[208:211], v[124:127], a[80:83], v[208:211]
    ds_read_b128 v[124:127], v1 offset:4096
    v_smfmac_f32_16x16x64_bf16 v[248:251], a[240:243], v[228:235], v5
    v_mfma_f32_16x16x32_bf16 v[76:79], v[140:143], v[228:231], v[76:79]
    buffer_load_dwordx4 v7, s[16:19], s92 offen offset:1024 nt lds
    v_mfma_f32_16x16x32_bf16 v[76:79], v[164:167], v[232:235], v[76:79]
    ds_read_b64_tr_b16 v[140:141], v2
    ds_read_b64_tr_b16 v[142:143], v2 offset:4096
    v_mfma_f32_16x16x32_bf16 v[80:83], v[144:147], v[228:231], v[80:83]
    v_exp_f32_e64 v204, v204
    v_mfma_f32_16x16x32_bf16 v[80:83], v[168:171], v[232:235], v[80:83]
    v_exp_f32_e64 v205, v205
    v_mfma_f32_16x16x32_bf16 v[84:87], v[148:151], v[228:231], v[84:87]
    v_exp_f32_e64 v206, v206
    v_mfma_f32_16x16x32_bf16 v[84:87], v[172:175], v[232:235], v[84:87]
    v_exp_f32_e64 v207, v207
    v_mfma_f32_16x16x32_bf16 v[88:91], v[152:155], v[228:231], v[88:91]
    ds_read_b64_tr_b16 v[144:145], v2 offset:8
    ds_read_b64_tr_b16 v[146:147], v2 offset:4104
    v_mfma_f32_16x16x32_bf16 v[88:91], v[176:179], v[232:235], v[88:91]
    s_cmp_lt_u32 s92, 524288
    s_cbranch_scc1 L_loop
    s_waitcnt lgkmcnt(4)
    v_mfma_f32_16x16x32_bf16 v[196:199], v[108:111], a[96:99], 0
    v_xor_b32 v1, 0x2000, v1
    v_cvt_pk_bf16_f32 v236, v204, v205
    v_mfma_f32_16x16x32_bf16 v[196:199], v[112:115], a[100:103], v[196:199]
    v_cvt_pk_bf16_f32 v237, v206, v207
    v_add_u32_e64 v3, s100, v10
    v_mfma_f32_16x16x32_bf16 v[196:199], v[116:119], a[104:107], v[196:199]
    v_exp_f32_e64 v208, v208
    v_mfma_f32_16x16x32_bf16 v[196:199], v[120:123], a[108:111], v[196:199]
    v_exp_f32_e64 v209, v209
    v_mfma_f32_16x16x32_bf16 v[200:203], v[136:139], a[108:111], 0
    v_exp_f32_e64 v210, v210
    v_mfma_f32_16x16x32_bf16 v[200:203], v[132:135], a[104:107], v[200:203]
    v_exp_f32_e64 v211, v211
    v_mfma_f32_16x16x32_bf16 v[200:203], v[128:131], a[100:103], v[200:203]
    v_cvt_pk_bf16_f32 v238, v208, v209
    v_cvt_pk_bf16_f32 v239, v210, v211
    v_mfma_f32_16x16x32_bf16 v[200:203], v[124:127], a[96:99], v[200:203]
    v_exp_f32_e64 v196, v196
    v_mfma_f32_16x16x32_bf16 v[92:95], v[156:159], v[228:231], v[92:95]
    v_exp_f32_e64 v197, v197
    v_mfma_f32_16x16x32_bf16 v[92:95], v[180:183], v[232:235], v[92:95]
    v_exp_f32_e64 v198, v198
    v_mfma_f32_16x16x32_bf16 v[96:99], v[160:163], v[228:231], v[96:99]
    v_exp_f32_e64 v199, v199
    v_mfma_f32_16x16x32_bf16 v[96:99], v[184:187], v[232:235], v[96:99]
    v_exp_f32 v200, v200
    v_mfma_f32_16x16x32_bf16 v[100:103], a[248:251], v[228:231], v[100:103]
    s_waitcnt vmcnt(0)
    ds_read_b64_tr_b16 v[148:149], v2 offset:256
    v_mfma_f32_16x16x32_bf16 v[100:103], v[188:191], v[232:235], v[100:103]
    ds_read_b64_tr_b16 v[150:151], v2 offset:4352
    v_add_u32_e64 v4, s101, v10
    v_mfma_f32_16x16x32_bf16 v[104:107], a[252:255], v[228:231], v[104:107]
    v_exp_f32_e64 v201, v201
    v_mfma_f32_16x16x32_bf16 v[104:107], v[192:195], v[232:235], v[104:107]
    ds_read_b64_tr_b16 v[152:153], v2 offset:264
    ds_read_b64_tr_b16 v[154:155], v2 offset:4360
    v_mfma_f32_16x16x32_bf16 v[204:207], v[108:111], a[48:51], 0
    v_exp_f32_e64 v202, v202
    v_mfma_f32_16x16x32_bf16 v[204:207], v[112:115], a[52:55], v[204:207]
    ds_read_b64_tr_b16 v[156:157], v2 offset:512
    ds_read_b64_tr_b16 v[158:159], v2 offset:4608
    v_mfma_f32_16x16x32_bf16 v[204:207], v[116:119], a[56:59], v[204:207]
    v_cvt_pk_bf16_f32 v228, v196, v197
    v_cvt_pk_bf16_f32 v229, v198, v199
    v_mfma_f32_16x16x32_bf16 v[204:207], v[120:123], a[60:63], v[204:207]
    v_exp_f32_e64 v203, v203
    v_mfma_f32_16x16x32_bf16 v[208:211], v[136:139], a[60:63], 0
    ds_read_b64_tr_b16 v[160:161], v2 offset:520
    ds_read_b64_tr_b16 v[162:163], v2 offset:4616
    v_mfma_f32_16x16x32_bf16 v[208:211], v[132:135], a[56:59], v[208:211]
    v_cvt_pk_bf16_f32 v230, v200, v201
    v_cvt_pk_bf16_f32 v231, v202, v203
    v_mfma_f32_16x16x32_bf16 v[208:211], v[128:131], a[52:55], v[208:211]
    ds_read_b64_tr_b16 a[248:249], v2 offset:768
    ds_read_b64_tr_b16 a[250:251], v2 offset:4864
    v_mfma_f32_16x16x32_bf16 v[208:211], v[124:127], a[48:51], v[208:211]
    ds_read_b64_tr_b16 a[252:253], v2 offset:776
    ds_read_b64_tr_b16 a[254:255], v2 offset:4872
    v_mfma_f32_16x16x32_bf16 a[144:147], v[164:167], v[220:223], a[144:147]
    v_exp_f32_e64 v204, v204
    v_mfma_f32_16x16x32_bf16 a[148:151], v[168:171], v[220:223], a[148:151]
    v_exp_f32_e64 v205, v205
    v_mfma_f32_16x16x32_bf16 a[152:155], v[172:175], v[220:223], a[152:155]
    v_exp_f32_e64 v206, v206
    v_mfma_f32_16x16x32_bf16 a[156:159], v[176:179], v[220:223], a[156:159]
    ds_read_b128 a[96:99], v1
    ds_read_b128 a[100:103], v1 offset:256
    v_mfma_f32_16x16x32_bf16 a[160:163], v[180:183], v[220:223], a[160:163]
    ds_read_b128 a[104:107], v1 offset:512
    ds_read_b128 a[108:111], v1 offset:768
    v_mfma_f32_16x16x32_bf16 a[164:167], v[184:187], v[220:223], a[164:167]
    v_exp_f32_e64 v207, v207
    v_mfma_f32_16x16x32_bf16 a[168:171], v[188:191], v[220:223], a[168:171]
    v_exp_f32_e64 v208, v208
    v_mfma_f32_16x16x32_bf16 a[172:175], v[192:195], v[220:223], a[172:175]
    v_exp_f32_e64 v209, v209
    v_mfma_f32_16x16x32_bf16 v[252:255], a[240:243], v[228:231], v[252:255]
    v_exp_f32 v210, v210
    s_waitcnt lgkmcnt(12)
    v_mfma_f32_16x16x32_bf16 a[208:211], v[140:143], v[228:231], a[208:211]
    v_cvt_pk_bf16_f32 v216, v204, v205
    v_cvt_pk_bf16_f32 v217, v206, v207
    v_mfma_f32_16x16x32_bf16 a[212:215], v[144:147], v[228:231], a[212:215]
    v_exp_f32_e64 v211, v211
    v_mfma_f32_16x16x32_bf16 a[216:219], v[148:151], v[228:231], a[216:219]
    ds_write_b32 v4, v252 offset:32780
    v_mfma_f32_16x16x32_bf16 a[220:223], v[152:155], v[228:231], a[220:223]
    v_cvt_pk_bf16_f32 v218, v208, v209
    v_cvt_pk_bf16_f32 v219, v210, v211
    s_waitcnt lgkmcnt(5)
    v_mfma_f32_16x16x32_bf16 a[224:227], v[156:159], v[228:231], a[224:227]
    ds_write_b128 v3, a[208:211] offset:32768
    v_mfma_f32_16x16x32_bf16 a[228:231], v[160:163], v[228:231], a[228:231]
    v_xor_b32 v2, 0x2000, v2
    v_add_u32 v8, s96, v10
    v_mfma_f32_16x16x32_bf16 a[232:235], a[248:251], v[228:231], a[232:235]
    v_add_u32 v9, 0x1000c, v10
    v_xor_b32 v6, 0x4000, v3
    v_mfma_f32_16x16x32_bf16 a[236:239], a[252:255], v[228:231], a[236:239]
    ds_write_b128 v3, a[212:215] offset:33792
    v_mfma_f32_16x16x32_bf16 v[196:199], v[108:111], a[0:3], 0
    v_xor_b32 v7, 0x4000, v4
    v_mfma_f32_16x16x32_bf16 v[196:199], v[112:115], a[4:7], v[196:199]
    s_nop 0
    s_nop 0
    v_mfma_f32_16x16x32_bf16 v[196:199], v[116:119], a[8:11], v[196:199]
    ds_write_b128 v3, a[216:219] offset:34816
    v_mfma_f32_16x16x32_bf16 v[196:199], v[120:123], a[12:15], v[196:199]
    v_mfma_f32_16x16x32_bf16 v[200:203], v[136:139], a[12:15], 0
    s_nop 0
    s_nop 0
    v_mfma_f32_16x16x32_bf16 v[200:203], v[132:135], a[8:11], v[200:203]
    ds_write_b128 v3, a[220:223] offset:35840
    v_mfma_f32_16x16x32_bf16 v[200:203], v[128:131], a[4:7], v[200:203]
    s_nop 0
    s_nop 0
    v_mfma_f32_16x16x32_bf16 v[200:203], v[124:127], a[0:3], v[200:203]
    v_exp_f32_e64 v196, v196
    v_smfmac_f32_16x16x64_bf16 v[240:243], a[244:247], v[212:219], v5
    ds_write_b128 v3, a[224:227] offset:36864
    v_mfma_f32_16x16x32_bf16 a[112:115], v[164:167], v[212:215], a[112:115]
    v_exp_f32_e64 v197, v197
    v_mfma_f32_16x16x32_bf16 a[112:115], v[140:143], v[216:219], a[112:115]
    v_exp_f32_e64 v198, v198
    v_mfma_f32_16x16x32_bf16 a[116:119], v[168:171], v[212:215], a[116:119]
    ds_write_b128 v3, a[228:231] offset:37888
    v_mfma_f32_16x16x32_bf16 a[116:119], v[144:147], v[216:219], a[116:119]
    v_exp_f32_e64 v199, v199
    v_mfma_f32_16x16x32_bf16 a[120:123], v[172:175], v[212:215], a[120:123]
    v_cvt_pk_bf16_f32 v232, v196, v197
    v_cvt_pk_bf16_f32 v233, v198, v199
    v_mfma_f32_16x16x32_bf16 a[120:123], v[148:151], v[216:219], a[120:123]
    ds_write_b128 v3, a[232:235] offset:38912
    v_mfma_f32_16x16x32_bf16 a[124:127], v[176:179], v[212:215], a[124:127]
    v_exp_f32_e64 v200, v200
    v_mfma_f32_16x16x32_bf16 a[124:127], v[152:155], v[216:219], a[124:127]
    v_exp_f32_e64 v201, v201
    v_mfma_f32_16x16x32_bf16 a[128:131], v[180:183], v[212:215], a[128:131]
    ds_read_b128 a[220:223], v1 offset:4864
    ds_read_b128 a[216:219], v1 offset:4608
    v_mfma_f32_16x16x32_bf16 a[128:131], v[156:159], v[216:219], a[128:131]
    ds_read_b128 a[212:215], v1 offset:4352
    ds_read_b128 a[208:211], v1 offset:4096
    v_mfma_f32_16x16x32_bf16 a[132:135], v[184:187], v[212:215], a[132:135]
    v_exp_f32_e64 v202, v202
    v_mfma_f32_16x16x32_bf16 a[132:135], v[160:163], v[216:219], a[132:135]
    ds_write_b128 v3, a[236:239] offset:39936
    v_mfma_f32_16x16x32_bf16 a[136:139], v[188:191], v[212:215], a[136:139]
    v_exp_f32_e64 v203, v203
    v_mfma_f32_16x16x32_bf16 a[136:139], a[248:251], v[216:219], a[136:139]
    v_cvt_pk_bf16_f32 v234, v200, v201
    v_cvt_pk_bf16_f32 v235, v202, v203
    v_mfma_f32_16x16x32_bf16 a[140:143], v[192:195], v[212:215], a[140:143]
    ds_read_b64_tr_b16 a[224:225], v2
    ds_read_b64_tr_b16 a[226:227], v2 offset:4096
    v_mfma_f32_16x16x32_bf16 a[140:143], a[252:255], v[216:219], a[140:143]
    ds_read_b64_tr_b16 a[228:229], v2 offset:8
    ds_read_b64_tr_b16 a[230:231], v2 offset:4104
    s_waitcnt lgkmcnt(15)
    v_mfma_f32_16x16x32_bf16 v[204:207], a[96:99], a[48:51], 0
    ds_read_b64_tr_b16 a[232:233], v2 offset:256
    s_waitcnt lgkmcnt(5)
    s_barrier
    v_mfma_f32_16x16x32_bf16 v[204:207], a[100:103], a[52:55], v[204:207]
    ds_read_b64_tr_b16 a[234:235], v2 offset:4352
    ds_read_b64_tr_b16 a[236:237], v2 offset:264
    v_mfma_f32_16x16x32_bf16 v[204:207], a[104:107], a[56:59], v[204:207]
    ds_read_b64_tr_b16 a[238:239], v2 offset:4360
    v_add_f32 v242, v242, v243
    v_mfma_f32_16x16x32_bf16 v[204:207], a[108:111], a[60:63], v[204:207]
    v_mfma_f32_16x16x32_bf16 v[208:211], a[220:223], a[60:63], 0
    s_nop 0
    s_nop 0
    v_mfma_f32_16x16x32_bf16 v[208:211], a[216:219], a[56:59], v[208:211]
    s_nop 0
    s_nop 0
    v_mfma_f32_16x16x32_bf16 v[208:211], a[212:215], a[52:55], v[208:211]
    s_nop 0
    v_exp_f32 v204, v204
    v_mfma_f32_16x16x32_bf16 v[208:211], a[208:211], a[48:51], v[208:211]
    v_exp_f32_e64 v205, v205
    v_mfma_f32_16x16x32_bf16 a[176:179], v[164:167], v[236:239], a[176:179]
    v_exp_f32_e64 v206, v206
    v_mfma_f32_16x16x32_bf16 a[180:183], v[168:171], v[236:239], a[180:183]
    ds_read_b64_tr_b16 a[48:49], v2 offset:512
    ds_read_b64_tr_b16 a[50:51], v2 offset:4608
    v_mfma_f32_16x16x32_bf16 a[184:187], v[172:175], v[236:239], a[184:187]
    v_exp_f32_e64 v207, v207
    v_mfma_f32_16x16x32_bf16 a[188:191], v[176:179], v[236:239], a[188:191]
    ds_read_b64_tr_b16 a[52:53], v2 offset:520
    ds_read_b64_tr_b16 a[54:55], v2 offset:4616
    v_mfma_f32_16x16x32_bf16 a[192:195], v[180:183], v[236:239], a[192:195]
    v_exp_f32_e64 v208, v208
    v_mfma_f32_16x16x32_bf16 a[196:199], v[184:187], v[236:239], a[196:199]
    ds_read_b64_tr_b16 a[56:57], v2 offset:768
    ds_read_b64_tr_b16 a[58:59], v2 offset:4864
    v_mfma_f32_16x16x32_bf16 a[200:203], v[188:191], v[236:239], a[200:203]
    v_exp_f32_e64 v209, v209
    v_mfma_f32_16x16x32_bf16 a[204:207], v[192:195], v[236:239], a[204:207]
    ds_read_b64_tr_b16 a[60:61], v2 offset:776
    ds_read_b64_tr_b16 a[62:63], v2 offset:4872
    v_mfma_f32_16x16x32_bf16 v[196:199], a[96:99], a[0:3], 0
    v_exp_f32_e64 v210, v210
    v_mfma_f32_16x16x32_bf16 v[196:199], a[100:103], a[4:7], v[196:199]
    v_cvt_pk_bf16_f32 v212, v204, v205
    v_cvt_pk_bf16_f32 v213, v206, v207
    v_mfma_f32_16x16x32_bf16 v[196:199], a[104:107], a[8:11], v[196:199]
    v_exp_f32_e64 v211, v211
    v_mfma_f32_16x16x32_bf16 v[196:199], a[108:111], a[12:15], v[196:199]
    v_cvt_pk_bf16_f32 v214, v208, v209
    v_cvt_pk_bf16_f32 v215, v210, v211
    v_mfma_f32_16x16x32_bf16 v[200:203], a[220:223], a[12:15], 0
    ds_read2st64_b32 v[188:189], v9 offset0:0 offset1:32
    ds_read2st64_b32 v[190:191], v9 offset0:64 offset1:96
    v_mfma_f32_16x16x32_bf16 v[200:203], a[216:219], a[8:11], v[200:203]
    ds_read_b128 v[164:167], v8
    ds_read_b128 v[168:171], v8 offset:1024
    v_mfma_f32_16x16x32_bf16 v[200:203], a[212:215], a[4:7], v[200:203]
    ds_read_b128 v[172:175], v8 offset:8192
    ds_read_b128 v[176:179], v8 offset:9216
    v_mfma_f32_16x16x32_bf16 v[200:203], a[208:211], a[0:3], v[200:203]
    v_exp_f32_e64 v196, v196
    v_mfma_f32_16x16x32_bf16 v[240:243], a[244:247], v[212:215], v[240:243]
    v_exp_f32 v197, v197
    s_waitcnt lgkmcnt(14)
    v_mfma_f32_16x16x32_bf16 a[112:115], a[224:227], v[212:215], a[112:115]
    v_exp_f32_e64 v198, v198
    v_mfma_f32_16x16x32_bf16 a[116:119], a[228:231], v[212:215], a[116:119]
    v_exp_f32_e64 v199, v199
    v_mfma_f32_16x16x32_bf16 a[120:123], a[232:235], v[212:215], a[120:123]
    v_exp_f32_e64 v200, v200
    v_mfma_f32_16x16x32_bf16 a[124:127], a[236:239], v[212:215], a[124:127]
    ds_write_b32 v4, v242 offset:32768
    v_exp_f32_e64 v201, v201
    v_exp_f32 v202, v202
    s_waitcnt lgkmcnt(1)
    v_pk_add_f32 v[164:165], v[164:165], v[172:173]
    v_pk_add_f32 v[166:167], v[166:167], v[174:175]
    v_pk_add_f32 v[168:169], v[168:169], v[176:177]
    v_pk_add_f32 v[170:171], v[170:171], v[178:179]
    v_mfma_f32_16x16x32_bf16 a[128:131], a[48:51], v[212:215], a[128:131]
    ds_read_b128 v[172:175], v8 offset:16384
    ds_read_b128 v[176:179], v8 offset:17408
    v_mfma_f32_16x16x32_bf16 a[132:135], a[52:55], v[212:215], a[132:135]
    v_cvt_pk_bf16_f32 v228, v196, v197
    v_cvt_pk_bf16_f32 v229, v198, v199
    v_mfma_f32_16x16x32_bf16 a[136:139], a[56:59], v[212:215], a[136:139]
    ds_write_b128 v3, a[112:115]
    v_mfma_f32_16x16x32_bf16 a[140:143], a[60:63], v[212:215], a[140:143]
    v_exp_f32_e64 v203, v203
    v_mfma_f32_16x16x32_bf16 v[204:207], v[108:111], a[64:67], 0
    v_cvt_pk_bf16_f32 v230, v200, v201
    v_cvt_pk_bf16_f32 v231, v202, v203
    v_mfma_f32_16x16x32_bf16 v[204:207], v[112:115], a[68:71], v[204:207]
    ds_write_b128 v3, a[116:119] offset:1024
    v_mfma_f32_16x16x32_bf16 v[204:207], v[116:119], a[72:75], v[204:207]
    v_add_f32_e64 v188, v188, v189
    v_mfma_f32_16x16x32_bf16 v[204:207], v[120:123], a[76:79], v[204:207]
    v_add_f32_e64 v190, v190, v191
    v_add_f32 v188, v188, v190
    v_mfma_f32_16x16x32_bf16 v[208:211], v[136:139], a[76:79], 0
    ds_write_b128 v3, a[120:123] offset:2048
    s_waitcnt lgkmcnt(3)
    v_pk_add_f32 v[164:165], v[164:165], v[172:173]
    v_pk_add_f32 v[166:167], v[166:167], v[174:175]
    v_pk_add_f32 v[168:169], v[168:169], v[176:177]
    v_pk_add_f32 v[170:171], v[170:171], v[178:179]
    v_mfma_f32_16x16x32_bf16 v[208:211], v[132:135], a[72:75], v[208:211]
    v_rcp_f32_e64 v192, v188
    v_mfma_f32_16x16x32_bf16 v[208:211], v[128:131], a[68:71], v[208:211]
    ds_read_b128 v[172:175], v8 offset:24576
    ds_read_b128 v[176:179], v8 offset:25600
    v_mfma_f32_16x16x32_bf16 v[208:211], v[124:127], a[64:67], v[208:211]
    v_max_u32_e64 v193, v188, v192
    v_smfmac_f32_16x16x64_bf16 v[240:243], a[240:243], v[228:235], v5
    ds_write_b128 v3, a[124:127] offset:3072
    v_mfma_f32_16x16x32_bf16 v[12:15], v[140:143], v[232:235], v[12:15]
    v_exp_f32_e64 v204, v204
    v_mfma_f32_16x16x32_bf16 v[12:15], a[224:227], v[228:231], v[12:15]
    v_exp_f32 v205, v205
    v_mfma_f32_16x16x32_bf16 v[16:19], v[144:147], v[232:235], v[16:19]
    ds_write_b128 v3, a[128:131] offset:4096
    s_waitcnt lgkmcnt(2)
    v_pk_add_f32 v[164:165], v[164:165], v[172:173]
    v_pk_add_f32 v[166:167], v[166:167], v[174:175]
    v_pk_add_f32 v[168:169], v[168:169], v[176:177]
    v_pk_add_f32 v[170:171], v[170:171], v[178:179]
    v_pk_mul_f32 v[164:165], v[164:165], v[192:193] op_sel_hi:[1,0]
    v_pk_mul_f32 v[166:167], v[166:167], v[192:193] op_sel_hi:[1,0]
    v_pk_mul_f32 v[168:169], v[168:169], v[192:193] op_sel_hi:[1,0]
    v_pk_mul_f32 v[170:171], v[170:171], v[192:193] op_sel_hi:[1,0]
    v_mfma_f32_16x16x32_bf16 v[16:19], a[228:231], v[228:231], v[16:19]
    ds_write_b128 v3, a[132:135] offset:5120
    v_add_f32_e64 v240, v240, v241
    v_mfma_f32_16x16x32_bf16 v[20:23], v[148:151], v[232:235], v[20:23]
    v_cvt_pk_bf16_f32 v164, v164, v165
    v_cvt_pk_bf16_f32 v165, v166, v167
    v_mfma_f32_16x16x32_bf16 v[20:23], a[232:235], v[228:231], v[20:23]
    v_cvt_pk_bf16_f32 v166, v168, v169
    v_cvt_pk_bf16_f32 v167, v170, v171
    v_mfma_f32_16x16x32_bf16 v[24:27], v[152:155], v[232:235], v[24:27]
    buffer_store_dwordx4 v[164:167], v11, s[32:35], s62 offen nt sc1
    ds_write_b128 v3, a[136:139] offset:6144
    v_mfma_f32_16x16x32_bf16 v[24:27], a[236:239], v[228:231], v[24:27]
    v_exp_f32_e64 v206, v206
    v_mfma_f32_16x16x32_bf16 v[196:199], a[96:99], a[64:67], 0
    v_exp_f32_e64 v207, v207
    v_mfma_f32_16x16x32_bf16 v[196:199], a[100:103], a[68:71], v[196:199]
    ds_write_b128 v3, a[140:143] offset:7168
    v_mfma_f32_16x16x32_bf16 v[196:199], a[104:107], a[72:75], v[196:199]
    v_cvt_pk_bf16_f32 v224, v204, v205
    v_cvt_pk_bf16_f32 v225, v206, v207
    v_mfma_f32_16x16x32_bf16 v[196:199], a[108:111], a[76:79], v[196:199]
    v_exp_f32_e64 v208, v208
    v_mfma_f32_16x16x32_bf16 v[200:203], a[220:223], a[76:79], 0
    v_exp_f32_e64 v209, v209
    v_mfma_f32_16x16x32_bf16 v[200:203], a[216:219], a[72:75], v[200:203]
    v_exp_f32_e64 v210, v210
    v_mfma_f32_16x16x32_bf16 v[200:203], a[212:215], a[68:71], v[200:203]
    v_exp_f32_e64 v211, v211
    s_waitcnt lgkmcnt(0)
    s_barrier
    v_mfma_f32_16x16x32_bf16 v[200:203], a[208:211], a[64:67], v[200:203]
    ds_read_b32 v252, v7 offset:32768
    ds_read_b128 v[180:183], v6
    v_mfma_f32_16x16x32_bf16 v[28:31], v[156:159], v[232:235], v[28:31]
    ds_read_b128 v[184:187], v6 offset:1024
    ds_read_b128 v[172:175], v6 offset:2048
    v_mfma_f32_16x16x32_bf16 v[28:31], a[48:51], v[228:231], v[28:31]
    ds_read_b128 v[176:179], v6 offset:3072
    ds_read_b128 v[164:167], v6 offset:4096
    v_mfma_f32_16x16x32_bf16 v[32:35], v[160:163], v[232:235], v[32:35]
    ds_read_b128 v[168:171], v6 offset:5120
    v_cvt_pk_bf16_f32 v226, v208, v209
    v_mfma_f32_16x16x32_bf16 v[32:35], a[52:55], v[228:231], v[32:35]
    v_exp_f32_e64 v196, v196
    v_mfma_f32_16x16x32_bf16 v[36:39], a[248:251], v[232:235], v[36:39]
    v_exp_f32_e64 v197, v197
    v_mfma_f32_16x16x32_bf16 v[36:39], a[56:59], v[228:231], v[36:39]
    v_exp_f32_e64 v198, v198
    v_mfma_f32_16x16x32_bf16 v[40:43], a[252:255], v[232:235], v[40:43]
    v_cvt_pk_bf16_f32 v227, v210, v211
    s_waitcnt lgkmcnt(6)
    v_add_f32 v240, v240, v252
    v_rcp_f32 v242, v240
    s_waitcnt lgkmcnt(4)
    v_pk_add_f32 v[12:13], v[12:13], v[180:181]
    v_pk_add_f32 v[14:15], v[14:15], v[182:183]
    v_pk_add_f32 v[16:17], v[16:17], v[184:185]
    v_pk_add_f32 v[18:19], v[18:19], v[186:187]
    v_pk_mul_f32 v[12:13], v[12:13], v[242:243] op_sel_hi:[1,0]
    v_pk_mul_f32 v[14:15], v[14:15], v[242:243] op_sel_hi:[1,0]
    v_pk_mul_f32 v[16:17], v[16:17], v[242:243] op_sel_hi:[1,0]
    v_pk_mul_f32 v[18:19], v[18:19], v[242:243] op_sel_hi:[1,0]
    s_waitcnt lgkmcnt(2)
    v_pk_add_f32 v[20:21], v[20:21], v[172:173]
    v_pk_add_f32 v[22:23], v[22:23], v[174:175]
    v_pk_add_f32 v[24:25], v[24:25], v[176:177]
    v_pk_add_f32 v[26:27], v[26:27], v[178:179]
    s_waitcnt lgkmcnt(0)
    v_pk_add_f32 v[28:29], v[28:29], v[164:165]
    v_pk_add_f32 v[30:31], v[30:31], v[166:167]
    v_pk_add_f32 v[32:33], v[32:33], v[168:169]
    v_pk_add_f32 v[34:35], v[34:35], v[170:171]
    v_pk_mul_f32 v[20:21], v[20:21], v[242:243] op_sel_hi:[1,0]
    v_pk_mul_f32 v[22:23], v[22:23], v[242:243] op_sel_hi:[1,0]
    v_pk_mul_f32 v[24:25], v[24:25], v[242:243] op_sel_hi:[1,0]
    v_pk_mul_f32 v[26:27], v[26:27], v[242:243] op_sel_hi:[1,0]
    v_pk_mul_f32 v[28:29], v[28:29], v[242:243] op_sel_hi:[1,0]
    v_pk_mul_f32 v[30:31], v[30:31], v[242:243] op_sel_hi:[1,0]
    v_pk_mul_f32 v[32:33], v[32:33], v[242:243] op_sel_hi:[1,0]
    v_pk_mul_f32 v[34:35], v[34:35], v[242:243] op_sel_hi:[1,0]
    v_mfma_f32_16x16x32_bf16 v[40:43], a[60:63], v[228:231], v[40:43]
    ds_read_b128 v[180:183], v6 offset:6144
    ds_read_b128 v[184:187], v6 offset:7168
    v_mfma_f32_16x16x32_bf16 v[204:207], v[108:111], a[16:19], 0
    v_exp_f32_e64 v199, v199
    v_mfma_f32_16x16x32_bf16 v[204:207], v[112:115], a[20:23], v[204:207]
    v_exp_f32_e64 v200, v200
    v_mfma_f32_16x16x32_bf16 v[204:207], v[116:119], a[24:27], v[204:207]
    v_exp_f32_e64 v201, v201
    v_mfma_f32_16x16x32_bf16 v[204:207], v[120:123], a[28:31], v[204:207]
    v_cvt_pk_bf16_f32 v12, v12, v13
    v_cvt_pk_bf16_f32 v13, v14, v15
    v_mfma_f32_16x16x32_bf16 v[208:211], v[136:139], a[28:31], 0
    v_cvt_pk_bf16_f32 v14, v16, v17
    v_cvt_pk_bf16_f32 v15, v18, v19
    v_mfma_f32_16x16x32_bf16 v[208:211], v[132:135], a[24:27], v[208:211]
    buffer_store_dwordx4 v[12:15], v11, s[32:35], s97 offen nt sc1
    v_exp_f32 v202, v202
    s_waitcnt lgkmcnt(0)
    v_pk_add_f32 v[36:37], v[36:37], v[180:181]
    v_pk_add_f32 v[38:39], v[38:39], v[182:183]
    v_pk_add_f32 v[40:41], v[40:41], v[184:185]
    v_pk_add_f32 v[42:43], v[42:43], v[186:187]
    v_pk_mul_f32 v[36:37], v[36:37], v[242:243] op_sel_hi:[1,0]
    v_pk_mul_f32 v[38:39], v[38:39], v[242:243] op_sel_hi:[1,0]
    v_pk_mul_f32 v[40:41], v[40:41], v[242:243] op_sel_hi:[1,0]
    v_pk_mul_f32 v[42:43], v[42:43], v[242:243] op_sel_hi:[1,0]
    v_mfma_f32_16x16x32_bf16 v[208:211], v[128:131], a[20:23], v[208:211]
    v_cvt_pk_bf16_f32 v228, v196, v197
    v_cvt_pk_bf16_f32 v229, v198, v199
    v_exp_f32_e64 v203, v203
    v_mfma_f32_16x16x32_bf16 v[208:211], v[124:127], a[16:19], v[208:211]
    v_cvt_pk_bf16_f32 v230, v200, v201
    v_cvt_pk_bf16_f32 v231, v202, v203
    v_smfmac_f32_16x16x64_bf16 v[244:247], a[244:247], v[220:227], v5
    v_cvt_pk_bf16_f32 v20, v20, v21
    v_mfma_f32_16x16x32_bf16 a[144:147], v[140:143], v[224:227], a[144:147]
    v_cvt_pk_bf16_f32 v21, v22, v23
    v_cvt_pk_bf16_f32 v22, v24, v25
    v_mfma_f32_16x16x32_bf16 a[144:147], a[224:227], v[228:231], a[144:147]
    v_cvt_pk_bf16_f32 v23, v26, v27
    v_max3_u32 v193, v193, v240, v242
    v_mfma_f32_16x16x32_bf16 a[148:151], v[144:147], v[224:227], a[148:151]
    v_cvt_pk_bf16_f32 v28, v28, v29
    v_cvt_pk_bf16_f32 v29, v30, v31
    v_mfma_f32_16x16x32_bf16 a[148:151], a[228:231], v[228:231], a[148:151]
    v_cvt_pk_bf16_f32 v30, v32, v33
    v_cvt_pk_bf16_f32 v31, v34, v35
    v_mfma_f32_16x16x32_bf16 a[152:155], v[148:151], v[224:227], a[152:155]
    ds_write_b128 v3, a[144:147] offset:32768
    v_mfma_f32_16x16x32_bf16 a[152:155], a[232:235], v[228:231], a[152:155]
    buffer_store_dwordx4 v[20:23], v11, s[32:35], s97 offen offset:64 nt sc1
    v_add_f32_e64 v246, v246, v247
    v_cvt_pk_bf16_f32 v36, v36, v37
    v_mfma_f32_16x16x32_bf16 a[156:159], v[152:155], v[224:227], a[156:159]
    ds_write_b128 v3, a[148:151] offset:33792
    v_mfma_f32_16x16x32_bf16 a[156:159], a[236:239], v[228:231], a[156:159]
    v_exp_f32_e64 v204, v204
    v_mfma_f32_16x16x32_bf16 v[196:199], a[96:99], a[16:19], 0
    v_exp_f32_e64 v205, v205
    v_mfma_f32_16x16x32_bf16 v[196:199], a[100:103], a[20:23], v[196:199]
    ds_write_b128 v3, a[152:155] offset:34816
    v_mfma_f32_16x16x32_bf16 v[196:199], a[104:107], a[24:27], v[196:199]
    v_exp_f32_e64 v206, v206
    v_mfma_f32_16x16x32_bf16 v[196:199], a[108:111], a[28:31], v[196:199]
    v_exp_f32_e64 v207, v207
    v_mfma_f32_16x16x32_bf16 v[200:203], a[220:223], a[28:31], 0
    ds_write_b128 v3, a[156:159] offset:35840
    v_mfma_f32_16x16x32_bf16 v[200:203], a[216:219], a[24:27], v[200:203]
    v_cvt_pk_bf16_f32 v212, v204, v205
    v_cvt_pk_bf16_f32 v213, v206, v207
    v_mfma_f32_16x16x32_bf16 v[200:203], a[212:215], a[20:23], v[200:203]
    buffer_store_dwordx4 v[28:31], v11, s[32:35], s97 offen offset:128 nt sc1
    v_exp_f32_e64 v208, v208
    v_mfma_f32_16x16x32_bf16 v[200:203], a[208:211], a[16:19], v[200:203]
    v_exp_f32_e64 v196, v196
    v_mfma_f32_16x16x32_bf16 v[244:247], a[244:247], v[228:231], v[244:247]
    v_cvt_pk_bf16_f32 v37, v38, v39
    v_cvt_pk_bf16_f32 v38, v40, v41
    v_mfma_f32_16x16x32_bf16 a[160:163], v[156:159], v[224:227], a[160:163]
    v_exp_f32_e64 v209, v209
    v_mfma_f32_16x16x32_bf16 a[160:163], a[48:51], v[228:231], a[160:163]
    v_cvt_pk_bf16_f32 v39, v42, v43
    v_cvt_pk_bf16_f32 v214, v208, v209
    v_mfma_f32_16x16x32_bf16 a[164:167], v[160:163], v[224:227], a[164:167]
    v_exp_f32_e64 v197, v197
    v_mfma_f32_16x16x32_bf16 a[164:167], a[52:55], v[228:231], a[164:167]
    v_exp_f32_e64 v210, v210
    v_mfma_f32_16x16x32_bf16 a[168:171], a[248:251], v[224:227], a[168:171]
    v_exp_f32_e64 v198, v198
    v_mfma_f32_16x16x32_bf16 a[168:171], a[56:59], v[228:231], a[168:171]
    ds_write_b32 v4, v246 offset:32772
    v_mfma_f32_16x16x32_bf16 a[172:175], a[252:255], v[224:227], a[172:175]
    v_exp_f32_e64 v211, v211
    v_mfma_f32_16x16x32_bf16 a[172:175], a[60:63], v[228:231], a[172:175]
    ds_write_b128 v3, a[160:163] offset:36864
    v_mfma_f32_16x16x32_bf16 v[204:207], v[108:111], a[80:83], 0
    buffer_store_dwordx4 v[36:39], v11, s[32:35], s97 offen offset:192 nt sc1
    v_exp_f32_e64 v199, v199
    v_mfma_f32_16x16x32_bf16 v[204:207], v[112:115], a[84:87], v[204:207]
    ds_write_b128 v3, a[164:167] offset:37888
    v_cvt_pk_bf16_f32 v215, v210, v211
    v_exp_f32_e64 v200, v200
    v_mfma_f32_16x16x32_bf16 v[204:207], v[116:119], a[88:91], v[204:207]
    v_exp_f32_e64 v201, v201
    v_mfma_f32_16x16x32_bf16 v[204:207], v[120:123], a[92:95], v[204:207]
    ds_write_b128 v3, a[168:171] offset:38912
    v_exp_f32_e64 v202, v202
    v_mfma_f32_16x16x32_bf16 v[208:211], v[136:139], a[92:95], 0
    v_cvt_pk_bf16_f32 v216, v196, v197
    v_cvt_pk_bf16_f32 v217, v198, v199
    v_exp_f32_e64 v203, v203
    v_mfma_f32_16x16x32_bf16 v[208:211], v[132:135], a[88:91], v[208:211]
    ds_write_b128 v3, a[172:175] offset:39936
    v_cvt_pk_bf16_f32 v218, v200, v201
    v_cvt_pk_bf16_f32 v219, v202, v203
    v_mfma_f32_16x16x32_bf16 v[208:211], v[128:131], a[84:87], v[208:211]
    v_exp_f32_e64 v204, v204
    v_mfma_f32_16x16x32_bf16 v[208:211], v[124:127], a[80:83], v[208:211]
    v_exp_f32_e64 v205, v205
    v_smfmac_f32_16x16x64_bf16 v[244:247], a[240:243], v[212:219], v5
    v_cvt_pk_bf16_f32 v232, v204, v205
    v_mfma_f32_16x16x32_bf16 v[44:47], v[140:143], v[212:215], v[44:47]
    v_exp_f32_e64 v206, v206
    v_mfma_f32_16x16x32_bf16 v[44:47], a[224:227], v[216:219], v[44:47]
    s_waitcnt lgkmcnt(0)
    s_barrier
    v_mfma_f32_16x16x32_bf16 v[48:51], v[144:147], v[212:215], v[48:51]
    ds_read_b32 v253, v7 offset:32772
    ds_read_b128 v[12:15], v6 offset:32768
    v_mfma_f32_16x16x32_bf16 v[48:51], a[228:231], v[216:219], v[48:51]
    v_add_f32_e64 v244, v244, v245
    ds_read_b128 v[16:19], v6 offset:33792
    v_mfma_f32_16x16x32_bf16 v[52:55], v[148:151], v[212:215], v[52:55]
    ds_read_b128 v[20:23], v6 offset:34816
    ds_read_b128 v[24:27], v6 offset:35840
    v_mfma_f32_16x16x32_bf16 v[52:55], a[232:235], v[216:219], v[52:55]
    v_exp_f32_e64 v207, v207
    v_mfma_f32_16x16x32_bf16 v[56:59], v[152:155], v[212:215], v[56:59]
    v_exp_f32_e64 v208, v208
    v_mfma_f32_16x16x32_bf16 v[56:59], a[236:239], v[216:219], v[56:59]
    ds_read_b128 v[28:31], v6 offset:36864
    ds_read_b128 v[32:35], v6 offset:37888
    v_mfma_f32_16x16x32_bf16 v[196:199], a[96:99], a[80:83], 0
    v_exp_f32_e64 v209, v209
    v_mfma_f32_16x16x32_bf16 v[196:199], a[100:103], a[84:87], v[196:199]
    v_exp_f32_e64 v210, v210
    v_mfma_f32_16x16x32_bf16 v[196:199], a[104:107], a[88:91], v[196:199]
    s_waitcnt lgkmcnt(6)
    v_add_f32 v244, v244, v253
    v_mfma_f32_16x16x32_bf16 v[196:199], a[108:111], a[92:95], v[196:199]
    v_rcp_f32_e64 v246, v244
    v_mfma_f32_16x16x32_bf16 v[200:203], a[220:223], a[92:95], 0
    v_cvt_pk_bf16_f32 v233, v206, v207
    ds_read_b128 v[36:39], v6 offset:38912
    v_mfma_f32_16x16x32_bf16 v[200:203], a[216:219], a[88:91], v[200:203]
    v_exp_f32_e64 v211, v211
    v_mfma_f32_16x16x32_bf16 v[200:203], a[212:215], a[84:87], v[200:203]
    ds_read_b128 v[40:43], v6 offset:39936
    v_cvt_pk_bf16_f32 v234, v208, v209
    v_mfma_f32_16x16x32_bf16 v[200:203], a[208:211], a[80:83], v[200:203]
    v_cvt_pk_bf16_f32 v235, v210, v211
    v_max3_u32 v193, v193, v244, v246
    v_mfma_f32_16x16x32_bf16 v[60:63], v[156:159], v[212:215], v[60:63]
    v_exp_f32 v196, v196
    v_exp_f32 v197, v197
    s_waitcnt lgkmcnt(6)
    v_pk_add_f32 v[44:45], v[44:45], v[12:13]
    v_pk_add_f32 v[46:47], v[46:47], v[14:15]
    v_pk_add_f32 v[48:49], v[48:49], v[16:17]
    v_pk_add_f32 v[50:51], v[50:51], v[18:19]
    v_pk_mul_f32 v[44:45], v[44:45], v[246:247] op_sel_hi:[1,0]
    v_pk_mul_f32 v[46:47], v[46:47], v[246:247] op_sel_hi:[1,0]
    v_pk_mul_f32 v[48:49], v[48:49], v[246:247] op_sel_hi:[1,0]
    v_pk_mul_f32 v[50:51], v[50:51], v[246:247] op_sel_hi:[1,0]
    s_waitcnt lgkmcnt(4)
    v_pk_add_f32 v[52:53], v[52:53], v[20:21]
    v_pk_add_f32 v[54:55], v[54:55], v[22:23]
    v_pk_add_f32 v[56:57], v[56:57], v[24:25]
    v_pk_add_f32 v[58:59], v[58:59], v[26:27]
    v_pk_mul_f32 v[52:53], v[52:53], v[246:247] op_sel_hi:[1,0]
    v_pk_mul_f32 v[54:55], v[54:55], v[246:247] op_sel_hi:[1,0]
    v_pk_mul_f32 v[56:57], v[56:57], v[246:247] op_sel_hi:[1,0]
    v_pk_mul_f32 v[58:59], v[58:59], v[246:247] op_sel_hi:[1,0]
    v_mfma_f32_16x16x32_bf16 v[60:63], a[48:51], v[216:219], v[60:63]
    v_cvt_pk_bf16_f32 v44, v44, v45
    v_cvt_pk_bf16_f32 v45, v46, v47
    v_mfma_f32_16x16x32_bf16 v[64:67], v[160:163], v[212:215], v[64:67]
    v_cvt_pk_bf16_f32 v46, v48, v49
    v_cvt_pk_bf16_f32 v47, v50, v51
    v_mfma_f32_16x16x32_bf16 v[64:67], a[52:55], v[216:219], v[64:67]
    buffer_store_dwordx4 v[44:47], v11, s[32:35], s60 offen nt sc1
    v_exp_f32_e64 v198, v198
    v_mfma_f32_16x16x32_bf16 v[68:71], a[248:251], v[212:215], v[68:71]
    v_exp_f32_e64 v199, v199
    v_mfma_f32_16x16x32_bf16 v[68:71], a[56:59], v[216:219], v[68:71]
    v_exp_f32_e64 v200, v200
    v_mfma_f32_16x16x32_bf16 v[72:75], a[252:255], v[212:215], v[72:75]
    v_exp_f32_e64 v201, v201
    v_mfma_f32_16x16x32_bf16 v[72:75], a[60:63], v[216:219], v[72:75]
    v_exp_f32_e64 v202, v202
    v_cvt_pk_bf16_f32 v220, v196, v197
    v_cvt_pk_bf16_f32 v221, v198, v199
    v_cvt_pk_bf16_f32 v222, v200, v201
    s_waitcnt lgkmcnt(2)
    v_pk_add_f32 v[60:61], v[60:61], v[28:29]
    v_pk_add_f32 v[62:63], v[62:63], v[30:31]
    v_pk_add_f32 v[64:65], v[64:65], v[32:33]
    v_pk_add_f32 v[66:67], v[66:67], v[34:35]
    s_waitcnt lgkmcnt(0)
    v_pk_add_f32 v[68:69], v[68:69], v[36:37]
    v_pk_add_f32 v[70:71], v[70:71], v[38:39]
    v_pk_add_f32 v[72:73], v[72:73], v[40:41]
    v_pk_add_f32 v[74:75], v[74:75], v[42:43]
    v_pk_mul_f32 v[60:61], v[60:61], v[246:247] op_sel_hi:[1,0]
    v_pk_mul_f32 v[62:63], v[62:63], v[246:247] op_sel_hi:[1,0]
    v_pk_mul_f32 v[64:65], v[64:65], v[246:247] op_sel_hi:[1,0]
    v_pk_mul_f32 v[66:67], v[66:67], v[246:247] op_sel_hi:[1,0]
    v_pk_mul_f32 v[68:69], v[68:69], v[246:247] op_sel_hi:[1,0]
    v_pk_mul_f32 v[70:71], v[70:71], v[246:247] op_sel_hi:[1,0]
    v_pk_mul_f32 v[72:73], v[72:73], v[246:247] op_sel_hi:[1,0]
    v_pk_mul_f32 v[74:75], v[74:75], v[246:247] op_sel_hi:[1,0]
    v_smfmac_f32_16x16x64_bf16 v[248:251], a[244:247], v[232:239], v5
    v_cvt_pk_bf16_f32 v52, v52, v53
    v_mfma_f32_16x16x32_bf16 v[204:207], v[108:111], a[32:35], 0
    v_exp_f32_e64 v203, v203
    v_mfma_f32_16x16x32_bf16 v[204:207], v[112:115], a[36:39], v[204:207]
    v_cvt_pk_bf16_f32 v223, v202, v203
    v_cvt_pk_bf16_f32 v53, v54, v55
    v_mfma_f32_16x16x32_bf16 v[204:207], v[116:119], a[40:43], v[204:207]
    v_cvt_pk_bf16_f32 v54, v56, v57
    v_add_f32_e64 v250, v250, v251
    v_mfma_f32_16x16x32_bf16 v[204:207], v[120:123], a[44:47], v[204:207]
    v_cvt_pk_bf16_f32 v55, v58, v59
    v_cvt_pk_bf16_f32 v60, v60, v61
    v_mfma_f32_16x16x32_bf16 v[208:211], v[136:139], a[44:47], 0
    buffer_store_dwordx4 v[52:55], v11, s[32:35], s60 offen offset:64 nt sc1
    v_cvt_pk_bf16_f32 v61, v62, v63
    v_cvt_pk_bf16_f32 v62, v64, v65
    v_mfma_f32_16x16x32_bf16 v[208:211], v[132:135], a[40:43], v[208:211]
    v_cvt_pk_bf16_f32 v63, v66, v67
    v_cvt_pk_bf16_f32 v68, v68, v69
    v_mfma_f32_16x16x32_bf16 v[208:211], v[128:131], a[36:39], v[208:211]
    v_exp_f32_e64 v204, v204
    v_mfma_f32_16x16x32_bf16 v[208:211], v[124:127], a[32:35], v[208:211]
    v_exp_f32_e64 v205, v205
    v_mfma_f32_16x16x32_bf16 v[248:251], a[244:247], v[220:223], v[248:251]
    v_exp_f32_e64 v206, v206
    v_mfma_f32_16x16x32_bf16 a[176:179], v[140:143], v[232:235], a[176:179]
    v_exp_f32_e64 v207, v207
    v_mfma_f32_16x16x32_bf16 a[176:179], a[224:227], v[220:223], a[176:179]
    v_cvt_pk_bf16_f32 v69, v70, v71
    v_cvt_pk_bf16_f32 v70, v72, v73
    v_mfma_f32_16x16x32_bf16 a[180:183], v[144:147], v[232:235], a[180:183]
    v_exp_f32_e64 v208, v208
    v_mfma_f32_16x16x32_bf16 a[180:183], a[228:231], v[220:223], a[180:183]
    ds_write_b32 v4, v250 offset:32776
    v_mfma_f32_16x16x32_bf16 a[184:187], v[148:151], v[232:235], a[184:187]
    v_cvt_pk_bf16_f32 v71, v74, v75
    v_cvt_pk_bf16_f32 v212, v204, v205
    v_mfma_f32_16x16x32_bf16 a[184:187], a[232:235], v[220:223], a[184:187]
    ds_write_b128 v4, a[176:179]
    v_mfma_f32_16x16x32_bf16 a[188:191], v[152:155], v[232:235], a[188:191]
    buffer_store_dwordx4 v[60:63], v11, s[32:35], s60 offen offset:128 nt sc1
    v_exp_f32_e64 v209, v209
    v_mfma_f32_16x16x32_bf16 a[188:191], a[236:239], v[220:223], a[188:191]
    ds_write_b128 v4, a[180:183] offset:1024
    v_mfma_f32_16x16x32_bf16 v[196:199], a[96:99], a[32:35], 0
    v_exp_f32_e64 v210, v210
    v_mfma_f32_16x16x32_bf16 v[196:199], a[100:103], a[36:39], v[196:199]
    v_cvt_pk_bf16_f32 v213, v206, v207
    v_cvt_pk_bf16_f32 v214, v208, v209
    v_mfma_f32_16x16x32_bf16 v[196:199], a[104:107], a[40:43], v[196:199]
    ds_write_b128 v4, a[184:187] offset:2048
    v_mfma_f32_16x16x32_bf16 v[196:199], a[108:111], a[44:47], v[196:199]
    v_exp_f32 v211, v211
    v_mfma_f32_16x16x32_bf16 v[200:203], a[220:223], a[44:47], 0
    v_cvt_pk_bf16_f32 v215, v210, v211
    s_nop 0
    v_mfma_f32_16x16x32_bf16 v[200:203], a[216:219], a[40:43], v[200:203]
    ds_write_b128 v4, a[188:191] offset:3072
    v_mfma_f32_16x16x32_bf16 v[200:203], a[212:215], a[36:39], v[200:203]
    s_nop 0
    v_exp_f32 v196, v196
    v_exp_f32_e64 v197, v197
    v_mfma_f32_16x16x32_bf16 v[200:203], a[208:211], a[32:35], v[200:203]
    buffer_store_dwordx4 v[68:71], v11, s[32:35], s60 offen offset:192 nt sc1
    v_exp_f32_e64 v198, v198
    v_mfma_f32_16x16x32_bf16 a[192:195], v[156:159], v[232:235], a[192:195]
    v_exp_f32_e64 v199, v199
    s_waitcnt lgkmcnt(0)
    s_barrier
    v_mfma_f32_16x16x32_bf16 a[192:195], a[48:51], v[220:223], a[192:195]
    ds_read_b32 v254, v7 offset:32776
    ds_read_b128 v[180:183], v7
    v_exp_f32_e64 v200, v200
    ds_read_b128 v[184:187], v7 offset:1024
    v_mfma_f32_16x16x32_bf16 a[196:199], v[160:163], v[232:235], a[196:199]
    v_exp_f32_e64 v201, v201
    v_mfma_f32_16x16x32_bf16 a[196:199], a[52:55], v[220:223], a[196:199]
    v_exp_f32_e64 v202, v202
    v_mfma_f32_16x16x32_bf16 a[200:203], a[248:251], v[232:235], a[200:203]
    v_cvt_pk_bf16_f32 v216, v196, v197
    v_cvt_pk_bf16_f32 v217, v198, v199
    v_exp_f32 v203, v203
    ds_read_b128 v[172:175], v7 offset:2048
    ds_read_b128 v[176:179], v7 offset:3072
    v_mfma_f32_16x16x32_bf16 a[200:203], a[56:59], v[220:223], a[200:203]
    v_cvt_pk_bf16_f32 v218, v200, v201
    v_cvt_pk_bf16_f32 v219, v202, v203
    v_mfma_f32_16x16x32_bf16 a[204:207], a[252:255], v[232:235], a[204:207]
    ds_write_b128 v4, a[192:195] offset:4096
    s_waitcnt lgkmcnt(3)
    v_pk_add_f32 v[76:77], v[76:77], v[180:181]
    v_pk_add_f32 v[78:79], v[78:79], v[182:183]
    v_pk_add_f32 v[80:81], v[80:81], v[184:185]
    v_pk_add_f32 v[82:83], v[82:83], v[186:187]
    v_mfma_f32_16x16x32_bf16 a[204:207], a[60:63], v[220:223], a[204:207]
    s_nop 0
    s_nop 0
    v_smfmac_f32_16x16x64_bf16 v[248:251], a[240:243], v[212:219], v5
    ds_write_b128 v4, a[196:199] offset:5120
    v_mfma_f32_16x16x32_bf16 v[76:79], v[140:143], v[212:215], v[76:79]
    s_nop 0
    s_nop 0
    v_mfma_f32_16x16x32_bf16 v[76:79], a[224:227], v[216:219], v[76:79]
    s_nop 0
    s_nop 0
    v_mfma_f32_16x16x32_bf16 v[80:83], v[144:147], v[212:215], v[80:83]
    ds_write_b128 v4, a[200:203] offset:6144
    v_mfma_f32_16x16x32_bf16 v[80:83], a[228:231], v[216:219], v[80:83]
    v_add_f32 v248, v248, v249
    s_nop 0
    v_mfma_f32_16x16x32_bf16 v[84:87], v[148:151], v[212:215], v[84:87]
    v_add_f32 v248, v248, v254
    v_rcp_f32 v250, v248
    v_mfma_f32_16x16x32_bf16 v[84:87], a[232:235], v[216:219], v[84:87]
    ds_write_b128 v4, a[204:207] offset:7168
    v_max3_u32 v193, v193, v248, v250
    v_mfma_f32_16x16x32_bf16 v[88:91], v[152:155], v[212:215], v[88:91]
    v_mul_f32 v76, v76, v250
    v_mul_f32 v77, v77, v250
    v_mul_f32 v78, v78, v250
    v_mul_f32 v79, v79, v250
    v_mul_f32 v80, v80, v250
    v_mul_f32 v81, v81, v250
    v_mul_f32 v82, v82, v250
    v_mul_f32 v83, v83, v250
    ds_write_b32 v4, v193 offset:32780
    v_mfma_f32_16x16x32_bf16 v[88:91], a[236:239], v[216:219], v[88:91]
    v_cvt_pk_bf16_f32 v76, v76, v77
    v_cvt_pk_bf16_f32 v77, v78, v79
    v_mfma_f32_16x16x32_bf16 v[92:95], v[156:159], v[212:215], v[92:95]
    v_cvt_pk_bf16_f32 v78, v80, v81
    v_cvt_pk_bf16_f32 v79, v82, v83
    s_waitcnt lgkmcnt(0)
    s_barrier
    ds_read_b128 v[164:167], v7 offset:4096
    ds_read_b128 v[168:171], v7 offset:5120
    ds_read_b128 v[12:15], v7 offset:6144
    ds_read_b128 v[16:19], v7 offset:7168
    v_mfma_f32_16x16x32_bf16 v[92:95], a[48:51], v[216:219], v[92:95]
    buffer_store_dwordx4 v[76:79], v11, s[32:35], s61 offen nt sc1
    v_add_f32_e64 v84, v84, v172
    v_mfma_f32_16x16x32_bf16 v[96:99], v[160:163], v[212:215], v[96:99]
    v_add_f32 v85, v85, v173
    v_add_f32 v86, v86, v174
    v_mfma_f32_16x16x32_bf16 v[96:99], a[52:55], v[216:219], v[96:99]
    v_add_f32 v87, v87, v175
    v_add_f32 v88, v88, v176
    v_mfma_f32_16x16x32_bf16 v[100:103], a[248:251], v[212:215], v[100:103]
    v_add_f32 v89, v89, v177
    v_add_f32 v90, v90, v178
    v_mfma_f32_16x16x32_bf16 v[100:103], a[56:59], v[216:219], v[100:103]
    v_add_f32 v91, v91, v179
    v_mul_f32 v84, v84, v250
    v_mfma_f32_16x16x32_bf16 v[104:107], a[252:255], v[212:215], v[104:107]
    v_mul_f32 v85, v85, v250
    v_mul_f32 v86, v86, v250
    v_mul_f32 v87, v87, v250
    v_mul_f32 v88, v88, v250
    v_mul_f32 v89, v89, v250
    s_waitcnt lgkmcnt(2)
    v_pk_add_f32 v[92:93], v[92:93], v[164:165]
    v_pk_add_f32 v[94:95], v[94:95], v[166:167]
    v_pk_add_f32 v[96:97], v[96:97], v[168:169]
    v_pk_add_f32 v[98:99], v[98:99], v[170:171]
    v_pk_mul_f32 v[92:93], v[92:93], v[250:251] op_sel_hi:[1,0]
    v_pk_mul_f32 v[94:95], v[94:95], v[250:251] op_sel_hi:[1,0]
    v_pk_mul_f32 v[96:97], v[96:97], v[250:251] op_sel_hi:[1,0]
    v_pk_mul_f32 v[98:99], v[98:99], v[250:251] op_sel_hi:[1,0]
    v_mfma_f32_16x16x32_bf16 v[104:107], a[60:63], v[216:219], v[104:107]
    v_mul_f32_e64 v90, v90, v250
    v_mul_f32 v91, v91, v250
    v_cvt_pk_bf16_f32 v84, v84, v85
    v_cvt_pk_bf16_f32 v85, v86, v87
    v_cvt_pk_bf16_f32 v86, v88, v89
    v_cvt_pk_bf16_f32 v87, v90, v91
    buffer_store_dwordx4 v[84:87], v11, s[32:35], s61 offen offset:64 nt sc1
    v_cvt_pk_bf16_f32 v92, v92, v93
    s_waitcnt lgkmcnt(0)
    v_pk_add_f32 v[100:101], v[100:101], v[12:13]
    v_pk_add_f32 v[102:103], v[102:103], v[14:15]
    v_pk_add_f32 v[104:105], v[104:105], v[16:17]
    v_pk_add_f32 v[106:107], v[106:107], v[18:19]
    v_cvt_pk_bf16_f32 v93, v94, v95
    v_cvt_pk_bf16_f32 v94, v96, v97
    v_cvt_pk_bf16_f32 v95, v98, v99
    buffer_store_dwordx4 v[92:95], v11, s[32:35], s61 offen offset:128 nt sc1
    v_pk_mul_f32 v[100:101], v[100:101], v[250:251] op_sel_hi:[1,0]
    v_pk_mul_f32 v[102:103], v[102:103], v[250:251] op_sel_hi:[1,0]
    v_pk_mul_f32 v[104:105], v[104:105], v[250:251] op_sel_hi:[1,0]
    v_pk_mul_f32 v[106:107], v[106:107], v[250:251] op_sel_hi:[1,0]
    v_cvt_pk_bf16_f32 v100, v100, v101
    v_cvt_pk_bf16_f32 v101, v102, v103
    v_cvt_pk_bf16_f32 v102, v104, v105
    v_cvt_pk_bf16_f32 v103, v106, v107
    buffer_store_dwordx4 v[100:103], v11, s[32:35], s61 offen offset:192 nt sc1
    s_barrier
    ds_read2st64_b32 v[224:225], v9 offset0:0 offset1:32
    ds_read2st64_b32 v[226:227], v9 offset0:64 offset1:96
    s_waitcnt lgkmcnt(0)
    v_max3_u32 v224, v224, v225, v226
    v_max_u32 v224, v224, v227
    v_cmp_lt_u32 vcc, s63, v224
    s_nop 1
    s_and_b64 vcc, vcc, vcc
    s_cbranch_scc1 L_fallback
L_end:
    s_endpgm
L_fallback:
    s_mov_b64 s[66:67], 0
    s_waitcnt vmcnt(0) lgkmcnt(0)
    s_barrier
X_start:
    s_load_dwordx8 s[4:11], s[0:1], 0
    v_lshrrev_b32 v229, 6, v0
    v_and_b32 v228, 63, v0
    v_readfirstlane_b32 s36, v229
    s_and_b32 s93, s2, 7
    s_lshr_b32 s94, s2, 4
    s_lshl3_add_u32 s93, s94, s93
    v_bfe_u32 v229, v228, 2, 2
    v_lshlrev_b32_e64 v235, 8, v229
    s_bfe_u32 s94, s2, 0x10003
    s_lshl1_add_u32 s94, s93, s94
    v_lshrrev_b32 v230, 4, v228
    v_lshl_add_u32 v235, v230, 6, v235
    s_mul_i32 s3, s94, 53248
    s_lshl_b32 s93, s93, 19
    s_lshl_b32 s37, s36, 13
    v_and_b32_e64 v231, 3, v228
    v_lshl_add_u32 v235, v231, 4, v235
    v_add_u32 v6, s37, v235
    v_xor_b32 v7, 16, v6
    v_xor_b32 v8, 32, v6
    v_xor_b32 v9, 48, v6
    s_mul_i32 s95, s36, 1040
    v_xor_b32_e64 v13, s95, v235
    s_mov_b32 s90, 524288
    s_mov_b32 s91, 0x00020000
    s_mov_b32 s14, 53248
    s_mov_b32 s15, 0x00020000
    s_mov_b32 s94, 4096
    s_add_u32 m0, s37, 0
    s_waitcnt lgkmcnt(0)
    s_add_u32 s88, s6, s93
    s_addc_u32 s89, s7, 0
    buffer_load_dwordx4 v6, s[88:91], 0 offen nt lds
    buffer_load_dwordx4 v7, s[88:91], 0 offen offset:1024 nt lds
    buffer_load_dwordx4 v8, s[88:91], 0 offen offset:2048 nt lds
    buffer_load_dwordx4 v9, s[88:91], 0 offen offset:3072 nt lds
    s_add_u32 m0, s37, 4096
    s_nop 0
    buffer_load_dwordx4 v6, s[88:91], s94 offen nt lds
    buffer_load_dwordx4 v7, s[88:91], s94 offen offset:1024 nt lds
    buffer_load_dwordx4 v8, s[88:91], s94 offen offset:2048 nt lds
    buffer_load_dwordx4 v9, s[88:91], s94 offen offset:3072 nt lds
    s_add_u32 s12, s4, s3
    s_addc_u32 s13, s5, 0
    s_mov_b32 s95, 49152
    buffer_load_dwordx4 v[16:19], v13, s[12:15], s95 offen nt
    s_mov_b32 s95, 0
    buffer_load_dwordx4 v[20:23], v13, s[12:15], s95 offen nt
    s_mov_b32 s95, 12288
    buffer_load_dwordx4 v[24:27], v13, s[12:15], s95 offen nt
X_setup:
    v_lshlrev_b32_e64 v5, 10, v230
    v_lshl_add_u32 v5, v229, 6, v5
    v_lshl_add_u32 v5, v231, 4, v5
    v_lshlrev_b32_e64 v4, 10, v229
    v_lshl_add_u32 v4, v231, 6, v4
    v_and_b32 v11, 15, v228
    v_lshlrev_b32 v11, 8, v11
    v_lshl_add_u32 v11, v230, 4, v11
    v_bfe_u32 v231, v228, 4, 1
    v_mul_u32_u24_e64 v232, 3, v231
    v_lshrrev_b32 v230, 5, v228
    v_xor_b32 v232, v232, v230
    v_lshlrev_b32 v234, 4, v232
    v_xor_b32 v229, v229, v232
    v_lshl_add_u32 v4, v229, 4, v4
    v_add_u32_e64 v1, s37, v4
    v_lshlrev_b32 v10, 4, v228
    s_mov_b32 s38, s37
    s_add_u32 s39, s37, 32768
    s_mov_b32 s92, 32768
    v_add_u32 v2, s39, v5
    s_add_u32 s24, s8, s93
    s_addc_u32 s25, s9, 0
    s_add_u32 s32, s10, s3
    s_addc_u32 s33, s11, 0
    s_add_u32 s16, s88, 32768
    s_addc_u32 s17, s89, 0
    s_add_u32 s20, s88, 36864
    s_addc_u32 s21, s89, 0
    s_add_u32 s28, s24, 4096
    s_addc_u32 s29, s25, 0
    s_mov_b32 s26, 524288
    s_mov_b32 s27, 0x00020000
    s_mov_b32 s34, 53248
    s_mov_b32 s35, 0x00020000
    s_mov_b32 s18, 491520
    s_mov_b32 s19, 0x00020000
    s_mov_b32 s22, 487424
    s_mov_b32 s23, 0x00020000
    s_mov_b32 s30, 520192
    s_mov_b32 s31, 0x00020000
    s_mov_b32 s63, 0x4e800000
    s_add_u32 s100, s37, 98304
    s_add_u32 s101, s37, 32768
    s_lshl_b32 s96, s36, 11
    s_add_u32 s96, s96, 131072
    s_mov_b32 s98, 0x3e0293ee
    s_mov_b32 s99, 0x3e0293ee
    s_lshl_b32 s94, s36, 10
    s_add_u32 s94, s94, 98304
    v_add_u32_e64 v14, s94, v10
    v_bfe_i32 v229, v228, 1, 1
    v_bfe_i32 v230, v228, 5, 1
    v_xor_b32_e64 v230, v229, v230
    v_and_b32 v231, 0x3f803f80, v229
    v_xor_b32 v229, 0x3f803f80, v231
    v_and_b32 v230, 0x3f803f80, v230
    v_xor_b32 v230, 0x3f803f80, v230
    s_nop 0
    s_nop 0
    s_nop 0
    s_nop 0
    s_nop 0
    s_nop 0
    s_nop 0
    s_nop 0
    s_nop 0
    s_nop 0
    v_accvgpr_write_b32 a240, v230
    v_accvgpr_write_b32 a241, v230
    v_accvgpr_write_b32 a242, v230
    v_accvgpr_write_b32 a243, v230
    v_accvgpr_write_b32 a244, v229
    v_accvgpr_write_b32 a245, v229
    v_accvgpr_write_b32 a246, v229
    v_accvgpr_write_b32 a247, v229
    v_accvgpr_write_b32 a248, v231
    v_accvgpr_write_b32 a249, v231
    v_accvgpr_write_b32 a250, v231
    v_accvgpr_write_b32 a251, v231
    v_bfe_i32 v229, v228, 0, 1
    v_and_b32 v229, 0xaaaa, v229
    v_xor_b32 v12, 0x4444, v229
    v_mov_b32 v240, 0
    v_mov_b32 v241, 0
    v_mov_b32 v242, 0
    v_mov_b32 v243, 0
    v_mov_b32 v244, 0
    v_mov_b32 v245, 0
    v_mov_b32 v246, 0
    v_mov_b32 v247, 0
    v_mov_b32 v248, 0
    v_mov_b32 v249, 0
    v_mov_b32 v250, 0
    v_mov_b32 v251, 0
    v_mov_b32 v252, 0
    v_mov_b32 v253, 0
    v_mov_b32 v254, 0
    v_mov_b32 v255, 0
    v_mov_b32 v176, 0
    v_mov_b32 v177, 0
    v_mov_b32 v178, 0
    v_mov_b32 v179, 0
    v_mov_b32 v180, 0
    v_mov_b32 v181, 0
    v_mov_b32 v182, 0
    v_mov_b32 v183, 0
    v_mov_b32 v184, 0
    v_mov_b32 v185, 0
    v_mov_b32 v186, 0
    v_mov_b32 v187, 0
    v_mov_b32 v188, 0
    v_mov_b32 v189, 0
    v_mov_b32 v190, 0
    v_mov_b32 v191, 0
    v_mov_b32 v192, 0
    v_mov_b32 v193, 0
    v_mov_b32 v194, 0
    v_mov_b32 v195, 0
    v_mov_b32 v196, 0
    v_mov_b32 v197, 0
    v_mov_b32 v198, 0
    v_mov_b32 v199, 0
    v_mov_b32 v200, 0
    v_mov_b32 v201, 0
    v_mov_b32 v202, 0
    v_mov_b32 v203, 0
    s_and_b32 s94, s36, 1
    s_lshr_b32 s93, s36, 1
    s_lshl1_add_u32 s93, s94, s93
    s_mul_i32 s97, s93, 12288
    s_lshl_b32 s93, s93, 12
    s_add_u32 s93, s93, 98304
    v_add_u32 v15, s93, v4
    v_xor_b32 v3, 0x1000, v15
    v_add_u32 v233, 0x24000, v4
    s_add_u32 s60, s97, 4096
    s_add_u32 s61, s97, 8192
    s_lshl_b32 s62, s36, 6
    s_add_u32 s62, s62, 49152
    s_mov_b32 s95, 24576
    buffer_load_dwordx4 v[28:31], v13, s[12:15], s95 offen nt
    s_mov_b32 s95, 36864
    buffer_load_dwordx4 v[32:35], v13, s[12:15], s95 offen nt
    s_add_u32 m0, s37, 32768
    s_nop 0
    buffer_load_dwordx4 v6, s[24:27], 0 offen nt lds
    buffer_load_dwordx4 v6, s[24:27], 0 offen offset:1024 nt lds
    buffer_load_dwordx4 v6, s[24:27], 0 offen offset:2048 nt lds
    buffer_load_dwordx4 v6, s[24:27], 0 offen offset:3072 nt lds
    s_add_u32 m0, s37, 36864
    s_nop 0
    buffer_load_dwordx4 v6, s[28:31], 0 offen nt lds
    buffer_load_dwordx4 v6, s[28:31], 0 offen offset:1024 nt lds
    buffer_load_dwordx4 v6, s[28:31], 0 offen offset:2048 nt lds
    buffer_load_dwordx4 v6, s[28:31], 0 offen offset:3072 nt lds
    s_cmp_eq_u64 s[66:67], 0
    s_cbranch_scc1 X_exact
X_enter:
    s_waitcnt vmcnt(12)
    v_lshlrev_b32 v220, 16, v16
    v_and_b32 v221, 0xffff0000, v16
    v_lshlrev_b32_e64 v222, 16, v17
    v_and_b32 v223, 0xffff0000, v17
    v_lshlrev_b32_e64 v224, 16, v18
    v_and_b32 v225, 0xffff0000, v18
    v_lshlrev_b32_e64 v226, 16, v19
    v_and_b32 v227, 0xffff0000, v19
    v_pk_mul_f32 v[220:221], v[220:221], s[98:99]
    v_pk_mul_f32 v[222:223], v[222:223], s[98:99]
    v_pk_mul_f32 v[224:225], v[224:225], s[98:99]
    v_pk_mul_f32 v[226:227], v[226:227], s[98:99]
    v_cvt_pk_bf16_f32 v16, v220, v221
    v_cvt_pk_bf16_f32 v17, v222, v223
    v_cvt_pk_bf16_f32 v18, v224, v225
    v_cvt_pk_bf16_f32 v19, v226, v227
    ds_write_b128 v14, v[16:19] offset:49152
    s_waitcnt vmcnt(11)
    s_mov_b32 s95, 4096
    buffer_load_dwordx4 v[48:51], v13, s[12:15], s95 offen nt
    v_lshlrev_b32 v220, 16, v20
    v_and_b32 v221, 0xffff0000, v20
    v_lshlrev_b32_e64 v222, 16, v21
    v_and_b32 v223, 0xffff0000, v21
    v_lshlrev_b32_e64 v224, 16, v22
    v_and_b32 v225, 0xffff0000, v22
    v_lshlrev_b32_e64 v226, 16, v23
    v_and_b32 v227, 0xffff0000, v23
    v_pk_mul_f32 v[220:221], v[220:221], s[98:99]
    v_pk_mul_f32 v[222:223], v[222:223], s[98:99]
    v_pk_mul_f32 v[224:225], v[224:225], s[98:99]
    v_pk_mul_f32 v[226:227], v[226:227], s[98:99]
    v_cvt_pk_bf16_f32 v20, v220, v221
    v_cvt_pk_bf16_f32 v21, v222, v223
    v_cvt_pk_bf16_f32 v22, v224, v225
    v_cvt_pk_bf16_f32 v23, v226, v227
    ds_write_b128 v14, v[20:23]
    s_waitcnt vmcnt(11)
    s_mov_b32 s95, 16384
    buffer_load_dwordx4 v[52:55], v13, s[12:15], s95 offen nt
    v_lshlrev_b32 v220, 16, v24
    v_and_b32 v221, 0xffff0000, v24
    v_lshlrev_b32_e64 v222, 16, v25
    v_and_b32 v223, 0xffff0000, v25
    v_lshlrev_b32_e64 v224, 16, v26
    v_and_b32 v225, 0xffff0000, v26
    v_lshlrev_b32_e64 v226, 16, v27
    v_and_b32 v227, 0xffff0000, v27
    v_pk_mul_f32 v[220:221], v[220:221], s[98:99]
    v_pk_mul_f32 v[222:223], v[222:223], s[98:99]
    v_pk_mul_f32 v[224:225], v[224:225], s[98:99]
    v_pk_mul_f32 v[226:227], v[226:227], s[98:99]
    v_cvt_pk_bf16_f32 v24, v220, v221
    v_cvt_pk_bf16_f32 v25, v222, v223
    v_cvt_pk_bf16_f32 v26, v224, v225
    v_cvt_pk_bf16_f32 v27, v226, v227
    ds_write_b128 v14, v[24:27] offset:4096
    s_waitcnt vmcnt(11)
    s_mov_b32 s95, 28672
    buffer_load_dwordx4 v[56:59], v13, s[12:15], s95 offen nt
    v_lshlrev_b32 v220, 16, v28
    v_and_b32 v221, 0xffff0000, v28
    v_lshlrev_b32_e64 v222, 16, v29
    v_and_b32 v223, 0xffff0000, v29
    v_lshlrev_b32_e64 v224, 16, v30
    v_and_b32 v225, 0xffff0000, v30
    v_lshlrev_b32_e64 v226, 16, v31
    v_and_b32 v227, 0xffff0000, v31
    v_pk_mul_f32 v[220:221], v[220:221], s[98:99]
    v_pk_mul_f32 v[222:223], v[222:223], s[98:99]
    v_pk_mul_f32 v[224:225], v[224:225], s[98:99]
    v_pk_mul_f32 v[226:227], v[226:227], s[98:99]
    v_cvt_pk_bf16_f32 v28, v220, v221
    v_cvt_pk_bf16_f32 v29, v222, v223
    v_cvt_pk_bf16_f32 v30, v224, v225
    v_cvt_pk_bf16_f32 v31, v226, v227
    ds_write_b128 v14, v[28:31] offset:8192
    s_waitcnt vmcnt(11)
    s_mov_b32 s95, 40960
    buffer_load_dwordx4 v[60:63], v13, s[12:15], s95 offen nt
    v_lshlrev_b32 v220, 16, v32
    v_and_b32 v221, 0xffff0000, v32
    v_lshlrev_b32_e64 v222, 16, v33
    v_and_b32 v223, 0xffff0000, v33
    v_lshlrev_b32_e64 v224, 16, v34
    v_and_b32 v225, 0xffff0000, v34
    v_lshlrev_b32_e64 v226, 16, v35
    v_and_b32 v227, 0xffff0000, v35
    v_pk_mul_f32 v[220:221], v[220:221], s[98:99]
    v_pk_mul_f32 v[222:223], v[222:223], s[98:99]
    v_pk_mul_f32 v[224:225], v[224:225], s[98:99]
    v_pk_mul_f32 v[226:227], v[226:227], s[98:99]
    v_cvt_pk_bf16_f32 v32, v220, v221
    v_cvt_pk_bf16_f32 v33, v222, v223
    v_cvt_pk_bf16_f32 v34, v224, v225
    v_cvt_pk_bf16_f32 v35, v226, v227
    ds_write_b128 v14, v[32:35] offset:12288
    s_waitcnt lgkmcnt(0)
    s_barrier
    ds_read_b128 v[96:99], v234
    ds_read_b128 v[100:103], v234 offset:256
    ds_read_b128 v[104:107], v234 offset:512
    ds_read_b128 v[108:111], v234 offset:768
    ds_read_b128 a[96:99], v233
    ds_read_b128 a[100:103], v233 offset:256
    ds_read_b128 a[104:107], v233 offset:512
    ds_read_b128 a[108:111], v233 offset:768
    ds_read_b128 a[48:51], v3
    ds_read_b128 a[52:55], v3 offset:256
    ds_read_b128 a[56:59], v3 offset:512
    ds_read_b128 a[60:63], v3 offset:768
    s_waitcnt lgkmcnt(11)
    v_xor_b32 v96, 0x80008000, v96
    v_xor_b32 v97, 0x80008000, v97
    v_xor_b32 v98, 0x80008000, v98
    v_xor_b32 v99, 0x80008000, v99
    ds_read_b128 v[112:115], v1
    ds_read_b128 v[116:119], v1 offset:256
    ds_read_b128 v[120:123], v1 offset:512
    s_waitcnt lgkmcnt(13)
    v_xor_b32 v100, 0x80008000, v100
    v_xor_b32 v101, 0x80008000, v101
    v_xor_b32 v102, 0x80008000, v102
    v_xor_b32 v103, 0x80008000, v103
    ds_read_b128 v[124:127], v1 offset:768
    ds_read_b128 v[128:131], v1 offset:4096
    ds_read_b128 v[132:135], v1 offset:4352
    s_waitcnt lgkmcnt(15)
    v_xor_b32 v104, 0x80008000, v104
    v_xor_b32 v105, 0x80008000, v105
    v_xor_b32 v106, 0x80008000, v106
    v_xor_b32 v107, 0x80008000, v107
    ds_read_b128 v[136:139], v1 offset:4608
    ds_read_b128 v[140:143], v1 offset:4864
    ds_read_b128 a[0:3], v15
    s_waitcnt lgkmcnt(15)
    v_xor_b32 v108, 0x80008000, v108
    v_xor_b32 v109, 0x80008000, v109
    v_xor_b32 v110, 0x80008000, v110
    v_xor_b32 v111, 0x80008000, v111
    ds_read_b128 a[4:7], v15 offset:256
    ds_read_b128 a[8:11], v15 offset:512
    ds_read_b128 a[12:15], v15 offset:768
    v_mfma_f32_16x16x32_bf16 v[200:203], v[96:99], a[96:99], v[200:203]
    v_mfma_f32_16x16x32_bf16 v[200:203], v[100:103], a[100:103], v[200:203]
    s_waitcnt lgkmcnt(15)
    v_mfma_f32_16x16x32_bf16 v[200:203], v[104:107], a[104:107], v[200:203]
    v_mfma_f32_16x16x32_bf16 v[200:203], v[108:111], a[108:111], v[200:203]
    v_mfma_f32_16x16x32_bf16 v[188:191], v[96:99], a[48:51], v[188:191]
    s_waitcnt lgkmcnt(14)
    v_mfma_f32_16x16x32_bf16 v[188:191], v[100:103], a[52:55], v[188:191]
    s_waitcnt lgkmcnt(13)
    v_mfma_f32_16x16x32_bf16 v[188:191], v[104:107], a[56:59], v[188:191]
    s_waitcnt lgkmcnt(12)
    v_mfma_f32_16x16x32_bf16 v[188:191], v[108:111], a[60:63], v[188:191]
    s_waitcnt lgkmcnt(4)
    v_mfma_f32_16x16x32_bf16 v[220:223], v[112:115], a[96:99], v[200:203]
    v_mfma_f32_16x16x32_bf16 v[220:223], v[116:119], a[100:103], v[220:223]
    s_waitcnt lgkmcnt(0)
    v_mfma_f32_16x16x32_bf16 v[220:223], v[120:123], a[104:107], v[220:223]
    v_mfma_f32_16x16x32_bf16 v[220:223], v[124:127], a[108:111], v[220:223]
    s_nop 0
    s_nop 0
    v_mfma_f32_16x16x32_bf16 v[224:227], v[128:131], a[96:99], v[200:203]
    s_nop 0
    s_nop 0
    v_mfma_f32_16x16x32_bf16 v[224:227], v[132:135], a[100:103], v[224:227]
    s_nop 0
    s_nop 0
    v_mfma_f32_16x16x32_bf16 v[224:227], v[136:139], a[104:107], v[224:227]
    v_exp_f32_e64 v220, v220
    v_mfma_f32_16x16x32_bf16 v[224:227], v[140:143], a[108:111], v[224:227]
    v_exp_f32_e64 v221, v221
    v_mfma_f32_16x16x32_bf16 v[176:179], v[96:99], a[0:3], v[176:179]
    v_exp_f32_e64 v222, v222
    v_mfma_f32_16x16x32_bf16 v[176:179], v[100:103], a[4:7], v[176:179]
    v_exp_f32_e64 v223, v223
    v_mfma_f32_16x16x32_bf16 v[176:179], v[104:107], a[8:11], v[176:179]
    v_cvt_pk_bf16_f32 v236, v220, v221
    v_cvt_pk_bf16_f32 v237, v222, v223
    v_mfma_f32_16x16x32_bf16 v[176:179], v[108:111], a[12:15], v[176:179]
    v_exp_f32_e64 v224, v224
    v_mfma_f32_16x16x32_bf16 v[212:215], v[112:115], a[48:51], v[188:191]
    v_exp_f32_e64 v225, v225
    v_mfma_f32_16x16x32_bf16 v[212:215], v[116:119], a[52:55], v[212:215]
    v_exp_f32_e64 v226, v226
    v_mfma_f32_16x16x32_bf16 v[212:215], v[120:123], a[56:59], v[212:215]
    v_exp_f32_e64 v227, v227
    v_mfma_f32_16x16x32_bf16 v[212:215], v[124:127], a[60:63], v[212:215]
    v_cvt_pk_bf16_f32 v238, v224, v225
    v_cvt_pk_bf16_f32 v239, v226, v227
    v_mfma_f32_16x16x32_bf16 v[216:219], v[128:131], a[48:51], v[188:191]
    v_xor_b32 v1, 0x2000, v1
    s_nop 0
    v_mfma_f32_16x16x32_bf16 v[216:219], v[132:135], a[52:55], v[216:219]
    s_nop 0
    s_nop 0
    v_mfma_f32_16x16x32_bf16 v[216:219], v[136:139], a[56:59], v[216:219]
    v_exp_f32 v212, v212
    v_mfma_f32_16x16x32_bf16 v[216:219], v[140:143], a[60:63], v[216:219]
    v_exp_f32_e64 v213, v213
    v_mfma_f32_16x16x32_bf16 v[204:207], v[112:115], a[0:3], v[176:179]
    v_cvt_pk_bf16_f32 v232, v212, v213
    v_mfma_f32_16x16x32_bf16 v[204:207], v[116:119], a[4:7], v[204:207]
    v_exp_f32_e64 v214, v214
    v_mfma_f32_16x16x32_bf16 v[204:207], v[120:123], a[8:11], v[204:207]
    v_exp_f32_e64 v215, v215
    v_mfma_f32_16x16x32_bf16 v[204:207], v[124:127], a[12:15], v[204:207]
    v_cvt_pk_bf16_f32 v233, v214, v215
    s_nop 0
    v_mfma_f32_16x16x32_bf16 v[208:211], v[128:131], a[0:3], v[176:179]
    v_exp_f32 v216, v216
    v_mfma_f32_16x16x32_bf16 v[208:211], v[132:135], a[4:7], v[208:211]
    v_exp_f32_e64 v217, v217
    v_mfma_f32_16x16x32_bf16 v[208:211], v[136:139], a[8:11], v[208:211]
    v_cvt_pk_bf16_f32 v234, v216, v217
    v_mfma_f32_16x16x32_bf16 v[208:211], v[140:143], a[12:15], v[208:211]
    v_exp_f32 v218, v218
    v_exp_f32 v219, v219
    s_nop 0
    v_cvt_pk_bf16_f32 v235, v218, v219
    s_mov_b32 s95, 8192
    buffer_load_dwordx4 v[80:83], v13, s[12:15], s95 offen nt
    s_mov_b32 s95, 20480
    buffer_load_dwordx4 v[84:87], v13, s[12:15], s95 offen nt
    s_mov_b32 s95, 32768
    buffer_load_dwordx4 v[88:91], v13, s[12:15], s95 offen nt
    s_mov_b32 s95, 45056
    buffer_load_dwordx4 v[92:95], v13, s[12:15], s95 offen nt
    s_waitcnt vmcnt(8)
    ds_read_b64_tr_b16 v[144:145], v2
    ds_read_b64_tr_b16 v[146:147], v2 offset:4096
    ds_read_b64_tr_b16 v[148:149], v2 offset:8
    ds_read_b64_tr_b16 v[150:151], v2 offset:4104
    ds_read_b64_tr_b16 v[152:153], v2 offset:256
    ds_read_b64_tr_b16 v[154:155], v2 offset:4352
    ds_read_b64_tr_b16 v[156:157], v2 offset:264
    ds_read_b64_tr_b16 v[158:159], v2 offset:4360
    ds_read_b64_tr_b16 v[160:161], v2 offset:512
    ds_read_b64_tr_b16 v[162:163], v2 offset:4608
    ds_read_b64_tr_b16 v[164:165], v2 offset:520
    ds_read_b64_tr_b16 v[166:167], v2 offset:4616
    ds_read_b64_tr_b16 v[168:169], v2 offset:768
    ds_read_b64_tr_b16 v[170:171], v2 offset:4864
    ds_read_b64_tr_b16 v[172:173], v2 offset:776
    ds_read_b64_tr_b16 v[174:175], v2 offset:4872
    s_add_u32 m0, s37, 65536
    s_nop 0
    buffer_load_dwordx4 v6, s[16:19], 0 offen nt lds
    buffer_load_dwordx4 v7, s[16:19], 0 offen offset:1024 nt lds
    buffer_load_dwordx4 v8, s[16:19], 0 offen offset:2048 nt lds
    v_exp_f32 v204, v204
    v_exp_f32 v205, v205
    v_exp_f32 v206, v206
    v_exp_f32 v207, v207
    v_exp_f32 v208, v208
    v_exp_f32 v209, v209
    v_exp_f32 v210, v210
    v_exp_f32_e64 v211, v211
    v_mfma_f32_16x16x32_bf16 v[252:255], a[240:243], v[236:239], v[252:255]
    v_cvt_pk_bf16_f32 v228, v204, v205
    s_waitcnt lgkmcnt(8)
    v_mfma_f32_16x16x32_bf16 a[208:211], v[144:147], v[236:239], 0
    v_cvt_pk_bf16_f32 v229, v206, v207
    v_cvt_pk_bf16_f32 v230, v208, v209
    v_mfma_f32_16x16x32_bf16 a[212:215], v[148:151], v[236:239], 0
    v_cvt_pk_bf16_f32 v231, v210, v211
    v_mfma_f32_16x16x32_bf16 a[216:219], v[152:155], v[236:239], 0
    v_mfma_f32_16x16x32_bf16 a[220:223], v[156:159], v[236:239], 0
    v_xor_b32 v2, 0x2000, v2
    s_waitcnt lgkmcnt(0)
    v_mfma_f32_16x16x32_bf16 a[224:227], v[160:163], v[236:239], 0
    v_mfma_f32_16x16x32_bf16 a[228:231], v[164:167], v[236:239], 0
    v_mfma_f32_16x16x32_bf16 a[232:235], v[168:171], v[236:239], 0
    v_mfma_f32_16x16x32_bf16 a[236:239], v[172:175], v[236:239], 0
    v_mfma_f32_16x16x32_bf16 a[112:115], v[144:147], v[232:235], 0
    v_mfma_f32_16x16x32_bf16 a[116:119], v[148:151], v[232:235], 0
    v_mfma_f32_16x16x32_bf16 a[120:123], v[152:155], v[232:235], 0
    v_mfma_f32_16x16x32_bf16 a[124:127], v[156:159], v[232:235], 0
    v_mfma_f32_16x16x32_bf16 a[128:131], v[160:163], v[232:235], 0
    v_mfma_f32_16x16x32_bf16 a[132:135], v[164:167], v[232:235], 0
    v_mfma_f32_16x16x32_bf16 a[136:139], v[168:171], v[232:235], 0
    v_mfma_f32_16x16x32_bf16 a[140:143], v[172:175], v[232:235], 0
    s_waitcnt vmcnt(10)
    buffer_load_dwordx4 v9, s[16:19], 0 offen offset:3072 nt lds
    s_add_u32 m0, s37, 69632
    v_lshlrev_b32 v220, 16, v48
    v_and_b32 v221, 0xffff0000, v48
    v_lshlrev_b32_e64 v222, 16, v49
    v_and_b32 v223, 0xffff0000, v49
    v_lshlrev_b32_e64 v224, 16, v50
    v_and_b32 v225, 0xffff0000, v50
    v_lshlrev_b32_e64 v226, 16, v51
    v_and_b32 v227, 0xffff0000, v51
    v_pk_mul_f32 v[220:221], v[220:221], s[98:99]
    v_pk_mul_f32 v[222:223], v[222:223], s[98:99]
    v_pk_mul_f32 v[224:225], v[224:225], s[98:99]
    v_pk_mul_f32 v[226:227], v[226:227], s[98:99]
    v_cvt_pk_bf16_f32 v48, v220, v221
    v_cvt_pk_bf16_f32 v49, v222, v223
    v_cvt_pk_bf16_f32 v50, v224, v225
    v_cvt_pk_bf16_f32 v51, v226, v227
    ds_write_b128 v14, v[48:51] offset:16384
    s_waitcnt vmcnt(10)
    buffer_load_dwordx4 v6, s[20:23], 0 offen nt lds
    v_lshlrev_b32 v220, 16, v52
    v_and_b32 v221, 0xffff0000, v52
    v_lshlrev_b32_e64 v222, 16, v53
    v_and_b32 v223, 0xffff0000, v53
    v_lshlrev_b32_e64 v224, 16, v54
    v_and_b32 v225, 0xffff0000, v54
    v_lshlrev_b32_e64 v226, 16, v55
    v_and_b32 v227, 0xffff0000, v55
    v_pk_mul_f32 v[220:221], v[220:221], s[98:99]
    v_pk_mul_f32 v[222:223], v[222:223], s[98:99]
    v_pk_mul_f32 v[224:225], v[224:225], s[98:99]
    v_pk_mul_f32 v[226:227], v[226:227], s[98:99]
    v_cvt_pk_bf16_f32 v52, v220, v221
    v_cvt_pk_bf16_f32 v53, v222, v223
    v_cvt_pk_bf16_f32 v54, v224, v225
    v_cvt_pk_bf16_f32 v55, v226, v227
    ds_write_b128 v14, v[52:55] offset:20480
    s_waitcnt vmcnt(10)
    buffer_load_dwordx4 v7, s[20:23], 0 offen offset:1024 nt lds
    v_lshlrev_b32 v220, 16, v56
    v_and_b32 v221, 0xffff0000, v56
    v_lshlrev_b32_e64 v222, 16, v57
    v_and_b32 v223, 0xffff0000, v57
    v_lshlrev_b32_e64 v224, 16, v58
    v_and_b32 v225, 0xffff0000, v58
    v_lshlrev_b32_e64 v226, 16, v59
    v_and_b32 v227, 0xffff0000, v59
    v_pk_mul_f32 v[220:221], v[220:221], s[98:99]
    v_pk_mul_f32 v[222:223], v[222:223], s[98:99]
    v_pk_mul_f32 v[224:225], v[224:225], s[98:99]
    v_pk_mul_f32 v[226:227], v[226:227], s[98:99]
    v_cvt_pk_bf16_f32 v56, v220, v221
    v_cvt_pk_bf16_f32 v57, v222, v223
    v_cvt_pk_bf16_f32 v58, v224, v225
    v_cvt_pk_bf16_f32 v59, v226, v227
    ds_write_b128 v14, v[56:59] offset:24576
    s_waitcnt vmcnt(10)
    buffer_load_dwordx4 v8, s[20:23], 0 offen offset:2048 nt lds
    v_lshlrev_b32 v220, 16, v60
    v_and_b32 v221, 0xffff0000, v60
    v_lshlrev_b32_e64 v222, 16, v61
    v_and_b32 v223, 0xffff0000, v61
    v_lshlrev_b32_e64 v224, 16, v62
    v_and_b32 v225, 0xffff0000, v62
    v_lshlrev_b32_e64 v226, 16, v63
    v_and_b32 v227, 0xffff0000, v63
    v_pk_mul_f32 v[220:221], v[220:221], s[98:99]
    v_pk_mul_f32 v[222:223], v[222:223], s[98:99]
    v_pk_mul_f32 v[224:225], v[224:225], s[98:99]
    v_pk_mul_f32 v[226:227], v[226:227], s[98:99]
    v_cvt_pk_bf16_f32 v60, v220, v221
    v_cvt_pk_bf16_f32 v61, v222, v223
    v_cvt_pk_bf16_f32 v62, v224, v225
    v_cvt_pk_bf16_f32 v63, v226, v227
    ds_write_b128 v14, v[60:63] offset:28672
    v_smfmac_f32_16x16x64_bf16 v[240:243], a[240:243], v[228:235], v12
    v_mfma_f32_16x16x32_bf16 v[16:19], v[144:147], v[228:231], 0
    v_mfma_f32_16x16x32_bf16 v[20:23], v[148:151], v[228:231], 0
    v_mfma_f32_16x16x32_bf16 v[24:27], v[152:155], v[228:231], 0
    s_waitcnt lgkmcnt(0)
    s_barrier
    ds_read_b128 a[64:67], v3 offset:16384
    ds_read_b128 a[68:71], v3 offset:16640
    v_mfma_f32_16x16x32_bf16 v[28:31], v[156:159], v[228:231], 0
    ds_read_b128 a[72:75], v3 offset:16896
    ds_read_b128 a[76:79], v3 offset:17152
    v_mfma_f32_16x16x32_bf16 v[32:35], v[160:163], v[228:231], 0
    ds_read_b128 a[16:19], v15 offset:16384
    ds_read_b128 a[20:23], v15 offset:16640
    v_mfma_f32_16x16x32_bf16 v[36:39], v[164:167], v[228:231], 0
    ds_read_b128 a[24:27], v15 offset:16896
    ds_read_b128 a[28:31], v15 offset:17152
    v_mfma_f32_16x16x32_bf16 v[40:43], v[168:171], v[228:231], 0
    v_mfma_f32_16x16x32_bf16 v[44:47], v[172:175], v[228:231], 0
    s_waitcnt lgkmcnt(7)
    v_mfma_f32_16x16x32_bf16 v[192:195], v[96:99], a[64:67], v[192:195]
    s_waitcnt lgkmcnt(6)
    v_mfma_f32_16x16x32_bf16 v[192:195], v[100:103], a[68:71], v[192:195]
    s_waitcnt lgkmcnt(5)
    v_mfma_f32_16x16x32_bf16 v[192:195], v[104:107], a[72:75], v[192:195]
    s_waitcnt lgkmcnt(4)
    v_mfma_f32_16x16x32_bf16 v[192:195], v[108:111], a[76:79], v[192:195]
    v_mfma_f32_16x16x32_bf16 v[212:215], v[112:115], a[64:67], v[192:195]
    v_mfma_f32_16x16x32_bf16 v[212:215], v[116:119], a[68:71], v[212:215]
    s_waitcnt lgkmcnt(0)
    v_mfma_f32_16x16x32_bf16 v[212:215], v[120:123], a[72:75], v[212:215]
    v_mfma_f32_16x16x32_bf16 v[212:215], v[124:127], a[76:79], v[212:215]
    s_nop 0
    s_nop 0
    v_mfma_f32_16x16x32_bf16 v[216:219], v[128:131], a[64:67], v[192:195]
    s_nop 0
    s_nop 0
    v_mfma_f32_16x16x32_bf16 v[216:219], v[132:135], a[68:71], v[216:219]
    s_nop 0
    s_nop 0
    v_mfma_f32_16x16x32_bf16 v[216:219], v[136:139], a[72:75], v[216:219]
    v_exp_f32 v212, v212
    v_mfma_f32_16x16x32_bf16 v[216:219], v[140:143], a[76:79], v[216:219]
    v_exp_f32_e64 v213, v213
    v_mfma_f32_16x16x32_bf16 v[180:183], v[96:99], a[16:19], v[180:183]
    v_exp_f32_e64 v214, v214
    v_mfma_f32_16x16x32_bf16 v[180:183], v[100:103], a[20:23], v[180:183]
    v_exp_f32_e64 v215, v215
    v_mfma_f32_16x16x32_bf16 v[180:183], v[104:107], a[24:27], v[180:183]
    v_cvt_pk_bf16_f32 v232, v212, v213
    v_cvt_pk_bf16_f32 v233, v214, v215
    v_mfma_f32_16x16x32_bf16 v[180:183], v[108:111], a[28:31], v[180:183]
    v_exp_f32_e64 v216, v216
    v_mfma_f32_16x16x32_bf16 v[204:207], v[112:115], a[16:19], v[180:183]
    v_exp_f32_e64 v217, v217
    v_mfma_f32_16x16x32_bf16 v[204:207], v[116:119], a[20:23], v[204:207]
    v_exp_f32_e64 v218, v218
    v_mfma_f32_16x16x32_bf16 v[204:207], v[120:123], a[24:27], v[204:207]
    v_exp_f32_e64 v219, v219
    v_mfma_f32_16x16x32_bf16 v[204:207], v[124:127], a[28:31], v[204:207]
    v_cvt_pk_bf16_f32 v234, v216, v217
    v_cvt_pk_bf16_f32 v235, v218, v219
    v_mfma_f32_16x16x32_bf16 v[208:211], v[128:131], a[16:19], v[180:183]
    s_nop 0
    s_nop 0
    v_mfma_f32_16x16x32_bf16 v[208:211], v[132:135], a[20:23], v[208:211]
    s_nop 0
    s_nop 0
    v_exp_f32_e64 v204, v204
    v_mfma_f32_16x16x32_bf16 v[208:211], v[136:139], a[24:27], v[208:211]
    v_exp_f32_e64 v205, v205
    v_mfma_f32_16x16x32_bf16 v[208:211], v[140:143], a[28:31], v[208:211]
    v_exp_f32_e64 v206, v206
    v_mfma_f32_16x16x32_bf16 a[144:147], v[144:147], v[232:235], 0
    v_exp_f32_e64 v207, v207
    v_mfma_f32_16x16x32_bf16 a[148:151], v[148:151], v[232:235], 0
    v_cvt_pk_bf16_f32 v228, v204, v205
    v_cvt_pk_bf16_f32 v229, v206, v207
    v_mfma_f32_16x16x32_bf16 a[152:155], v[152:155], v[232:235], 0
    s_nop 0
    v_exp_f32 v208, v208
    v_exp_f32_e64 v209, v209
    v_mfma_f32_16x16x32_bf16 a[156:159], v[156:159], v[232:235], 0
    v_exp_f32_e64 v210, v210
    v_mfma_f32_16x16x32_bf16 a[160:163], v[160:163], v[232:235], 0
    v_exp_f32_e64 v211, v211
    v_mfma_f32_16x16x32_bf16 a[164:167], v[164:167], v[232:235], 0
    v_cvt_pk_bf16_f32 v230, v208, v209
    v_cvt_pk_bf16_f32 v231, v210, v211
    v_mfma_f32_16x16x32_bf16 a[168:171], v[168:171], v[232:235], 0
    v_mfma_f32_16x16x32_bf16 a[172:175], v[172:175], v[232:235], 0
    s_waitcnt vmcnt(10)
    buffer_load_dwordx4 v9, s[20:23], 0 offen offset:3072 nt lds
    v_lshlrev_b32 v220, 16, v80
    v_and_b32 v221, 0xffff0000, v80
    v_lshlrev_b32_e64 v222, 16, v81
    v_and_b32 v223, 0xffff0000, v81
    v_lshlrev_b32_e64 v224, 16, v82
    v_and_b32 v225, 0xffff0000, v82
    v_lshlrev_b32_e64 v226, 16, v83
    v_and_b32 v227, 0xffff0000, v83
    v_pk_mul_f32 v[220:221], v[220:221], s[98:99]
    v_pk_mul_f32 v[222:223], v[222:223], s[98:99]
    v_pk_mul_f32 v[224:225], v[224:225], s[98:99]
    v_pk_mul_f32 v[226:227], v[226:227], s[98:99]
    v_cvt_pk_bf16_f32 v80, v220, v221
    v_cvt_pk_bf16_f32 v81, v222, v223
    v_cvt_pk_bf16_f32 v82, v224, v225
    v_cvt_pk_bf16_f32 v83, v226, v227
    ds_write_b128 v14, v[80:83] offset:32768
    s_waitcnt vmcnt(10)
    v_lshlrev_b32 v220, 16, v84
    v_and_b32 v221, 0xffff0000, v84
    v_lshlrev_b32_e64 v222, 16, v85
    v_and_b32 v223, 0xffff0000, v85
    v_lshlrev_b32_e64 v224, 16, v86
    v_and_b32 v225, 0xffff0000, v86
    v_lshlrev_b32_e64 v226, 16, v87
    v_and_b32 v227, 0xffff0000, v87
    v_pk_mul_f32 v[220:221], v[220:221], s[98:99]
    v_pk_mul_f32 v[222:223], v[222:223], s[98:99]
    v_pk_mul_f32 v[224:225], v[224:225], s[98:99]
    v_pk_mul_f32 v[226:227], v[226:227], s[98:99]
    v_cvt_pk_bf16_f32 v84, v220, v221
    v_cvt_pk_bf16_f32 v85, v222, v223
    v_cvt_pk_bf16_f32 v86, v224, v225
    v_cvt_pk_bf16_f32 v87, v226, v227
    ds_write_b128 v14, v[84:87] offset:36864
    s_waitcnt vmcnt(9)
    v_lshlrev_b32 v220, 16, v88
    v_and_b32 v221, 0xffff0000, v88
    v_lshlrev_b32_e64 v222, 16, v89
    v_and_b32 v223, 0xffff0000, v89
    v_lshlrev_b32_e64 v224, 16, v90
    v_and_b32 v225, 0xffff0000, v90
    v_lshlrev_b32_e64 v226, 16, v91
    v_and_b32 v227, 0xffff0000, v91
    v_pk_mul_f32 v[220:221], v[220:221], s[98:99]
    v_pk_mul_f32 v[222:223], v[222:223], s[98:99]
    v_pk_mul_f32 v[224:225], v[224:225], s[98:99]
    v_pk_mul_f32 v[226:227], v[226:227], s[98:99]
    v_cvt_pk_bf16_f32 v88, v220, v221
    v_cvt_pk_bf16_f32 v89, v222, v223
    v_cvt_pk_bf16_f32 v90, v224, v225
    v_cvt_pk_bf16_f32 v91, v226, v227
    ds_write_b128 v14, v[88:91] offset:40960
    s_waitcnt vmcnt(8)
    v_lshlrev_b32 v220, 16, v92
    v_and_b32 v221, 0xffff0000, v92
    v_lshlrev_b32_e64 v222, 16, v93
    v_and_b32 v223, 0xffff0000, v93
    v_lshlrev_b32_e64 v224, 16, v94
    v_and_b32 v225, 0xffff0000, v94
    v_lshlrev_b32_e64 v226, 16, v95
    v_and_b32 v227, 0xffff0000, v95
    v_pk_mul_f32 v[220:221], v[220:221], s[98:99]
    v_pk_mul_f32 v[222:223], v[222:223], s[98:99]
    v_pk_mul_f32 v[224:225], v[224:225], s[98:99]
    v_pk_mul_f32 v[226:227], v[226:227], s[98:99]
    v_cvt_pk_bf16_f32 v92, v220, v221
    v_cvt_pk_bf16_f32 v93, v222, v223
    v_cvt_pk_bf16_f32 v94, v224, v225
    v_cvt_pk_bf16_f32 v95, v226, v227
    ds_write_b128 v14, v[92:95] offset:45056
    v_smfmac_f32_16x16x64_bf16 v[244:247], a[240:243], v[228:235], v12
    v_mfma_f32_16x16x32_bf16 v[48:51], v[144:147], v[228:231], 0
    v_mfma_f32_16x16x32_bf16 v[52:55], v[148:151], v[228:231], 0
    v_mfma_f32_16x16x32_bf16 v[56:59], v[152:155], v[228:231], 0
    s_waitcnt lgkmcnt(0)
    s_barrier
    ds_read_b128 a[80:83], v3 offset:32768
    ds_read_b128 a[84:87], v3 offset:33024
    v_mfma_f32_16x16x32_bf16 v[60:63], v[156:159], v[228:231], 0
    ds_read_b128 a[88:91], v3 offset:33280
    ds_read_b128 a[92:95], v3 offset:33536
    v_mfma_f32_16x16x32_bf16 v[64:67], v[160:163], v[228:231], 0
    ds_read_b128 a[32:35], v15 offset:32768
    ds_read_b128 a[36:39], v15 offset:33024
    v_mfma_f32_16x16x32_bf16 v[68:71], v[164:167], v[228:231], 0
    ds_read_b128 a[40:43], v15 offset:33280
    ds_read_b128 a[44:47], v15 offset:33536
    v_mfma_f32_16x16x32_bf16 v[72:75], v[168:171], v[228:231], 0
    s_add_u32 m0, s37, 98304
    v_mfma_f32_16x16x32_bf16 v[76:79], v[172:175], v[228:231], 0
    s_waitcnt lgkmcnt(7)
    v_mfma_f32_16x16x32_bf16 v[196:199], v[96:99], a[80:83], v[196:199]
    s_waitcnt lgkmcnt(6)
    v_mfma_f32_16x16x32_bf16 v[196:199], v[100:103], a[84:87], v[196:199]
    s_waitcnt lgkmcnt(5)
    v_mfma_f32_16x16x32_bf16 v[196:199], v[104:107], a[88:91], v[196:199]
    s_waitcnt lgkmcnt(4)
    v_mfma_f32_16x16x32_bf16 v[196:199], v[108:111], a[92:95], v[196:199]
    buffer_load_dwordx4 v6, s[24:27], s92 offen nt lds
    v_mfma_f32_16x16x32_bf16 v[212:215], v[112:115], a[80:83], v[196:199]
    buffer_load_dwordx4 v6, s[24:27], s92 offen offset:1024 nt lds
    v_mfma_f32_16x16x32_bf16 v[212:215], v[116:119], a[84:87], v[212:215]
    s_waitcnt lgkmcnt(0)
    v_mfma_f32_16x16x32_bf16 v[212:215], v[120:123], a[88:91], v[212:215]
    buffer_load_dwordx4 v6, s[24:27], s92 offen offset:2048 nt lds
    v_mfma_f32_16x16x32_bf16 v[212:215], v[124:127], a[92:95], v[212:215]
    s_nop 0
    s_nop 0
    v_mfma_f32_16x16x32_bf16 v[216:219], v[128:131], a[80:83], v[196:199]
    s_nop 0
    s_nop 0
    v_mfma_f32_16x16x32_bf16 v[216:219], v[132:135], a[84:87], v[216:219]
    s_nop 0
    s_nop 0
    v_mfma_f32_16x16x32_bf16 v[216:219], v[136:139], a[88:91], v[216:219]
    v_exp_f32 v212, v212
    v_mfma_f32_16x16x32_bf16 v[216:219], v[140:143], a[92:95], v[216:219]
    v_exp_f32_e64 v213, v213
    v_mfma_f32_16x16x32_bf16 v[184:187], v[96:99], a[32:35], v[184:187]
    v_exp_f32_e64 v214, v214
    v_mfma_f32_16x16x32_bf16 v[184:187], v[100:103], a[36:39], v[184:187]
    v_exp_f32_e64 v215, v215
    v_mfma_f32_16x16x32_bf16 v[184:187], v[104:107], a[40:43], v[184:187]
    v_cvt_pk_bf16_f32 v232, v212, v213
    v_cvt_pk_bf16_f32 v233, v214, v215
    v_mfma_f32_16x16x32_bf16 v[184:187], v[108:111], a[44:47], v[184:187]
    v_exp_f32_e64 v216, v216
    v_mfma_f32_16x16x32_bf16 v[204:207], v[112:115], a[32:35], v[184:187]
    ds_read_b128 v[112:115], v1
    buffer_load_dwordx4 v6, s[24:27], s92 offen offset:3072 nt lds
    v_mfma_f32_16x16x32_bf16 v[204:207], v[116:119], a[36:39], v[204:207]
    ds_read_b128 v[116:119], v1 offset:256
    s_add_u32 m0, s37, 102400
    v_mfma_f32_16x16x32_bf16 v[204:207], v[120:123], a[40:43], v[204:207]
    v_exp_f32_e64 v217, v217
    v_mfma_f32_16x16x32_bf16 v[204:207], v[124:127], a[44:47], v[204:207]
    ds_read_b128 v[120:123], v1 offset:512
    v_exp_f32_e64 v218, v218
    v_mfma_f32_16x16x32_bf16 v[208:211], v[128:131], a[32:35], v[184:187]
    ds_read_b128 v[124:127], v1 offset:768
    v_exp_f32_e64 v219, v219
    v_mfma_f32_16x16x32_bf16 v[208:211], v[132:135], a[36:39], v[208:211]
    ds_read_b128 v[128:131], v1 offset:4096
    v_cvt_pk_bf16_f32 v234, v216, v217
    v_cvt_pk_bf16_f32 v235, v218, v219
    v_mfma_f32_16x16x32_bf16 v[208:211], v[136:139], a[40:43], v[208:211]
    ds_read_b128 v[132:135], v1 offset:4352
    v_mfma_f32_16x16x32_bf16 v[208:211], v[140:143], a[44:47], v[208:211]
    ds_read_b128 v[136:139], v1 offset:4608
    v_mfma_f32_16x16x32_bf16 a[176:179], v[144:147], v[232:235], 0
    ds_read_b128 v[140:143], v1 offset:4864
    v_mfma_f32_16x16x32_bf16 a[180:183], v[148:151], v[232:235], 0
    buffer_load_dwordx4 v6, s[28:31], s92 offen nt lds
    v_mfma_f32_16x16x32_bf16 a[184:187], v[152:155], v[232:235], 0
    buffer_load_dwordx4 v6, s[28:31], s92 offen offset:1024 nt lds
    v_mfma_f32_16x16x32_bf16 a[188:191], v[156:159], v[232:235], 0
    v_exp_f32_e64 v204, v204
    v_mfma_f32_16x16x32_bf16 a[192:195], v[160:163], v[232:235], 0
    v_exp_f32_e64 v205, v205
    v_mfma_f32_16x16x32_bf16 a[196:199], v[164:167], v[232:235], 0
    v_cvt_pk_bf16_f32 v228, v204, v205
    buffer_load_dwordx4 v6, s[28:31], s92 offen offset:2048 nt lds
    v_mfma_f32_16x16x32_bf16 a[200:203], v[168:171], v[232:235], 0
    v_exp_f32_e64 v206, v206
    v_mfma_f32_16x16x32_bf16 a[204:207], v[172:175], v[232:235], 0
    v_exp_f32 v207, v207
    s_waitcnt lgkmcnt(0)
    v_mfma_f32_16x16x32_bf16 v[212:215], v[112:115], a[48:51], v[188:191]
    v_exp_f32_e64 v208, v208
    v_mfma_f32_16x16x32_bf16 v[212:215], v[116:119], a[52:55], v[212:215]
    v_exp_f32_e64 v209, v209
    v_mfma_f32_16x16x32_bf16 v[212:215], v[120:123], a[56:59], v[212:215]
    v_exp_f32_e64 v210, v210
    v_mfma_f32_16x16x32_bf16 v[212:215], v[124:127], a[60:63], v[212:215]
    v_cvt_pk_bf16_f32 v229, v206, v207
    v_cvt_pk_bf16_f32 v230, v208, v209
    v_mfma_f32_16x16x32_bf16 v[216:219], v[128:131], a[48:51], v[188:191]
    v_exp_f32_e64 v211, v211
    v_mfma_f32_16x16x32_bf16 v[216:219], v[132:135], a[52:55], v[216:219]
    v_cvt_pk_bf16_f32 v231, v210, v211
    s_nop 0
    v_mfma_f32_16x16x32_bf16 v[216:219], v[136:139], a[56:59], v[216:219]
    v_exp_f32 v212, v212
    v_mfma_f32_16x16x32_bf16 v[216:219], v[140:143], a[60:63], v[216:219]
    v_exp_f32_e64 v213, v213
    v_smfmac_f32_16x16x64_bf16 v[248:251], a[240:243], v[228:235], v12
    v_cvt_pk_bf16_f32 v232, v212, v213
    buffer_load_dwordx4 v6, s[28:31], s92 offen offset:3072 nt lds
    v_mfma_f32_16x16x32_bf16 v[80:83], v[144:147], v[228:231], 0
    ds_read_b64_tr_b16 v[144:145], v2
    ds_read_b64_tr_b16 v[146:147], v2 offset:4096
    s_add_u32 m0, s37, 131072
    v_mfma_f32_16x16x32_bf16 v[84:87], v[148:151], v[228:231], 0
    v_exp_f32_e64 v214, v214
    v_mfma_f32_16x16x32_bf16 v[88:91], v[152:155], v[228:231], 0
    ds_read_b64_tr_b16 v[148:149], v2 offset:8
    ds_read_b64_tr_b16 v[150:151], v2 offset:4104
    v_mfma_f32_16x16x32_bf16 v[92:95], v[156:159], v[228:231], 0
    v_exp_f32_e64 v215, v215
    v_mfma_f32_16x16x32_bf16 v[96:99], v[160:163], v[228:231], 0
    ds_read_b64_tr_b16 v[152:153], v2 offset:256
    ds_read_b64_tr_b16 v[154:155], v2 offset:4352
    v_mfma_f32_16x16x32_bf16 v[100:103], v[164:167], v[228:231], 0
    v_exp_f32_e64 v216, v216
    v_mfma_f32_16x16x32_bf16 v[104:107], v[168:171], v[228:231], 0
    ds_read_b64_tr_b16 v[156:157], v2 offset:264
    ds_read_b64_tr_b16 v[158:159], v2 offset:4360
    v_mfma_f32_16x16x32_bf16 v[108:111], v[172:175], v[228:231], 0
    v_exp_f32_e64 v217, v217
    v_mfma_f32_16x16x32_bf16 v[204:207], v[112:115], a[0:3], v[176:179]
    ds_read_b64_tr_b16 v[160:161], v2 offset:512
    ds_read_b64_tr_b16 v[162:163], v2 offset:4608
    v_mfma_f32_16x16x32_bf16 v[204:207], v[116:119], a[4:7], v[204:207]
    v_exp_f32_e64 v218, v218
    v_mfma_f32_16x16x32_bf16 v[204:207], v[120:123], a[8:11], v[204:207]
    ds_read_b64_tr_b16 v[164:165], v2 offset:520
    ds_read_b64_tr_b16 v[166:167], v2 offset:4616
    v_mfma_f32_16x16x32_bf16 v[204:207], v[124:127], a[12:15], v[204:207]
    v_cvt_pk_bf16_f32 v233, v214, v215
    v_cvt_pk_bf16_f32 v234, v216, v217
    v_mfma_f32_16x16x32_bf16 v[208:211], v[128:131], a[0:3], v[176:179]
    ds_read_b64_tr_b16 v[168:169], v2 offset:768
    ds_read_b64_tr_b16 v[170:171], v2 offset:4864
    v_mfma_f32_16x16x32_bf16 v[208:211], v[132:135], a[4:7], v[208:211]
    v_exp_f32_e64 v219, v219
    v_mfma_f32_16x16x32_bf16 v[208:211], v[136:139], a[8:11], v[208:211]
    ds_read_b64_tr_b16 v[172:173], v2 offset:776
    ds_read_b64_tr_b16 v[174:175], v2 offset:4872
    v_mfma_f32_16x16x32_bf16 v[208:211], v[140:143], a[12:15], v[208:211]
    v_cvt_pk_bf16_f32 v235, v218, v219
    v_mfma_f32_16x16x32_bf16 v[220:223], v[112:115], a[64:67], v[192:195]
    v_exp_f32_e64 v204, v204
    v_mfma_f32_16x16x32_bf16 v[220:223], v[116:119], a[68:71], v[220:223]
    v_exp_f32_e64 v205, v205
    v_mfma_f32_16x16x32_bf16 v[220:223], v[120:123], a[72:75], v[220:223]
    v_exp_f32_e64 v206, v206
    v_mfma_f32_16x16x32_bf16 v[220:223], v[124:127], a[76:79], v[220:223]
    v_exp_f32_e64 v207, v207
    v_mfma_f32_16x16x32_bf16 v[224:227], v[128:131], a[64:67], v[192:195]
    v_exp_f32_e64 v208, v208
    v_mfma_f32_16x16x32_bf16 v[224:227], v[132:135], a[68:71], v[224:227]
    v_exp_f32_e64 v209, v209
    v_mfma_f32_16x16x32_bf16 v[224:227], v[136:139], a[72:75], v[224:227]
    v_exp_f32_e64 v210, v210
    v_mfma_f32_16x16x32_bf16 v[224:227], v[140:143], a[76:79], v[224:227]
    s_waitcnt lgkmcnt(0)
    s_barrier
    v_mfma_f32_16x16x32_bf16 a[112:115], v[144:147], v[232:235], a[112:115]
    v_cvt_pk_bf16_f32 v228, v204, v205
    v_cvt_pk_bf16_f32 v229, v206, v207
    v_mfma_f32_16x16x32_bf16 a[116:119], v[148:151], v[232:235], a[116:119]
    v_exp_f32_e64 v211, v211
    v_mfma_f32_16x16x32_bf16 a[120:123], v[152:155], v[232:235], a[120:123]
    v_cvt_pk_bf16_f32 v230, v208, v209
    v_cvt_pk_bf16_f32 v231, v210, v211
    v_mfma_f32_16x16x32_bf16 a[124:127], v[156:159], v[232:235], a[124:127]
    buffer_load_dwordx4 v6, s[16:19], s92 offen nt lds
    v_mfma_f32_16x16x32_bf16 a[128:131], v[160:163], v[232:235], a[128:131]
    v_exp_f32_e64 v220, v220
    v_mfma_f32_16x16x32_bf16 a[132:135], v[164:167], v[232:235], a[132:135]
    v_exp_f32_e64 v221, v221
    v_mfma_f32_16x16x32_bf16 a[136:139], v[168:171], v[232:235], a[136:139]
    v_exp_f32_e64 v222, v222
    v_mfma_f32_16x16x32_bf16 a[140:143], v[172:175], v[232:235], a[140:143]
    buffer_load_dwordx4 v7, s[16:19], s92 offen offset:1024 nt lds
    v_smfmac_f32_16x16x64_bf16 v[240:243], a[240:243], v[228:235], v12
    v_cvt_pk_bf16_f32 v232, v220, v221
    v_mfma_f32_16x16x32_bf16 v[16:19], v[144:147], v[228:231], v[16:19]
    v_exp_f32_e64 v223, v223
    v_mfma_f32_16x16x32_bf16 v[20:23], v[148:151], v[228:231], v[20:23]
    v_exp_f32_e64 v224, v224
    v_mfma_f32_16x16x32_bf16 v[24:27], v[152:155], v[228:231], v[24:27]
    buffer_load_dwordx4 v8, s[16:19], s92 offen offset:2048 nt lds
    v_mfma_f32_16x16x32_bf16 v[28:31], v[156:159], v[228:231], v[28:31]
    v_exp_f32_e64 v225, v225
    v_mfma_f32_16x16x32_bf16 v[32:35], v[160:163], v[228:231], v[32:35]
    v_exp_f32_e64 v226, v226
    v_mfma_f32_16x16x32_bf16 v[36:39], v[164:167], v[228:231], v[36:39]
    v_cvt_pk_bf16_f32 v233, v222, v223
    v_cvt_pk_bf16_f32 v234, v224, v225
    v_mfma_f32_16x16x32_bf16 v[40:43], v[168:171], v[228:231], v[40:43]
    buffer_load_dwordx4 v9, s[16:19], s92 offen offset:3072 nt lds
    v_mfma_f32_16x16x32_bf16 v[44:47], v[172:175], v[228:231], v[44:47]
    v_exp_f32_e64 v227, v227
    v_mfma_f32_16x16x32_bf16 v[204:207], v[112:115], a[16:19], v[180:183]
    v_cvt_pk_bf16_f32 v235, v226, v227
    s_add_u32 m0, s37, 135168
    v_mfma_f32_16x16x32_bf16 v[204:207], v[116:119], a[20:23], v[204:207]
    s_add_u32 s93, s39, 32768
    v_mfma_f32_16x16x32_bf16 v[204:207], v[120:123], a[24:27], v[204:207]
    buffer_load_dwordx4 v6, s[20:23], s92 offen nt lds
    v_mfma_f32_16x16x32_bf16 v[204:207], v[124:127], a[28:31], v[204:207]
    s_cmp_lt_u32 s93, 163840
    s_cselect_b32 s38, s93, s37
    v_mfma_f32_16x16x32_bf16 v[208:211], v[128:131], a[16:19], v[180:183]
    v_add_u32_e64 v1, s38, v4
    s_nop 0
    v_mfma_f32_16x16x32_bf16 v[208:211], v[132:135], a[20:23], v[208:211]
    s_nop 0
    s_nop 0
    v_mfma_f32_16x16x32_bf16 v[208:211], v[136:139], a[24:27], v[208:211]
    v_mfma_f32_16x16x32_bf16 v[208:211], v[140:143], a[28:31], v[208:211]
    v_exp_f32_e64 v204, v204
    v_mfma_f32_16x16x32_bf16 a[144:147], v[144:147], v[232:235], a[144:147]
    v_exp_f32_e64 v205, v205
    v_mfma_f32_16x16x32_bf16 a[148:151], v[148:151], v[232:235], a[148:151]
    v_exp_f32_e64 v206, v206
    v_mfma_f32_16x16x32_bf16 a[152:155], v[152:155], v[232:235], a[152:155]
    buffer_load_dwordx4 v7, s[20:23], s92 offen offset:1024 nt lds
    v_mfma_f32_16x16x32_bf16 a[156:159], v[156:159], v[232:235], a[156:159]
    v_exp_f32_e64 v207, v207
    v_mfma_f32_16x16x32_bf16 a[160:163], v[160:163], v[232:235], a[160:163]
    v_exp_f32_e64 v208, v208
    v_mfma_f32_16x16x32_bf16 a[164:167], v[164:167], v[232:235], a[164:167]
    v_exp_f32_e64 v209, v209
    v_mfma_f32_16x16x32_bf16 a[168:171], v[168:171], v[232:235], a[168:171]
    v_exp_f32_e64 v210, v210
    v_mfma_f32_16x16x32_bf16 a[172:175], v[172:175], v[232:235], a[172:175]
    v_mfma_f32_16x16x32_bf16 v[212:215], v[112:115], a[32:35], v[184:187]
    v_cvt_pk_bf16_f32 v228, v204, v205
    v_cvt_pk_bf16_f32 v229, v206, v207
    v_mfma_f32_16x16x32_bf16 v[212:215], v[116:119], a[36:39], v[212:215]
    v_exp_f32_e64 v211, v211
    v_mfma_f32_16x16x32_bf16 v[212:215], v[120:123], a[40:43], v[212:215]
    v_cvt_pk_bf16_f32 v230, v208, v209
    v_cvt_pk_bf16_f32 v231, v210, v211
    v_mfma_f32_16x16x32_bf16 v[212:215], v[124:127], a[44:47], v[212:215]
    buffer_load_dwordx4 v8, s[20:23], s92 offen offset:2048 nt lds
    v_mfma_f32_16x16x32_bf16 v[216:219], v[128:131], a[32:35], v[184:187]
    s_add_u32 s93, s38, 32768
    s_nop 0
    v_mfma_f32_16x16x32_bf16 v[216:219], v[132:135], a[36:39], v[216:219]
    s_cmp_lt_u32 s93, 163840
    s_cselect_b32 s39, s93, s37
    v_mfma_f32_16x16x32_bf16 v[216:219], v[136:139], a[40:43], v[216:219]
    v_exp_f32_e64 v212, v212
    v_mfma_f32_16x16x32_bf16 v[216:219], v[140:143], a[44:47], v[216:219]
    v_exp_f32_e64 v213, v213
    v_smfmac_f32_16x16x64_bf16 v[244:247], a[240:243], v[228:235], v12
    v_cvt_pk_bf16_f32 v232, v212, v213
    v_mfma_f32_16x16x32_bf16 v[48:51], v[144:147], v[228:231], v[48:51]
    v_exp_f32_e64 v214, v214
    v_mfma_f32_16x16x32_bf16 v[52:55], v[148:151], v[228:231], v[52:55]
    v_exp_f32_e64 v215, v215
    v_mfma_f32_16x16x32_bf16 v[56:59], v[152:155], v[228:231], v[56:59]
    v_exp_f32_e64 v216, v216
    v_mfma_f32_16x16x32_bf16 v[60:63], v[156:159], v[228:231], v[60:63]
    v_exp_f32_e64 v217, v217
    v_mfma_f32_16x16x32_bf16 v[64:67], v[160:163], v[228:231], v[64:67]
    v_exp_f32_e64 v218, v218
    v_mfma_f32_16x16x32_bf16 v[68:71], v[164:167], v[228:231], v[68:71]
    v_cvt_pk_bf16_f32 v233, v214, v215
    v_cvt_pk_bf16_f32 v234, v216, v217
    v_mfma_f32_16x16x32_bf16 v[72:75], v[168:171], v[228:231], v[72:75]
    v_exp_f32_e64 v219, v219
    v_mfma_f32_16x16x32_bf16 v[76:79], v[172:175], v[228:231], v[76:79]
    v_cvt_pk_bf16_f32 v235, v218, v219
    v_add_u32_e64 v2, s39, v5
    v_mfma_f32_16x16x32_bf16 v[204:207], v[112:115], a[80:83], v[196:199]
    s_waitcnt vmcnt(15)
    ds_read_b128 v[112:115], v1
    v_mfma_f32_16x16x32_bf16 v[204:207], v[116:119], a[84:87], v[204:207]
    ds_read_b128 v[116:119], v1 offset:256
    buffer_load_dwordx4 v9, s[20:23], s92 offen offset:3072 nt lds
    v_mfma_f32_16x16x32_bf16 v[204:207], v[120:123], a[88:91], v[204:207]
    ds_read_b128 v[120:123], v1 offset:512
    s_add_u32 s92, s92, 32768
    v_mfma_f32_16x16x32_bf16 v[204:207], v[124:127], a[92:95], v[204:207]
    ds_read_b128 v[124:127], v1 offset:768
    s_add_u32 m0, s37, 0
    v_mfma_f32_16x16x32_bf16 v[208:211], v[128:131], a[80:83], v[196:199]
    ds_read_b128 v[128:131], v1 offset:4096
    v_mfma_f32_16x16x32_bf16 v[208:211], v[132:135], a[84:87], v[208:211]
    buffer_load_dwordx4 v6, s[24:27], s92 offen nt lds
    v_mfma_f32_16x16x32_bf16 v[208:211], v[136:139], a[88:91], v[208:211]
    ds_read_b128 v[132:135], v1 offset:4352
    v_mfma_f32_16x16x32_bf16 v[208:211], v[140:143], a[92:95], v[208:211]
    ds_read_b128 v[136:139], v1 offset:4608
    v_mfma_f32_16x16x32_bf16 v[80:83], v[144:147], v[232:235], v[80:83]
    ds_read_b128 v[140:143], v1 offset:4864
    v_mfma_f32_16x16x32_bf16 v[84:87], v[148:151], v[232:235], v[84:87]
    v_mfma_f32_16x16x32_bf16 v[88:91], v[152:155], v[232:235], v[88:91]
    buffer_load_dwordx4 v6, s[24:27], s92 offen offset:1024 nt lds
    v_mfma_f32_16x16x32_bf16 v[92:95], v[156:159], v[232:235], v[92:95]
    v_exp_f32_e64 v204, v204
    v_mfma_f32_16x16x32_bf16 v[96:99], v[160:163], v[232:235], v[96:99]
    v_exp_f32_e64 v205, v205
    v_mfma_f32_16x16x32_bf16 v[100:103], v[164:167], v[232:235], v[100:103]
    v_exp_f32_e64 v206, v206
    v_mfma_f32_16x16x32_bf16 v[104:107], v[168:171], v[232:235], v[104:107]
    v_exp_f32_e64 v207, v207
    v_mfma_f32_16x16x32_bf16 v[108:111], v[172:175], v[232:235], v[108:111]
    s_waitcnt lgkmcnt(0)
    v_mfma_f32_16x16x32_bf16 v[220:223], v[112:115], a[96:99], v[200:203]
    v_exp_f32 v208, v208
    v_mfma_f32_16x16x32_bf16 v[220:223], v[116:119], a[100:103], v[220:223]
    v_exp_f32_e64 v209, v209
    v_mfma_f32_16x16x32_bf16 v[220:223], v[120:123], a[104:107], v[220:223]
    v_exp_f32_e64 v210, v210
    v_mfma_f32_16x16x32_bf16 v[220:223], v[124:127], a[108:111], v[220:223]
    v_cvt_pk_bf16_f32 v236, v204, v205
    v_cvt_pk_bf16_f32 v237, v206, v207
    v_mfma_f32_16x16x32_bf16 v[224:227], v[128:131], a[96:99], v[200:203]
    v_exp_f32_e64 v211, v211
    v_mfma_f32_16x16x32_bf16 v[224:227], v[132:135], a[100:103], v[224:227]
    v_cvt_pk_bf16_f32 v238, v208, v209
    v_cvt_pk_bf16_f32 v239, v210, v211
    v_mfma_f32_16x16x32_bf16 v[224:227], v[136:139], a[104:107], v[224:227]
    buffer_load_dwordx4 v6, s[24:27], s92 offen offset:2048 nt lds
    v_mfma_f32_16x16x32_bf16 v[224:227], v[140:143], a[108:111], v[224:227]
    v_exp_f32 v220, v220
    v_smfmac_f32_16x16x64_bf16 v[248:251], a[240:243], v[232:239], v12
    v_mfma_f32_16x16x32_bf16 a[176:179], v[144:147], v[236:239], a[176:179]
    s_waitcnt vmcnt(11)
    ds_read_b64_tr_b16 v[144:145], v2
    ds_read_b64_tr_b16 v[146:147], v2 offset:4096
    v_mfma_f32_16x16x32_bf16 a[180:183], v[148:151], v[236:239], a[180:183]
    v_exp_f32_e64 v221, v221
    v_mfma_f32_16x16x32_bf16 a[184:187], v[152:155], v[236:239], a[184:187]
    ds_read_b64_tr_b16 v[148:149], v2 offset:8
    ds_read_b64_tr_b16 v[150:151], v2 offset:4104
    v_mfma_f32_16x16x32_bf16 a[188:191], v[156:159], v[236:239], a[188:191]
    v_exp_f32_e64 v222, v222
    v_mfma_f32_16x16x32_bf16 a[192:195], v[160:163], v[236:239], a[192:195]
    ds_read_b64_tr_b16 v[152:153], v2 offset:256
    ds_read_b64_tr_b16 v[154:155], v2 offset:4352
    v_mfma_f32_16x16x32_bf16 a[196:199], v[164:167], v[236:239], a[196:199]
    buffer_load_dwordx4 v6, s[24:27], s92 offen offset:3072 nt lds
    v_mfma_f32_16x16x32_bf16 a[200:203], v[168:171], v[236:239], a[200:203]
    ds_read_b64_tr_b16 v[156:157], v2 offset:264
    ds_read_b64_tr_b16 v[158:159], v2 offset:4360
    s_add_u32 m0, s37, 4096
    v_mfma_f32_16x16x32_bf16 a[204:207], v[172:175], v[236:239], a[204:207]
    v_exp_f32_e64 v223, v223
    v_mfma_f32_16x16x32_bf16 v[212:215], v[112:115], a[48:51], v[188:191]
    ds_read_b64_tr_b16 v[160:161], v2 offset:512
    ds_read_b64_tr_b16 v[162:163], v2 offset:4608
    v_mfma_f32_16x16x32_bf16 v[212:215], v[116:119], a[52:55], v[212:215]
    v_exp_f32_e64 v224, v224
    v_mfma_f32_16x16x32_bf16 v[212:215], v[120:123], a[56:59], v[212:215]
    ds_read_b64_tr_b16 v[164:165], v2 offset:520
    ds_read_b64_tr_b16 v[166:167], v2 offset:4616
    v_mfma_f32_16x16x32_bf16 v[212:215], v[124:127], a[60:63], v[212:215]
    v_exp_f32_e64 v225, v225
    buffer_load_dwordx4 v6, s[28:31], s92 offen nt lds
    v_mfma_f32_16x16x32_bf16 v[216:219], v[128:131], a[48:51], v[188:191]
    ds_read_b64_tr_b16 v[168:169], v2 offset:768
    ds_read_b64_tr_b16 v[170:171], v2 offset:4864
    v_mfma_f32_16x16x32_bf16 v[216:219], v[132:135], a[52:55], v[216:219]
    v_exp_f32_e64 v226, v226
    v_mfma_f32_16x16x32_bf16 v[216:219], v[136:139], a[56:59], v[216:219]
    ds_read_b64_tr_b16 v[172:173], v2 offset:776
    ds_read_b64_tr_b16 v[174:175], v2 offset:4872
    v_mfma_f32_16x16x32_bf16 v[216:219], v[140:143], a[60:63], v[216:219]
    v_cvt_pk_bf16_f32 v228, v220, v221
    v_cvt_pk_bf16_f32 v229, v222, v223
    v_mfma_f32_16x16x32_bf16 v[204:207], v[112:115], a[0:3], v[176:179]
    v_exp_f32_e64 v227, v227
    v_mfma_f32_16x16x32_bf16 v[204:207], v[116:119], a[4:7], v[204:207]
    v_cvt_pk_bf16_f32 v230, v224, v225
    v_cvt_pk_bf16_f32 v231, v226, v227
    v_mfma_f32_16x16x32_bf16 v[204:207], v[120:123], a[8:11], v[204:207]
    v_exp_f32_e64 v212, v212
    v_mfma_f32_16x16x32_bf16 v[204:207], v[124:127], a[12:15], v[204:207]
    v_exp_f32_e64 v213, v213
    v_mfma_f32_16x16x32_bf16 v[208:211], v[128:131], a[0:3], v[176:179]
    v_exp_f32_e64 v214, v214
    v_mfma_f32_16x16x32_bf16 v[208:211], v[132:135], a[4:7], v[208:211]
    v_exp_f32_e64 v215, v215
    v_mfma_f32_16x16x32_bf16 v[208:211], v[136:139], a[8:11], v[208:211]
    v_exp_f32_e64 v216, v216
    v_mfma_f32_16x16x32_bf16 v[208:211], v[140:143], a[12:15], v[208:211]
    v_exp_f32_e64 v217, v217
    v_mfma_f32_16x16x32_bf16 v[252:255], a[240:243], v[228:231], v[252:255]
    v_cvt_pk_bf16_f32 v232, v212, v213
    s_waitcnt lgkmcnt(0)
    v_mfma_f32_16x16x32_bf16 a[208:211], v[144:147], v[228:231], a[208:211]
    v_exp_f32 v218, v218
    v_mfma_f32_16x16x32_bf16 a[212:215], v[148:151], v[228:231], a[212:215]
    buffer_load_dwordx4 v6, s[28:31], s92 offen offset:1024 nt lds
    v_mfma_f32_16x16x32_bf16 a[216:219], v[152:155], v[228:231], a[216:219]
    v_cvt_pk_bf16_f32 v233, v214, v215
    v_cvt_pk_bf16_f32 v234, v216, v217
    v_mfma_f32_16x16x32_bf16 a[220:223], v[156:159], v[228:231], a[220:223]
    v_exp_f32_e64 v219, v219
    v_mfma_f32_16x16x32_bf16 a[224:227], v[160:163], v[228:231], a[224:227]
    v_cvt_pk_bf16_f32 v235, v218, v219
    v_xor_b32 v1, 0x2000, v1
    v_mfma_f32_16x16x32_bf16 a[228:231], v[164:167], v[228:231], a[228:231]
    v_exp_f32_e64 v204, v204
    v_mfma_f32_16x16x32_bf16 a[232:235], v[168:171], v[228:231], a[232:235]
    v_exp_f32_e64 v205, v205
    v_mfma_f32_16x16x32_bf16 a[236:239], v[172:175], v[228:231], a[236:239]
    v_exp_f32_e64 v206, v206
    v_mfma_f32_16x16x32_bf16 a[112:115], v[144:147], v[232:235], a[112:115]
    v_exp_f32_e64 v207, v207
    v_mfma_f32_16x16x32_bf16 a[116:119], v[148:151], v[232:235], a[116:119]
    v_exp_f32_e64 v208, v208
    v_mfma_f32_16x16x32_bf16 a[120:123], v[152:155], v[232:235], a[120:123]
    v_exp_f32_e64 v209, v209
    v_mfma_f32_16x16x32_bf16 a[124:127], v[156:159], v[232:235], a[124:127]
    v_exp_f32_e64 v210, v210
    v_mfma_f32_16x16x32_bf16 a[128:131], v[160:163], v[232:235], a[128:131]
    v_cvt_pk_bf16_f32 v228, v204, v205
    v_mfma_f32_16x16x32_bf16 a[132:135], v[164:167], v[232:235], a[132:135]
    buffer_load_dwordx4 v6, s[28:31], s92 offen offset:2048 nt lds
    v_mfma_f32_16x16x32_bf16 a[136:139], v[168:171], v[232:235], a[136:139]
    v_cvt_pk_bf16_f32 v229, v206, v207
    v_cvt_pk_bf16_f32 v230, v208, v209
    v_mfma_f32_16x16x32_bf16 a[140:143], v[172:175], v[232:235], a[140:143]
    v_exp_f32_e64 v211, v211
    v_mfma_f32_16x16x32_bf16 v[212:215], v[112:115], a[64:67], v[192:195]
    v_cvt_pk_bf16_f32 v231, v210, v211
    v_xor_b32 v2, 0x2000, v2
    v_mfma_f32_16x16x32_bf16 v[212:215], v[116:119], a[68:71], v[212:215]
    buffer_load_dwordx4 v6, s[28:31], s92 offen offset:3072 nt lds
    v_mfma_f32_16x16x32_bf16 v[212:215], v[120:123], a[72:75], v[212:215]
    s_add_u32 m0, s37, 32768
    v_mfma_f32_16x16x32_bf16 v[212:215], v[124:127], a[76:79], v[212:215]
    buffer_load_dwordx4 v6, s[16:19], s92 offen nt lds
    v_mfma_f32_16x16x32_bf16 v[216:219], v[128:131], a[64:67], v[192:195]
    s_nop 0
    s_nop 0
    v_mfma_f32_16x16x32_bf16 v[216:219], v[132:135], a[68:71], v[216:219]
    s_nop 0
    s_nop 0
    v_mfma_f32_16x16x32_bf16 v[216:219], v[136:139], a[72:75], v[216:219]
    s_nop 0
    v_mfma_f32_16x16x32_bf16 v[216:219], v[140:143], a[76:79], v[216:219]
    v_exp_f32 v212, v212
    v_smfmac_f32_16x16x64_bf16 v[240:243], a[240:243], v[228:235], v12
    v_mfma_f32_16x16x32_bf16 v[16:19], v[144:147], v[228:231], v[16:19]
    v_exp_f32_e64 v213, v213
    v_mfma_f32_16x16x32_bf16 v[20:23], v[148:151], v[228:231], v[20:23]
    v_exp_f32_e64 v214, v214
    v_mfma_f32_16x16x32_bf16 v[24:27], v[152:155], v[228:231], v[24:27]
    v_exp_f32_e64 v215, v215
    v_mfma_f32_16x16x32_bf16 v[28:31], v[156:159], v[228:231], v[28:31]
    v_exp_f32_e64 v216, v216
    v_mfma_f32_16x16x32_bf16 v[32:35], v[160:163], v[228:231], v[32:35]
    v_exp_f32_e64 v217, v217
    v_mfma_f32_16x16x32_bf16 v[36:39], v[164:167], v[228:231], v[36:39]
    buffer_load_dwordx4 v7, s[16:19], s92 offen offset:1024 nt lds
    v_mfma_f32_16x16x32_bf16 v[40:43], v[168:171], v[228:231], v[40:43]
    v_exp_f32_e64 v218, v218
    v_mfma_f32_16x16x32_bf16 v[44:47], v[172:175], v[228:231], v[44:47]
    v_cvt_pk_bf16_f32 v232, v212, v213
    v_cvt_pk_bf16_f32 v233, v214, v215
    v_mfma_f32_16x16x32_bf16 v[204:207], v[112:115], a[16:19], v[180:183]
    v_exp_f32_e64 v219, v219
    v_mfma_f32_16x16x32_bf16 v[204:207], v[116:119], a[20:23], v[204:207]
    v_cvt_pk_bf16_f32 v234, v216, v217
    v_cvt_pk_bf16_f32 v235, v218, v219
    v_mfma_f32_16x16x32_bf16 v[204:207], v[120:123], a[24:27], v[204:207]
    v_mfma_f32_16x16x32_bf16 v[204:207], v[124:127], a[28:31], v[204:207]
    buffer_load_dwordx4 v8, s[16:19], s92 offen offset:2048 nt lds
    v_mfma_f32_16x16x32_bf16 v[208:211], v[128:131], a[16:19], v[180:183]
    s_nop 0
    s_nop 0
    v_mfma_f32_16x16x32_bf16 v[208:211], v[132:135], a[20:23], v[208:211]
    s_nop 0
    s_nop 0
    v_mfma_f32_16x16x32_bf16 v[208:211], v[136:139], a[24:27], v[208:211]
    s_nop 0
    v_mfma_f32_16x16x32_bf16 v[208:211], v[140:143], a[28:31], v[208:211]
    v_exp_f32 v204, v204
    v_mfma_f32_16x16x32_bf16 a[144:147], v[144:147], v[232:235], a[144:147]
    v_exp_f32_e64 v205, v205
    v_mfma_f32_16x16x32_bf16 a[148:151], v[148:151], v[232:235], a[148:151]
    v_exp_f32_e64 v206, v206
    v_mfma_f32_16x16x32_bf16 a[152:155], v[152:155], v[232:235], a[152:155]
    v_exp_f32_e64 v207, v207
    v_mfma_f32_16x16x32_bf16 a[156:159], v[156:159], v[232:235], a[156:159]
    v_exp_f32_e64 v208, v208
    v_mfma_f32_16x16x32_bf16 a[160:163], v[160:163], v[232:235], a[160:163]
    v_exp_f32_e64 v209, v209
    v_mfma_f32_16x16x32_bf16 a[164:167], v[164:167], v[232:235], a[164:167]
    buffer_load_dwordx4 v9, s[16:19], s92 offen offset:3072 nt lds
    v_mfma_f32_16x16x32_bf16 a[168:171], v[168:171], v[232:235], a[168:171]
    v_exp_f32_e64 v210, v210
    v_mfma_f32_16x16x32_bf16 a[172:175], v[172:175], v[232:235], a[172:175]
    v_cvt_pk_bf16_f32 v228, v204, v205
    v_cvt_pk_bf16_f32 v229, v206, v207
    v_mfma_f32_16x16x32_bf16 v[212:215], v[112:115], a[80:83], v[196:199]
    v_exp_f32_e64 v211, v211
    v_mfma_f32_16x16x32_bf16 v[212:215], v[116:119], a[84:87], v[212:215]
    v_cvt_pk_bf16_f32 v230, v208, v209
    v_cvt_pk_bf16_f32 v231, v210, v211
    v_mfma_f32_16x16x32_bf16 v[212:215], v[120:123], a[88:91], v[212:215]
    s_add_u32 m0, s37, 36864
    v_mfma_f32_16x16x32_bf16 v[212:215], v[124:127], a[92:95], v[212:215]
    buffer_load_dwordx4 v6, s[20:23], s92 offen nt lds
    v_mfma_f32_16x16x32_bf16 v[216:219], v[128:131], a[80:83], v[196:199]
    s_nop 0
    s_nop 0
    v_mfma_f32_16x16x32_bf16 v[216:219], v[132:135], a[84:87], v[216:219]
    s_nop 0
    s_nop 0
    v_mfma_f32_16x16x32_bf16 v[216:219], v[136:139], a[88:91], v[216:219]
    s_nop 0
    v_mfma_f32_16x16x32_bf16 v[216:219], v[140:143], a[92:95], v[216:219]
    v_exp_f32 v212, v212
    v_smfmac_f32_16x16x64_bf16 v[244:247], a[240:243], v[228:235], v12
    v_mfma_f32_16x16x32_bf16 v[48:51], v[144:147], v[228:231], v[48:51]
    v_exp_f32_e64 v213, v213
    v_mfma_f32_16x16x32_bf16 v[52:55], v[148:151], v[228:231], v[52:55]
    v_exp_f32_e64 v214, v214
    v_mfma_f32_16x16x32_bf16 v[56:59], v[152:155], v[228:231], v[56:59]
    v_exp_f32_e64 v215, v215
    v_mfma_f32_16x16x32_bf16 v[60:63], v[156:159], v[228:231], v[60:63]
    v_exp_f32_e64 v216, v216
    v_mfma_f32_16x16x32_bf16 v[64:67], v[160:163], v[228:231], v[64:67]
    buffer_load_dwordx4 v7, s[20:23], s92 offen offset:1024 nt lds
    v_mfma_f32_16x16x32_bf16 v[68:71], v[164:167], v[228:231], v[68:71]
    v_exp_f32_e64 v217, v217
    v_mfma_f32_16x16x32_bf16 v[72:75], v[168:171], v[228:231], v[72:75]
    v_exp_f32 v218, v218
    v_mfma_f32_16x16x32_bf16 v[76:79], v[172:175], v[228:231], v[76:79]
    v_cvt_pk_bf16_f32 v232, v212, v213
    v_cvt_pk_bf16_f32 v233, v214, v215
    v_mfma_f32_16x16x32_bf16 v[204:207], v[112:115], a[32:35], v[184:187]
    s_barrier
    ds_read_b128 v[112:115], v1
    v_cvt_pk_bf16_f32 v234, v216, v217
    v_mfma_f32_16x16x32_bf16 v[204:207], v[116:119], a[36:39], v[204:207]
    ds_read_b128 v[116:119], v1 offset:256
    v_mfma_f32_16x16x32_bf16 v[204:207], v[120:123], a[40:43], v[204:207]
    ds_read_b128 v[120:123], v1 offset:512
    v_mfma_f32_16x16x32_bf16 v[204:207], v[124:127], a[44:47], v[204:207]
    ds_read_b128 v[124:127], v1 offset:768
    v_mfma_f32_16x16x32_bf16 v[208:211], v[128:131], a[32:35], v[184:187]
    v_exp_f32_e64 v219, v219
    v_mfma_f32_16x16x32_bf16 v[208:211], v[132:135], a[36:39], v[208:211]
    ds_read_b128 v[128:131], v1 offset:4096
    v_cvt_pk_bf16_f32 v235, v218, v219
    v_mfma_f32_16x16x32_bf16 v[208:211], v[136:139], a[40:43], v[208:211]
    ds_read_b128 v[132:135], v1 offset:4352
    v_mfma_f32_16x16x32_bf16 v[208:211], v[140:143], a[44:47], v[208:211]
    ds_read_b128 v[136:139], v1 offset:4608
    v_mfma_f32_16x16x32_bf16 a[176:179], v[144:147], v[232:235], a[176:179]
    ds_read_b128 v[140:143], v1 offset:4864
    v_mfma_f32_16x16x32_bf16 a[180:183], v[148:151], v[232:235], a[180:183]
    buffer_load_dwordx4 v8, s[20:23], s92 offen offset:2048 nt lds
    v_mfma_f32_16x16x32_bf16 a[184:187], v[152:155], v[232:235], a[184:187]
    buffer_load_dwordx4 v9, s[20:23], s92 offen offset:3072 nt lds
    v_mfma_f32_16x16x32_bf16 a[188:191], v[156:159], v[232:235], a[188:191]
    v_exp_f32_e64 v204, v204
    s_add_u32 s92, s92, 32768
    v_mfma_f32_16x16x32_bf16 a[192:195], v[160:163], v[232:235], a[192:195]
    v_exp_f32 v205, v205
    s_mov_b32 m0, s38
    v_mfma_f32_16x16x32_bf16 a[196:199], v[164:167], v[232:235], a[196:199]
    v_exp_f32_e64 v206, v206
    v_mfma_f32_16x16x32_bf16 a[200:203], v[168:171], v[232:235], a[200:203]
    v_exp_f32_e64 v207, v207
    v_mfma_f32_16x16x32_bf16 a[204:207], v[172:175], v[232:235], a[204:207]
    v_cvt_pk_bf16_f32 v228, v204, v205
    s_waitcnt lgkmcnt(0)
    v_mfma_f32_16x16x32_bf16 v[212:215], v[112:115], a[48:51], v[188:191]
    v_exp_f32 v208, v208
    v_mfma_f32_16x16x32_bf16 v[212:215], v[116:119], a[52:55], v[212:215]
    v_exp_f32_e64 v209, v209
    v_mfma_f32_16x16x32_bf16 v[212:215], v[120:123], a[56:59], v[212:215]
    v_exp_f32_e64 v210, v210
    v_mfma_f32_16x16x32_bf16 v[212:215], v[124:127], a[60:63], v[212:215]
    v_cvt_pk_bf16_f32 v229, v206, v207
    v_cvt_pk_bf16_f32 v230, v208, v209
    v_mfma_f32_16x16x32_bf16 v[216:219], v[128:131], a[48:51], v[188:191]
    v_exp_f32_e64 v211, v211
    v_mfma_f32_16x16x32_bf16 v[216:219], v[132:135], a[52:55], v[216:219]
    v_cvt_pk_bf16_f32 v231, v210, v211
    s_nop 0
    v_mfma_f32_16x16x32_bf16 v[216:219], v[136:139], a[56:59], v[216:219]
    v_exp_f32 v212, v212
    v_mfma_f32_16x16x32_bf16 v[216:219], v[140:143], a[60:63], v[216:219]
    v_exp_f32_e64 v213, v213
    v_smfmac_f32_16x16x64_bf16 v[248:251], a[240:243], v[228:235], v12
    v_cvt_pk_bf16_f32 v232, v212, v213
    v_mfma_f32_16x16x32_bf16 v[80:83], v[144:147], v[228:231], v[80:83]
    ds_read_b64_tr_b16 v[144:145], v2
    ds_read_b64_tr_b16 v[146:147], v2 offset:4096
    v_mfma_f32_16x16x32_bf16 v[84:87], v[148:151], v[228:231], v[84:87]
    v_exp_f32_e64 v214, v214
    v_mfma_f32_16x16x32_bf16 v[88:91], v[152:155], v[228:231], v[88:91]
    ds_read_b64_tr_b16 v[148:149], v2 offset:8
    ds_read_b64_tr_b16 v[150:151], v2 offset:4104
    v_mfma_f32_16x16x32_bf16 v[92:95], v[156:159], v[228:231], v[92:95]
    v_exp_f32_e64 v215, v215
    v_mfma_f32_16x16x32_bf16 v[96:99], v[160:163], v[228:231], v[96:99]
    ds_read_b64_tr_b16 v[152:153], v2 offset:256
    ds_read_b64_tr_b16 v[154:155], v2 offset:4352
    v_mfma_f32_16x16x32_bf16 v[100:103], v[164:167], v[228:231], v[100:103]
    v_exp_f32_e64 v216, v216
    v_mfma_f32_16x16x32_bf16 v[104:107], v[168:171], v[228:231], v[104:107]
    ds_read_b64_tr_b16 v[156:157], v2 offset:264
    ds_read_b64_tr_b16 v[158:159], v2 offset:4360
    v_mfma_f32_16x16x32_bf16 v[108:111], v[172:175], v[228:231], v[108:111]
    v_exp_f32_e64 v217, v217
    v_mfma_f32_16x16x32_bf16 v[204:207], v[112:115], a[0:3], v[176:179]
    ds_read_b64_tr_b16 v[160:161], v2 offset:512
    ds_read_b64_tr_b16 v[162:163], v2 offset:4608
    v_mfma_f32_16x16x32_bf16 v[204:207], v[116:119], a[4:7], v[204:207]
    v_exp_f32_e64 v218, v218
    v_mfma_f32_16x16x32_bf16 v[204:207], v[120:123], a[8:11], v[204:207]
    ds_read_b64_tr_b16 v[164:165], v2 offset:520
    ds_read_b64_tr_b16 v[166:167], v2 offset:4616
    v_mfma_f32_16x16x32_bf16 v[204:207], v[124:127], a[12:15], v[204:207]
    v_cvt_pk_bf16_f32 v233, v214, v215
    v_cvt_pk_bf16_f32 v234, v216, v217
    v_mfma_f32_16x16x32_bf16 v[208:211], v[128:131], a[0:3], v[176:179]
    ds_read_b64_tr_b16 v[168:169], v2 offset:768
    ds_read_b64_tr_b16 v[170:171], v2 offset:4864
    v_mfma_f32_16x16x32_bf16 v[208:211], v[132:135], a[4:7], v[208:211]
    v_exp_f32_e64 v219, v219
    v_mfma_f32_16x16x32_bf16 v[208:211], v[136:139], a[8:11], v[208:211]
    ds_read_b64_tr_b16 v[172:173], v2 offset:776
    ds_read_b64_tr_b16 v[174:175], v2 offset:4872
    v_mfma_f32_16x16x32_bf16 v[208:211], v[140:143], a[12:15], v[208:211]
    v_cvt_pk_bf16_f32 v235, v218, v219
    v_mfma_f32_16x16x32_bf16 v[220:223], v[112:115], a[64:67], v[192:195]
    v_exp_f32_e64 v204, v204
    v_mfma_f32_16x16x32_bf16 v[220:223], v[116:119], a[68:71], v[220:223]
    v_exp_f32_e64 v205, v205
    v_mfma_f32_16x16x32_bf16 v[220:223], v[120:123], a[72:75], v[220:223]
    v_exp_f32_e64 v206, v206
    v_mfma_f32_16x16x32_bf16 v[220:223], v[124:127], a[76:79], v[220:223]
    v_exp_f32_e64 v207, v207
    v_mfma_f32_16x16x32_bf16 v[224:227], v[128:131], a[64:67], v[192:195]
    v_exp_f32_e64 v208, v208
    v_mfma_f32_16x16x32_bf16 v[224:227], v[132:135], a[68:71], v[224:227]
    v_exp_f32_e64 v209, v209
    v_mfma_f32_16x16x32_bf16 v[224:227], v[136:139], a[72:75], v[224:227]
    v_exp_f32_e64 v210, v210
    v_mfma_f32_16x16x32_bf16 v[224:227], v[140:143], a[76:79], v[224:227]
    s_waitcnt vmcnt(8) lgkmcnt(0)
    s_barrier
    v_mfma_f32_16x16x32_bf16 a[112:115], v[144:147], v[232:235], a[112:115]
    v_cvt_pk_bf16_f32 v228, v204, v205
    v_cvt_pk_bf16_f32 v229, v206, v207
    v_mfma_f32_16x16x32_bf16 a[116:119], v[148:151], v[232:235], a[116:119]
    v_exp_f32_e64 v211, v211
    v_mfma_f32_16x16x32_bf16 a[120:123], v[152:155], v[232:235], a[120:123]
    v_cvt_pk_bf16_f32 v230, v208, v209
    v_cvt_pk_bf16_f32 v231, v210, v211
    v_mfma_f32_16x16x32_bf16 a[124:127], v[156:159], v[232:235], a[124:127]
    buffer_load_dwordx4 v6, s[24:27], s92 offen nt lds
    v_mfma_f32_16x16x32_bf16 a[128:131], v[160:163], v[232:235], a[128:131]
    v_exp_f32_e64 v220, v220
    v_mfma_f32_16x16x32_bf16 a[132:135], v[164:167], v[232:235], a[132:135]
    v_exp_f32_e64 v221, v221
    v_mfma_f32_16x16x32_bf16 a[136:139], v[168:171], v[232:235], a[136:139]
    v_exp_f32_e64 v222, v222
    v_mfma_f32_16x16x32_bf16 a[140:143], v[172:175], v[232:235], a[140:143]
    buffer_load_dwordx4 v6, s[24:27], s92 offen offset:1024 nt lds
    v_smfmac_f32_16x16x64_bf16 v[240:243], a[240:243], v[228:235], v12
    v_cvt_pk_bf16_f32 v232, v220, v221
    v_mfma_f32_16x16x32_bf16 v[16:19], v[144:147], v[228:231], v[16:19]
    v_exp_f32_e64 v223, v223
    v_mfma_f32_16x16x32_bf16 v[20:23], v[148:151], v[228:231], v[20:23]
    v_exp_f32_e64 v224, v224
    v_mfma_f32_16x16x32_bf16 v[24:27], v[152:155], v[228:231], v[24:27]
    buffer_load_dwordx4 v6, s[24:27], s92 offen offset:2048 nt lds
    v_mfma_f32_16x16x32_bf16 v[28:31], v[156:159], v[228:231], v[28:31]
    v_exp_f32_e64 v225, v225
    v_mfma_f32_16x16x32_bf16 v[32:35], v[160:163], v[228:231], v[32:35]
    v_exp_f32_e64 v226, v226
    v_mfma_f32_16x16x32_bf16 v[36:39], v[164:167], v[228:231], v[36:39]
    v_cvt_pk_bf16_f32 v233, v222, v223
    v_cvt_pk_bf16_f32 v234, v224, v225
    v_mfma_f32_16x16x32_bf16 v[40:43], v[168:171], v[228:231], v[40:43]
    buffer_load_dwordx4 v6, s[24:27], s92 offen offset:3072 nt lds
    v_mfma_f32_16x16x32_bf16 v[44:47], v[172:175], v[228:231], v[44:47]
    v_exp_f32_e64 v227, v227
    v_mfma_f32_16x16x32_bf16 v[204:207], v[112:115], a[16:19], v[180:183]
    v_cvt_pk_bf16_f32 v235, v226, v227
    s_add_u32 m0, m0, 4096
    v_mfma_f32_16x16x32_bf16 v[204:207], v[116:119], a[20:23], v[204:207]
    s_add_u32 s93, s39, 32768
    v_mfma_f32_16x16x32_bf16 v[204:207], v[120:123], a[24:27], v[204:207]
    buffer_load_dwordx4 v6, s[28:31], s92 offen nt lds
    v_mfma_f32_16x16x32_bf16 v[204:207], v[124:127], a[28:31], v[204:207]
    s_cmp_lt_u32 s93, 163840
    s_cselect_b32 s38, s93, s37
    v_mfma_f32_16x16x32_bf16 v[208:211], v[128:131], a[16:19], v[180:183]
    v_add_u32_e64 v1, s38, v4
    s_nop 0
    v_mfma_f32_16x16x32_bf16 v[208:211], v[132:135], a[20:23], v[208:211]
    s_nop 0
    s_nop 0
    v_mfma_f32_16x16x32_bf16 v[208:211], v[136:139], a[24:27], v[208:211]
    buffer_load_dwordx4 v6, s[28:31], s92 offen offset:1024 nt lds
    v_mfma_f32_16x16x32_bf16 v[208:211], v[140:143], a[28:31], v[208:211]
    v_exp_f32_e64 v204, v204
    v_mfma_f32_16x16x32_bf16 a[144:147], v[144:147], v[232:235], a[144:147]
    v_exp_f32_e64 v205, v205
    v_mfma_f32_16x16x32_bf16 a[148:151], v[148:151], v[232:235], a[148:151]
    v_exp_f32_e64 v206, v206
    v_mfma_f32_16x16x32_bf16 a[152:155], v[152:155], v[232:235], a[152:155]
    buffer_load_dwordx4 v6, s[28:31], s92 offen offset:2048 nt lds
    v_mfma_f32_16x16x32_bf16 a[156:159], v[156:159], v[232:235], a[156:159]
    v_exp_f32_e64 v207, v207
    v_mfma_f32_16x16x32_bf16 a[160:163], v[160:163], v[232:235], a[160:163]
    v_exp_f32_e64 v208, v208
    v_mfma_f32_16x16x32_bf16 a[164:167], v[164:167], v[232:235], a[164:167]
    v_exp_f32_e64 v209, v209
    v_mfma_f32_16x16x32_bf16 a[168:171], v[168:171], v[232:235], a[168:171]
    v_exp_f32_e64 v210, v210
    v_mfma_f32_16x16x32_bf16 a[172:175], v[172:175], v[232:235], a[172:175]
    buffer_load_dwordx4 v6, s[28:31], s92 offen offset:3072 nt lds
    v_mfma_f32_16x16x32_bf16 v[212:215], v[112:115], a[32:35], v[184:187]
    v_cvt_pk_bf16_f32 v228, v204, v205
    v_cvt_pk_bf16_f32 v229, v206, v207
    v_mfma_f32_16x16x32_bf16 v[212:215], v[116:119], a[36:39], v[212:215]
    v_exp_f32_e64 v211, v211
    v_mfma_f32_16x16x32_bf16 v[212:215], v[120:123], a[40:43], v[212:215]
    v_cvt_pk_bf16_f32 v230, v208, v209
    v_cvt_pk_bf16_f32 v231, v210, v211
    v_mfma_f32_16x16x32_bf16 v[212:215], v[124:127], a[44:47], v[212:215]
    s_and_b32 m0, s39, 0x7fffffff
    v_mfma_f32_16x16x32_bf16 v[216:219], v[128:131], a[32:35], v[184:187]
    s_add_u32 s93, s38, 32768
    s_nop 0
    v_mfma_f32_16x16x32_bf16 v[216:219], v[132:135], a[36:39], v[216:219]
    s_cmp_lt_u32 s93, 163840
    s_cselect_b32 s39, s93, s37
    v_mfma_f32_16x16x32_bf16 v[216:219], v[136:139], a[40:43], v[216:219]
    v_exp_f32_e64 v212, v212
    v_mfma_f32_16x16x32_bf16 v[216:219], v[140:143], a[44:47], v[216:219]
    v_exp_f32_e64 v213, v213
    v_smfmac_f32_16x16x64_bf16 v[244:247], a[240:243], v[228:235], v12
    v_cvt_pk_bf16_f32 v232, v212, v213
    v_mfma_f32_16x16x32_bf16 v[48:51], v[144:147], v[228:231], v[48:51]
    v_exp_f32_e64 v214, v214
    v_mfma_f32_16x16x32_bf16 v[52:55], v[148:151], v[228:231], v[52:55]
    v_exp_f32_e64 v215, v215
    v_mfma_f32_16x16x32_bf16 v[56:59], v[152:155], v[228:231], v[56:59]
    v_exp_f32_e64 v216, v216
    v_mfma_f32_16x16x32_bf16 v[60:63], v[156:159], v[228:231], v[60:63]
    v_exp_f32_e64 v217, v217
    v_mfma_f32_16x16x32_bf16 v[64:67], v[160:163], v[228:231], v[64:67]
    v_exp_f32_e64 v218, v218
    v_mfma_f32_16x16x32_bf16 v[68:71], v[164:167], v[228:231], v[68:71]
    v_cvt_pk_bf16_f32 v233, v214, v215
    v_cvt_pk_bf16_f32 v234, v216, v217
    v_mfma_f32_16x16x32_bf16 v[72:75], v[168:171], v[228:231], v[72:75]
    v_exp_f32_e64 v219, v219
    v_mfma_f32_16x16x32_bf16 v[76:79], v[172:175], v[228:231], v[76:79]
    v_cvt_pk_bf16_f32 v235, v218, v219
    v_add_u32_e64 v2, s39, v5
    v_mfma_f32_16x16x32_bf16 v[204:207], v[112:115], a[80:83], v[196:199]
    ds_read_b128 v[112:115], v1
    v_mfma_f32_16x16x32_bf16 v[204:207], v[116:119], a[84:87], v[204:207]
    ds_read_b128 v[116:119], v1 offset:256
    v_mfma_f32_16x16x32_bf16 v[204:207], v[120:123], a[88:91], v[204:207]
    ds_read_b128 v[120:123], v1 offset:512
    v_mfma_f32_16x16x32_bf16 v[204:207], v[124:127], a[92:95], v[204:207]
    ds_read_b128 v[124:127], v1 offset:768
    v_mfma_f32_16x16x32_bf16 v[208:211], v[128:131], a[80:83], v[196:199]
    ds_read_b128 v[128:131], v1 offset:4096
    v_mfma_f32_16x16x32_bf16 v[208:211], v[132:135], a[84:87], v[208:211]
    buffer_load_dwordx4 v6, s[16:19], s92 offen nt lds
    v_mfma_f32_16x16x32_bf16 v[208:211], v[136:139], a[88:91], v[208:211]
    ds_read_b128 v[132:135], v1 offset:4352
    v_mfma_f32_16x16x32_bf16 v[208:211], v[140:143], a[92:95], v[208:211]
    ds_read_b128 v[136:139], v1 offset:4608
    v_mfma_f32_16x16x32_bf16 v[80:83], v[144:147], v[232:235], v[80:83]
    ds_read_b128 v[140:143], v1 offset:4864
    v_mfma_f32_16x16x32_bf16 v[84:87], v[148:151], v[232:235], v[84:87]
    v_mfma_f32_16x16x32_bf16 v[88:91], v[152:155], v[232:235], v[88:91]
    v_mfma_f32_16x16x32_bf16 v[92:95], v[156:159], v[232:235], v[92:95]
    v_exp_f32_e64 v204, v204
    v_mfma_f32_16x16x32_bf16 v[96:99], v[160:163], v[232:235], v[96:99]
    v_exp_f32_e64 v205, v205
    v_mfma_f32_16x16x32_bf16 v[100:103], v[164:167], v[232:235], v[100:103]
    v_exp_f32_e64 v206, v206
    v_mfma_f32_16x16x32_bf16 v[104:107], v[168:171], v[232:235], v[104:107]
    v_exp_f32_e64 v207, v207
    v_mfma_f32_16x16x32_bf16 v[108:111], v[172:175], v[232:235], v[108:111]
X_loop:
    s_waitcnt lgkmcnt(0)
    v_mfma_f32_16x16x32_bf16 v[220:223], v[112:115], a[96:99], v[200:203]
    v_exp_f32 v208, v208
    v_mfma_f32_16x16x32_bf16 v[220:223], v[116:119], a[100:103], v[220:223]
    v_exp_f32_e64 v209, v209
    v_mfma_f32_16x16x32_bf16 v[220:223], v[120:123], a[104:107], v[220:223]
    v_exp_f32_e64 v210, v210
    v_mfma_f32_16x16x32_bf16 v[220:223], v[124:127], a[108:111], v[220:223]
    v_cvt_pk_bf16_f32 v236, v204, v205
    v_cvt_pk_bf16_f32 v237, v206, v207
    v_mfma_f32_16x16x32_bf16 v[224:227], v[128:131], a[96:99], v[200:203]
    v_exp_f32_e64 v211, v211
    v_mfma_f32_16x16x32_bf16 v[224:227], v[132:135], a[100:103], v[224:227]
    v_cvt_pk_bf16_f32 v238, v208, v209
    v_cvt_pk_bf16_f32 v239, v210, v211
    v_mfma_f32_16x16x32_bf16 v[224:227], v[136:139], a[104:107], v[224:227]
    buffer_load_dwordx4 v7, s[16:19], s92 offen offset:1024 nt lds
    v_mfma_f32_16x16x32_bf16 v[224:227], v[140:143], a[108:111], v[224:227]
    v_exp_f32_e64 v220, v220
    v_smfmac_f32_16x16x64_bf16 v[248:251], a[240:243], v[232:239], v12
    v_mfma_f32_16x16x32_bf16 a[176:179], v[144:147], v[236:239], a[176:179]
    ds_read_b64_tr_b16 v[144:145], v2
    ds_read_b64_tr_b16 v[146:147], v2 offset:4096
    v_mfma_f32_16x16x32_bf16 a[180:183], v[148:151], v[236:239], a[180:183]
    v_exp_f32_e64 v221, v221
    v_mfma_f32_16x16x32_bf16 a[184:187], v[152:155], v[236:239], a[184:187]
    ds_read_b64_tr_b16 v[148:149], v2 offset:8
    ds_read_b64_tr_b16 v[150:151], v2 offset:4104
    v_mfma_f32_16x16x32_bf16 a[188:191], v[156:159], v[236:239], a[188:191]
    v_exp_f32_e64 v222, v222
    v_mfma_f32_16x16x32_bf16 a[192:195], v[160:163], v[236:239], a[192:195]
    ds_read_b64_tr_b16 v[152:153], v2 offset:256
    ds_read_b64_tr_b16 v[154:155], v2 offset:4352
    v_mfma_f32_16x16x32_bf16 a[196:199], v[164:167], v[236:239], a[196:199]
    buffer_load_dwordx4 v8, s[16:19], s92 offen offset:2048 nt lds
    v_mfma_f32_16x16x32_bf16 a[200:203], v[168:171], v[236:239], a[200:203]
    ds_read_b64_tr_b16 v[156:157], v2 offset:264
    ds_read_b64_tr_b16 v[158:159], v2 offset:4360
    v_mfma_f32_16x16x32_bf16 a[204:207], v[172:175], v[236:239], a[204:207]
    v_exp_f32_e64 v223, v223
    v_mfma_f32_16x16x32_bf16 v[212:215], v[112:115], a[48:51], v[188:191]
    ds_read_b64_tr_b16 v[160:161], v2 offset:512
    ds_read_b64_tr_b16 v[162:163], v2 offset:4608
    v_mfma_f32_16x16x32_bf16 v[212:215], v[116:119], a[52:55], v[212:215]
    v_exp_f32_e64 v224, v224
    v_mfma_f32_16x16x32_bf16 v[212:215], v[120:123], a[56:59], v[212:215]
    ds_read_b64_tr_b16 v[164:165], v2 offset:520
    ds_read_b64_tr_b16 v[166:167], v2 offset:4616
    v_mfma_f32_16x16x32_bf16 v[212:215], v[124:127], a[60:63], v[212:215]
    v_exp_f32_e64 v225, v225
    v_mfma_f32_16x16x32_bf16 v[216:219], v[128:131], a[48:51], v[188:191]
    ds_read_b64_tr_b16 v[168:169], v2 offset:768
    ds_read_b64_tr_b16 v[170:171], v2 offset:4864
    v_mfma_f32_16x16x32_bf16 v[216:219], v[132:135], a[52:55], v[216:219]
    v_exp_f32_e64 v226, v226
    v_mfma_f32_16x16x32_bf16 v[216:219], v[136:139], a[56:59], v[216:219]
    ds_read_b64_tr_b16 v[172:173], v2 offset:776
    ds_read_b64_tr_b16 v[174:175], v2 offset:4872
    v_mfma_f32_16x16x32_bf16 v[216:219], v[140:143], a[60:63], v[216:219]
    v_cvt_pk_bf16_f32 v228, v220, v221
    v_cvt_pk_bf16_f32 v229, v222, v223
    v_mfma_f32_16x16x32_bf16 v[204:207], v[112:115], a[0:3], v[176:179]
    v_exp_f32_e64 v227, v227
    v_mfma_f32_16x16x32_bf16 v[204:207], v[116:119], a[4:7], v[204:207]
    v_cvt_pk_bf16_f32 v230, v224, v225
    v_cvt_pk_bf16_f32 v231, v226, v227
    v_mfma_f32_16x16x32_bf16 v[204:207], v[120:123], a[8:11], v[204:207]
    v_exp_f32_e64 v212, v212
    v_mfma_f32_16x16x32_bf16 v[204:207], v[124:127], a[12:15], v[204:207]
    v_exp_f32_e64 v213, v213
    v_mfma_f32_16x16x32_bf16 v[208:211], v[128:131], a[0:3], v[176:179]
    v_exp_f32_e64 v214, v214
    v_mfma_f32_16x16x32_bf16 v[208:211], v[132:135], a[4:7], v[208:211]
    v_exp_f32_e64 v215, v215
    v_mfma_f32_16x16x32_bf16 v[208:211], v[136:139], a[8:11], v[208:211]
    v_exp_f32_e64 v216, v216
    v_mfma_f32_16x16x32_bf16 v[208:211], v[140:143], a[12:15], v[208:211]
    v_exp_f32_e64 v217, v217
    v_mfma_f32_16x16x32_bf16 v[252:255], a[240:243], v[228:231], v[252:255]
    v_cvt_pk_bf16_f32 v232, v212, v213
    s_waitcnt lgkmcnt(0)
    v_mfma_f32_16x16x32_bf16 a[208:211], v[144:147], v[228:231], a[208:211]
    v_exp_f32 v218, v218
    v_mfma_f32_16x16x32_bf16 a[212:215], v[148:151], v[228:231], a[212:215]
    buffer_load_dwordx4 v9, s[16:19], s92 offen offset:3072 nt lds
    v_mfma_f32_16x16x32_bf16 a[216:219], v[152:155], v[228:231], a[216:219]
    v_cvt_pk_bf16_f32 v233, v214, v215
    v_cvt_pk_bf16_f32 v234, v216, v217
    v_mfma_f32_16x16x32_bf16 a[220:223], v[156:159], v[228:231], a[220:223]
    v_exp_f32_e64 v219, v219
    v_mfma_f32_16x16x32_bf16 a[224:227], v[160:163], v[228:231], a[224:227]
    v_cvt_pk_bf16_f32 v235, v218, v219
    v_xor_b32 v1, 0x2000, v1
    v_mfma_f32_16x16x32_bf16 a[228:231], v[164:167], v[228:231], a[228:231]
    v_exp_f32_e64 v204, v204
    v_mfma_f32_16x16x32_bf16 a[232:235], v[168:171], v[228:231], a[232:235]
    v_exp_f32_e64 v205, v205
    v_mfma_f32_16x16x32_bf16 a[236:239], v[172:175], v[228:231], a[236:239]
    v_exp_f32_e64 v206, v206
    v_mfma_f32_16x16x32_bf16 a[112:115], v[144:147], v[232:235], a[112:115]
    v_exp_f32_e64 v207, v207
    v_mfma_f32_16x16x32_bf16 a[116:119], v[148:151], v[232:235], a[116:119]
    v_exp_f32_e64 v208, v208
    v_mfma_f32_16x16x32_bf16 a[120:123], v[152:155], v[232:235], a[120:123]
    v_exp_f32_e64 v209, v209
    v_mfma_f32_16x16x32_bf16 a[124:127], v[156:159], v[232:235], a[124:127]
    v_exp_f32_e64 v210, v210
    v_mfma_f32_16x16x32_bf16 a[128:131], v[160:163], v[232:235], a[128:131]
    s_add_u32 m0, m0, 4096
    v_cvt_pk_bf16_f32 v228, v204, v205
    v_mfma_f32_16x16x32_bf16 a[132:135], v[164:167], v[232:235], a[132:135]
    buffer_load_dwordx4 v6, s[20:23], s92 offen nt lds
    v_mfma_f32_16x16x32_bf16 a[136:139], v[168:171], v[232:235], a[136:139]
    v_cvt_pk_bf16_f32 v229, v206, v207
    v_cvt_pk_bf16_f32 v230, v208, v209
    v_mfma_f32_16x16x32_bf16 a[140:143], v[172:175], v[232:235], a[140:143]
    v_exp_f32_e64 v211, v211
    v_mfma_f32_16x16x32_bf16 v[212:215], v[112:115], a[64:67], v[192:195]
    v_cvt_pk_bf16_f32 v231, v210, v211
    v_xor_b32 v2, 0x2000, v2
    v_mfma_f32_16x16x32_bf16 v[212:215], v[116:119], a[68:71], v[212:215]
    v_mfma_f32_16x16x32_bf16 v[212:215], v[120:123], a[72:75], v[212:215]
    v_mfma_f32_16x16x32_bf16 v[212:215], v[124:127], a[76:79], v[212:215]
    v_mfma_f32_16x16x32_bf16 v[216:219], v[128:131], a[64:67], v[192:195]
    s_nop 0
    s_nop 0
    v_mfma_f32_16x16x32_bf16 v[216:219], v[132:135], a[68:71], v[216:219]
    s_nop 0
    s_nop 0
    v_mfma_f32_16x16x32_bf16 v[216:219], v[136:139], a[72:75], v[216:219]
    s_nop 0
    v_mfma_f32_16x16x32_bf16 v[216:219], v[140:143], a[76:79], v[216:219]
    v_exp_f32 v212, v212
    v_smfmac_f32_16x16x64_bf16 v[240:243], a[240:243], v[228:235], v12
    v_mfma_f32_16x16x32_bf16 v[16:19], v[144:147], v[228:231], v[16:19]
    v_exp_f32_e64 v213, v213
    v_mfma_f32_16x16x32_bf16 v[20:23], v[148:151], v[228:231], v[20:23]
    v_exp_f32_e64 v214, v214
    v_mfma_f32_16x16x32_bf16 v[24:27], v[152:155], v[228:231], v[24:27]
    v_exp_f32_e64 v215, v215
    v_mfma_f32_16x16x32_bf16 v[28:31], v[156:159], v[228:231], v[28:31]
    v_exp_f32_e64 v216, v216
    v_mfma_f32_16x16x32_bf16 v[32:35], v[160:163], v[228:231], v[32:35]
    v_exp_f32_e64 v217, v217
    v_mfma_f32_16x16x32_bf16 v[36:39], v[164:167], v[228:231], v[36:39]
    buffer_load_dwordx4 v7, s[20:23], s92 offen offset:1024 nt lds
    v_mfma_f32_16x16x32_bf16 v[40:43], v[168:171], v[228:231], v[40:43]
    v_exp_f32_e64 v218, v218
    v_mfma_f32_16x16x32_bf16 v[44:47], v[172:175], v[228:231], v[44:47]
    v_cvt_pk_bf16_f32 v232, v212, v213
    v_cvt_pk_bf16_f32 v233, v214, v215
    v_mfma_f32_16x16x32_bf16 v[204:207], v[112:115], a[16:19], v[180:183]
    v_exp_f32_e64 v219, v219
    v_mfma_f32_16x16x32_bf16 v[204:207], v[116:119], a[20:23], v[204:207]
    v_cvt_pk_bf16_f32 v234, v216, v217
    v_cvt_pk_bf16_f32 v235, v218, v219
    v_mfma_f32_16x16x32_bf16 v[204:207], v[120:123], a[24:27], v[204:207]
    v_mfma_f32_16x16x32_bf16 v[204:207], v[124:127], a[28:31], v[204:207]
    v_mfma_f32_16x16x32_bf16 v[208:211], v[128:131], a[16:19], v[180:183]
    s_nop 0
    s_nop 0
    v_mfma_f32_16x16x32_bf16 v[208:211], v[132:135], a[20:23], v[208:211]
    s_nop 0
    s_nop 0
    v_mfma_f32_16x16x32_bf16 v[208:211], v[136:139], a[24:27], v[208:211]
    s_nop 0
    v_mfma_f32_16x16x32_bf16 v[208:211], v[140:143], a[28:31], v[208:211]
    v_exp_f32 v204, v204
    v_mfma_f32_16x16x32_bf16 a[144:147], v[144:147], v[232:235], a[144:147]
    v_exp_f32_e64 v205, v205
    v_mfma_f32_16x16x32_bf16 a[148:151], v[148:151], v[232:235], a[148:151]
    v_exp_f32_e64 v206, v206
    v_mfma_f32_16x16x32_bf16 a[152:155], v[152:155], v[232:235], a[152:155]
    v_exp_f32_e64 v207, v207
    v_mfma_f32_16x16x32_bf16 a[156:159], v[156:159], v[232:235], a[156:159]
    v_exp_f32_e64 v208, v208
    v_mfma_f32_16x16x32_bf16 a[160:163], v[160:163], v[232:235], a[160:163]
    v_exp_f32_e64 v209, v209
    v_mfma_f32_16x16x32_bf16 a[164:167], v[164:167], v[232:235], a[164:167]
    buffer_load_dwordx4 v8, s[20:23], s92 offen offset:2048 nt lds
    v_mfma_f32_16x16x32_bf16 a[168:171], v[168:171], v[232:235], a[168:171]
    v_exp_f32_e64 v210, v210
    v_mfma_f32_16x16x32_bf16 a[172:175], v[172:175], v[232:235], a[172:175]
    v_cvt_pk_bf16_f32 v228, v204, v205
    v_cvt_pk_bf16_f32 v229, v206, v207
    v_mfma_f32_16x16x32_bf16 v[212:215], v[112:115], a[80:83], v[196:199]
    v_exp_f32_e64 v211, v211
    v_mfma_f32_16x16x32_bf16 v[212:215], v[116:119], a[84:87], v[212:215]
    v_cvt_pk_bf16_f32 v230, v208, v209
    v_cvt_pk_bf16_f32 v231, v210, v211
    v_mfma_f32_16x16x32_bf16 v[212:215], v[120:123], a[88:91], v[212:215]
    v_mfma_f32_16x16x32_bf16 v[212:215], v[124:127], a[92:95], v[212:215]
    v_mfma_f32_16x16x32_bf16 v[216:219], v[128:131], a[80:83], v[196:199]
    s_nop 0
    s_nop 0
    v_mfma_f32_16x16x32_bf16 v[216:219], v[132:135], a[84:87], v[216:219]
    s_nop 0
    s_nop 0
    v_mfma_f32_16x16x32_bf16 v[216:219], v[136:139], a[88:91], v[216:219]
    s_nop 0
    v_mfma_f32_16x16x32_bf16 v[216:219], v[140:143], a[92:95], v[216:219]
    v_exp_f32 v212, v212
    v_smfmac_f32_16x16x64_bf16 v[244:247], a[240:243], v[228:235], v12
    v_mfma_f32_16x16x32_bf16 v[48:51], v[144:147], v[228:231], v[48:51]
    v_exp_f32_e64 v213, v213
    v_mfma_f32_16x16x32_bf16 v[52:55], v[148:151], v[228:231], v[52:55]
    v_exp_f32_e64 v214, v214
    v_mfma_f32_16x16x32_bf16 v[56:59], v[152:155], v[228:231], v[56:59]
    v_exp_f32_e64 v215, v215
    v_mfma_f32_16x16x32_bf16 v[60:63], v[156:159], v[228:231], v[60:63]
    v_exp_f32_e64 v216, v216
    v_mfma_f32_16x16x32_bf16 v[64:67], v[160:163], v[228:231], v[64:67]
    buffer_load_dwordx4 v9, s[20:23], s92 offen offset:3072 nt lds
    v_mfma_f32_16x16x32_bf16 v[68:71], v[164:167], v[228:231], v[68:71]
    v_exp_f32_e64 v217, v217
    v_mfma_f32_16x16x32_bf16 v[72:75], v[168:171], v[228:231], v[72:75]
    v_exp_f32_e64 v218, v218
    v_mfma_f32_16x16x32_bf16 v[76:79], v[172:175], v[228:231], v[76:79]
    v_cvt_pk_bf16_f32 v232, v212, v213
    v_cvt_pk_bf16_f32 v233, v214, v215
    v_mfma_f32_16x16x32_bf16 v[204:207], v[112:115], a[32:35], v[184:187]
    ds_read_b128 v[112:115], v1
    v_cvt_pk_bf16_f32 v234, v216, v217
    v_mfma_f32_16x16x32_bf16 v[204:207], v[116:119], a[36:39], v[204:207]
    ds_read_b128 v[116:119], v1 offset:256
    s_add_u32 s92, s92, 32768
    v_mfma_f32_16x16x32_bf16 v[204:207], v[120:123], a[40:43], v[204:207]
    ds_read_b128 v[120:123], v1 offset:512
    v_mfma_f32_16x16x32_bf16 v[204:207], v[124:127], a[44:47], v[204:207]
    ds_read_b128 v[124:127], v1 offset:768
    v_mfma_f32_16x16x32_bf16 v[208:211], v[128:131], a[32:35], v[184:187]
    v_exp_f32_e64 v219, v219
    v_mfma_f32_16x16x32_bf16 v[208:211], v[132:135], a[36:39], v[208:211]
    ds_read_b128 v[128:131], v1 offset:4096
    v_cvt_pk_bf16_f32 v235, v218, v219
    v_mfma_f32_16x16x32_bf16 v[208:211], v[136:139], a[40:43], v[208:211]
    ds_read_b128 v[132:135], v1 offset:4352
    v_mfma_f32_16x16x32_bf16 v[208:211], v[140:143], a[44:47], v[208:211]
    ds_read_b128 v[136:139], v1 offset:4608
    v_mfma_f32_16x16x32_bf16 a[176:179], v[144:147], v[232:235], a[176:179]
    ds_read_b128 v[140:143], v1 offset:4864
    v_mfma_f32_16x16x32_bf16 a[180:183], v[148:151], v[232:235], a[180:183]
    v_mfma_f32_16x16x32_bf16 a[184:187], v[152:155], v[232:235], a[184:187]
    v_mfma_f32_16x16x32_bf16 a[188:191], v[156:159], v[232:235], a[188:191]
    v_exp_f32_e64 v204, v204
    v_mfma_f32_16x16x32_bf16 a[192:195], v[160:163], v[232:235], a[192:195]
    v_exp_f32_e64 v205, v205
    v_mfma_f32_16x16x32_bf16 a[196:199], v[164:167], v[232:235], a[196:199]
    v_exp_f32_e64 v206, v206
    v_mfma_f32_16x16x32_bf16 a[200:203], v[168:171], v[232:235], a[200:203]
    v_exp_f32_e64 v207, v207
    v_mfma_f32_16x16x32_bf16 a[204:207], v[172:175], v[232:235], a[204:207]
    v_cvt_pk_bf16_f32 v228, v204, v205
    s_waitcnt lgkmcnt(0)
    v_mfma_f32_16x16x32_bf16 v[212:215], v[112:115], a[48:51], v[188:191]
    v_exp_f32 v208, v208
    v_mfma_f32_16x16x32_bf16 v[212:215], v[116:119], a[52:55], v[212:215]
    v_exp_f32_e64 v209, v209
    v_mfma_f32_16x16x32_bf16 v[212:215], v[120:123], a[56:59], v[212:215]
    v_exp_f32_e64 v210, v210
    v_mfma_f32_16x16x32_bf16 v[212:215], v[124:127], a[60:63], v[212:215]
    v_cvt_pk_bf16_f32 v229, v206, v207
    v_cvt_pk_bf16_f32 v230, v208, v209
    v_mfma_f32_16x16x32_bf16 v[216:219], v[128:131], a[48:51], v[188:191]
    v_exp_f32_e64 v211, v211
    v_mfma_f32_16x16x32_bf16 v[216:219], v[132:135], a[52:55], v[216:219]
    v_cvt_pk_bf16_f32 v231, v210, v211
    s_nop 0
    v_mfma_f32_16x16x32_bf16 v[216:219], v[136:139], a[56:59], v[216:219]
    v_exp_f32 v212, v212
    v_mfma_f32_16x16x32_bf16 v[216:219], v[140:143], a[60:63], v[216:219]
    v_exp_f32_e64 v213, v213
    v_smfmac_f32_16x16x64_bf16 v[248:251], a[240:243], v[228:235], v12
    v_cvt_pk_bf16_f32 v232, v212, v213
    v_mfma_f32_16x16x32_bf16 v[80:83], v[144:147], v[228:231], v[80:83]
    ds_read_b64_tr_b16 v[144:145], v2
    ds_read_b64_tr_b16 v[146:147], v2 offset:4096
    v_mfma_f32_16x16x32_bf16 v[84:87], v[148:151], v[228:231], v[84:87]
    v_exp_f32_e64 v214, v214
    v_mfma_f32_16x16x32_bf16 v[88:91], v[152:155], v[228:231], v[88:91]
    ds_read_b64_tr_b16 v[148:149], v2 offset:8
    ds_read_b64_tr_b16 v[150:151], v2 offset:4104
    v_mfma_f32_16x16x32_bf16 v[92:95], v[156:159], v[228:231], v[92:95]
    v_exp_f32_e64 v215, v215
    v_mfma_f32_16x16x32_bf16 v[96:99], v[160:163], v[228:231], v[96:99]
    ds_read_b64_tr_b16 v[152:153], v2 offset:256
    ds_read_b64_tr_b16 v[154:155], v2 offset:4352
    v_mfma_f32_16x16x32_bf16 v[100:103], v[164:167], v[228:231], v[100:103]
    v_exp_f32_e64 v216, v216
    v_mfma_f32_16x16x32_bf16 v[104:107], v[168:171], v[228:231], v[104:107]
    ds_read_b64_tr_b16 v[156:157], v2 offset:264
    ds_read_b64_tr_b16 v[158:159], v2 offset:4360
    v_mfma_f32_16x16x32_bf16 v[108:111], v[172:175], v[228:231], v[108:111]
    v_exp_f32_e64 v217, v217
    v_mfma_f32_16x16x32_bf16 v[204:207], v[112:115], a[0:3], v[176:179]
    ds_read_b64_tr_b16 v[160:161], v2 offset:512
    ds_read_b64_tr_b16 v[162:163], v2 offset:4608
    v_mfma_f32_16x16x32_bf16 v[204:207], v[116:119], a[4:7], v[204:207]
    v_exp_f32_e64 v218, v218
    v_mfma_f32_16x16x32_bf16 v[204:207], v[120:123], a[8:11], v[204:207]
    ds_read_b64_tr_b16 v[164:165], v2 offset:520
    ds_read_b64_tr_b16 v[166:167], v2 offset:4616
    v_mfma_f32_16x16x32_bf16 v[204:207], v[124:127], a[12:15], v[204:207]
    v_cvt_pk_bf16_f32 v233, v214, v215
    v_cvt_pk_bf16_f32 v234, v216, v217
    v_mfma_f32_16x16x32_bf16 v[208:211], v[128:131], a[0:3], v[176:179]
    ds_read_b64_tr_b16 v[168:169], v2 offset:768
    ds_read_b64_tr_b16 v[170:171], v2 offset:4864
    v_mfma_f32_16x16x32_bf16 v[208:211], v[132:135], a[4:7], v[208:211]
    v_exp_f32_e64 v219, v219
    v_mfma_f32_16x16x32_bf16 v[208:211], v[136:139], a[8:11], v[208:211]
    ds_read_b64_tr_b16 v[172:173], v2 offset:776
    ds_read_b64_tr_b16 v[174:175], v2 offset:4872
    v_mfma_f32_16x16x32_bf16 v[208:211], v[140:143], a[12:15], v[208:211]
    v_cvt_pk_bf16_f32 v235, v218, v219
    s_and_b32 m0, s38, 0x7fffffff
    v_mfma_f32_16x16x32_bf16 v[220:223], v[112:115], a[64:67], v[192:195]
    v_exp_f32_e64 v204, v204
    v_mfma_f32_16x16x32_bf16 v[220:223], v[116:119], a[68:71], v[220:223]
    v_exp_f32_e64 v205, v205
    v_mfma_f32_16x16x32_bf16 v[220:223], v[120:123], a[72:75], v[220:223]
    v_exp_f32_e64 v206, v206
    v_mfma_f32_16x16x32_bf16 v[220:223], v[124:127], a[76:79], v[220:223]
    v_exp_f32_e64 v207, v207
    v_mfma_f32_16x16x32_bf16 v[224:227], v[128:131], a[64:67], v[192:195]
    v_exp_f32_e64 v208, v208
    v_mfma_f32_16x16x32_bf16 v[224:227], v[132:135], a[68:71], v[224:227]
    v_exp_f32_e64 v209, v209
    v_mfma_f32_16x16x32_bf16 v[224:227], v[136:139], a[72:75], v[224:227]
    v_exp_f32_e64 v210, v210
    v_mfma_f32_16x16x32_bf16 v[224:227], v[140:143], a[76:79], v[224:227]
    s_waitcnt vmcnt(8) lgkmcnt(0)
    s_barrier
    v_mfma_f32_16x16x32_bf16 a[112:115], v[144:147], v[232:235], a[112:115]
    v_cvt_pk_bf16_f32 v228, v204, v205
    v_cvt_pk_bf16_f32 v229, v206, v207
    v_mfma_f32_16x16x32_bf16 a[116:119], v[148:151], v[232:235], a[116:119]
    v_exp_f32_e64 v211, v211
    v_mfma_f32_16x16x32_bf16 a[120:123], v[152:155], v[232:235], a[120:123]
    v_cvt_pk_bf16_f32 v230, v208, v209
    v_cvt_pk_bf16_f32 v231, v210, v211
    v_mfma_f32_16x16x32_bf16 a[124:127], v[156:159], v[232:235], a[124:127]
    buffer_load_dwordx4 v6, s[24:27], s92 offen nt lds
    v_mfma_f32_16x16x32_bf16 a[128:131], v[160:163], v[232:235], a[128:131]
    v_exp_f32_e64 v220, v220
    v_mfma_f32_16x16x32_bf16 a[132:135], v[164:167], v[232:235], a[132:135]
    v_exp_f32_e64 v221, v221
    v_mfma_f32_16x16x32_bf16 a[136:139], v[168:171], v[232:235], a[136:139]
    v_exp_f32_e64 v222, v222
    v_mfma_f32_16x16x32_bf16 a[140:143], v[172:175], v[232:235], a[140:143]
    buffer_load_dwordx4 v6, s[24:27], s92 offen offset:1024 nt lds
    v_smfmac_f32_16x16x64_bf16 v[240:243], a[240:243], v[228:235], v12
    v_cvt_pk_bf16_f32 v232, v220, v221
    v_mfma_f32_16x16x32_bf16 v[16:19], v[144:147], v[228:231], v[16:19]
    v_exp_f32_e64 v223, v223
    v_mfma_f32_16x16x32_bf16 v[20:23], v[148:151], v[228:231], v[20:23]
    v_exp_f32_e64 v224, v224
    v_mfma_f32_16x16x32_bf16 v[24:27], v[152:155], v[228:231], v[24:27]
    buffer_load_dwordx4 v6, s[24:27], s92 offen offset:2048 nt lds
    v_mfma_f32_16x16x32_bf16 v[28:31], v[156:159], v[228:231], v[28:31]
    v_exp_f32_e64 v225, v225
    v_mfma_f32_16x16x32_bf16 v[32:35], v[160:163], v[228:231], v[32:35]
    v_exp_f32_e64 v226, v226
    v_mfma_f32_16x16x32_bf16 v[36:39], v[164:167], v[228:231], v[36:39]
    v_cvt_pk_bf16_f32 v233, v222, v223
    v_cvt_pk_bf16_f32 v234, v224, v225
    v_mfma_f32_16x16x32_bf16 v[40:43], v[168:171], v[228:231], v[40:43]
    buffer_load_dwordx4 v6, s[24:27], s92 offen offset:3072 nt lds
    v_mfma_f32_16x16x32_bf16 v[44:47], v[172:175], v[228:231], v[44:47]
    v_exp_f32_e64 v227, v227
    v_mfma_f32_16x16x32_bf16 v[204:207], v[112:115], a[16:19], v[180:183]
    v_cvt_pk_bf16_f32 v235, v226, v227
    s_add_u32 m0, m0, 4096
    v_mfma_f32_16x16x32_bf16 v[204:207], v[116:119], a[20:23], v[204:207]
    s_add_u32 s93, s39, 32768
    v_mfma_f32_16x16x32_bf16 v[204:207], v[120:123], a[24:27], v[204:207]
    buffer_load_dwordx4 v6, s[28:31], s92 offen nt lds
    v_mfma_f32_16x16x32_bf16 v[204:207], v[124:127], a[28:31], v[204:207]
    s_cmp_lt_u32 s93, 163840
    s_cselect_b32 s38, s93, s37
    v_mfma_f32_16x16x32_bf16 v[208:211], v[128:131], a[16:19], v[180:183]
    v_add_u32_e64 v1, s38, v4
    s_nop 0
    v_mfma_f32_16x16x32_bf16 v[208:211], v[132:135], a[20:23], v[208:211]
    s_nop 0
    s_nop 0
    v_mfma_f32_16x16x32_bf16 v[208:211], v[136:139], a[24:27], v[208:211]
    buffer_load_dwordx4 v6, s[28:31], s92 offen offset:1024 nt lds
    v_mfma_f32_16x16x32_bf16 v[208:211], v[140:143], a[28:31], v[208:211]
    v_exp_f32_e64 v204, v204
    v_mfma_f32_16x16x32_bf16 a[144:147], v[144:147], v[232:235], a[144:147]
    v_exp_f32_e64 v205, v205
    v_mfma_f32_16x16x32_bf16 a[148:151], v[148:151], v[232:235], a[148:151]
    v_exp_f32_e64 v206, v206
    v_mfma_f32_16x16x32_bf16 a[152:155], v[152:155], v[232:235], a[152:155]
    buffer_load_dwordx4 v6, s[28:31], s92 offen offset:2048 nt lds
    v_mfma_f32_16x16x32_bf16 a[156:159], v[156:159], v[232:235], a[156:159]
    v_exp_f32_e64 v207, v207
    v_mfma_f32_16x16x32_bf16 a[160:163], v[160:163], v[232:235], a[160:163]
    v_exp_f32_e64 v208, v208
    v_mfma_f32_16x16x32_bf16 a[164:167], v[164:167], v[232:235], a[164:167]
    v_exp_f32_e64 v209, v209
    v_mfma_f32_16x16x32_bf16 a[168:171], v[168:171], v[232:235], a[168:171]
    v_exp_f32_e64 v210, v210
    v_mfma_f32_16x16x32_bf16 a[172:175], v[172:175], v[232:235], a[172:175]
    buffer_load_dwordx4 v6, s[28:31], s92 offen offset:3072 nt lds
    v_mfma_f32_16x16x32_bf16 v[212:215], v[112:115], a[32:35], v[184:187]
    v_cvt_pk_bf16_f32 v228, v204, v205
    v_cvt_pk_bf16_f32 v229, v206, v207
    v_mfma_f32_16x16x32_bf16 v[212:215], v[116:119], a[36:39], v[212:215]
    v_exp_f32_e64 v211, v211
    v_mfma_f32_16x16x32_bf16 v[212:215], v[120:123], a[40:43], v[212:215]
    v_cvt_pk_bf16_f32 v230, v208, v209
    v_cvt_pk_bf16_f32 v231, v210, v211
    v_mfma_f32_16x16x32_bf16 v[212:215], v[124:127], a[44:47], v[212:215]
    s_and_b32 m0, s39, 0x7fffffff
    v_mfma_f32_16x16x32_bf16 v[216:219], v[128:131], a[32:35], v[184:187]
    s_add_u32 s93, s38, 32768
    s_nop 0
    v_mfma_f32_16x16x32_bf16 v[216:219], v[132:135], a[36:39], v[216:219]
    s_cmp_lt_u32 s93, 163840
    s_cselect_b32 s39, s93, s37
    v_mfma_f32_16x16x32_bf16 v[216:219], v[136:139], a[40:43], v[216:219]
    v_exp_f32_e64 v212, v212
    v_mfma_f32_16x16x32_bf16 v[216:219], v[140:143], a[44:47], v[216:219]
    v_exp_f32_e64 v213, v213
    v_smfmac_f32_16x16x64_bf16 v[244:247], a[240:243], v[228:235], v12
    v_cvt_pk_bf16_f32 v232, v212, v213
    v_mfma_f32_16x16x32_bf16 v[48:51], v[144:147], v[228:231], v[48:51]
    v_exp_f32_e64 v214, v214
    v_mfma_f32_16x16x32_bf16 v[52:55], v[148:151], v[228:231], v[52:55]
    v_exp_f32_e64 v215, v215
    v_mfma_f32_16x16x32_bf16 v[56:59], v[152:155], v[228:231], v[56:59]
    v_exp_f32_e64 v216, v216
    v_mfma_f32_16x16x32_bf16 v[60:63], v[156:159], v[228:231], v[60:63]
    v_exp_f32_e64 v217, v217
    v_mfma_f32_16x16x32_bf16 v[64:67], v[160:163], v[228:231], v[64:67]
    v_exp_f32_e64 v218, v218
    v_mfma_f32_16x16x32_bf16 v[68:71], v[164:167], v[228:231], v[68:71]
    v_cvt_pk_bf16_f32 v233, v214, v215
    v_cvt_pk_bf16_f32 v234, v216, v217
    v_mfma_f32_16x16x32_bf16 v[72:75], v[168:171], v[228:231], v[72:75]
    v_exp_f32_e64 v219, v219
    v_mfma_f32_16x16x32_bf16 v[76:79], v[172:175], v[228:231], v[76:79]
    v_cvt_pk_bf16_f32 v235, v218, v219
    v_add_u32_e64 v2, s39, v5
    v_mfma_f32_16x16x32_bf16 v[204:207], v[112:115], a[80:83], v[196:199]
    ds_read_b128 v[112:115], v1
    v_mfma_f32_16x16x32_bf16 v[204:207], v[116:119], a[84:87], v[204:207]
    ds_read_b128 v[116:119], v1 offset:256
    v_mfma_f32_16x16x32_bf16 v[204:207], v[120:123], a[88:91], v[204:207]
    ds_read_b128 v[120:123], v1 offset:512
    v_mfma_f32_16x16x32_bf16 v[204:207], v[124:127], a[92:95], v[204:207]
    ds_read_b128 v[124:127], v1 offset:768
    v_mfma_f32_16x16x32_bf16 v[208:211], v[128:131], a[80:83], v[196:199]
    ds_read_b128 v[128:131], v1 offset:4096
    v_mfma_f32_16x16x32_bf16 v[208:211], v[132:135], a[84:87], v[208:211]
    buffer_load_dwordx4 v6, s[16:19], s92 offen nt lds
    v_mfma_f32_16x16x32_bf16 v[208:211], v[136:139], a[88:91], v[208:211]
    ds_read_b128 v[132:135], v1 offset:4352
    v_mfma_f32_16x16x32_bf16 v[208:211], v[140:143], a[92:95], v[208:211]
    ds_read_b128 v[136:139], v1 offset:4608
    v_mfma_f32_16x16x32_bf16 v[80:83], v[144:147], v[232:235], v[80:83]
    ds_read_b128 v[140:143], v1 offset:4864
    v_mfma_f32_16x16x32_bf16 v[84:87], v[148:151], v[232:235], v[84:87]
    v_mfma_f32_16x16x32_bf16 v[88:91], v[152:155], v[232:235], v[88:91]
    v_mfma_f32_16x16x32_bf16 v[92:95], v[156:159], v[232:235], v[92:95]
    v_exp_f32_e64 v204, v204
    v_mfma_f32_16x16x32_bf16 v[96:99], v[160:163], v[232:235], v[96:99]
    v_exp_f32_e64 v205, v205
    v_mfma_f32_16x16x32_bf16 v[100:103], v[164:167], v[232:235], v[100:103]
    v_exp_f32_e64 v206, v206
    v_mfma_f32_16x16x32_bf16 v[104:107], v[168:171], v[232:235], v[104:107]
    v_exp_f32_e64 v207, v207
    v_mfma_f32_16x16x32_bf16 v[108:111], v[172:175], v[232:235], v[108:111]
    s_cmp_lt_u32 s92, 524288
    s_cbranch_scc1 X_loop
    s_waitcnt lgkmcnt(0)
    v_mfma_f32_16x16x32_bf16 v[220:223], v[112:115], a[96:99], v[200:203]
    v_exp_f32_e64 v208, v208
    v_mfma_f32_16x16x32_bf16 v[220:223], v[116:119], a[100:103], v[220:223]
    v_exp_f32_e64 v209, v209
    v_mfma_f32_16x16x32_bf16 v[220:223], v[120:123], a[104:107], v[220:223]
    v_exp_f32_e64 v210, v210
    v_mfma_f32_16x16x32_bf16 v[220:223], v[124:127], a[108:111], v[220:223]
    v_cvt_pk_bf16_f32 v236, v204, v205
    v_cvt_pk_bf16_f32 v237, v206, v207
    v_mfma_f32_16x16x32_bf16 v[224:227], v[128:131], a[96:99], v[200:203]
    v_exp_f32_e64 v211, v211
    v_mfma_f32_16x16x32_bf16 v[224:227], v[132:135], a[100:103], v[224:227]
    v_cvt_pk_bf16_f32 v238, v208, v209
    v_cvt_pk_bf16_f32 v239, v210, v211
    v_mfma_f32_16x16x32_bf16 v[224:227], v[136:139], a[104:107], v[224:227]
    v_xor_b32 v1, 0x2000, v1
    v_add_u32_e64 v4, s100, v10
    v_mfma_f32_16x16x32_bf16 v[224:227], v[140:143], a[108:111], v[224:227]
    v_exp_f32_e64 v220, v220
    v_smfmac_f32_16x16x64_bf16 v[248:251], a[240:243], v[232:239], v12
    ds_read_b128 a[96:99], v1
    v_mfma_f32_16x16x32_bf16 a[176:179], v[144:147], v[236:239], a[176:179]
    v_exp_f32_e64 v221, v221
    v_mfma_f32_16x16x32_bf16 a[180:183], v[148:151], v[236:239], a[180:183]
    v_exp_f32_e64 v222, v222
    v_mfma_f32_16x16x32_bf16 a[184:187], v[152:155], v[236:239], a[184:187]
    v_exp_f32_e64 v223, v223
    v_mfma_f32_16x16x32_bf16 a[188:191], v[156:159], v[236:239], a[188:191]
    v_exp_f32_e64 v224, v224
    v_mfma_f32_16x16x32_bf16 a[192:195], v[160:163], v[236:239], a[192:195]
    ds_read_b64_tr_b16 v[144:145], v2
    ds_read_b64_tr_b16 v[146:147], v2 offset:4096
    v_mfma_f32_16x16x32_bf16 a[196:199], v[164:167], v[236:239], a[196:199]
    ds_read_b64_tr_b16 v[148:149], v2 offset:8
    ds_read_b64_tr_b16 v[150:151], v2 offset:4104
    v_mfma_f32_16x16x32_bf16 a[200:203], v[168:171], v[236:239], a[200:203]
    v_exp_f32_e64 v225, v225
    v_mfma_f32_16x16x32_bf16 a[204:207], v[172:175], v[236:239], a[204:207]
    ds_read_b64_tr_b16 v[152:153], v2 offset:256
    ds_read_b64_tr_b16 v[154:155], v2 offset:4352
    v_mfma_f32_16x16x32_bf16 v[212:215], v[112:115], a[48:51], v[188:191]
    ds_read_b64_tr_b16 v[156:157], v2 offset:264
    ds_read_b64_tr_b16 v[158:159], v2 offset:4360
    v_mfma_f32_16x16x32_bf16 v[212:215], v[116:119], a[52:55], v[212:215]
    v_exp_f32_e64 v226, v226
    v_mfma_f32_16x16x32_bf16 v[212:215], v[120:123], a[56:59], v[212:215]
    v_cvt_pk_bf16_f32 v228, v220, v221
    v_cvt_pk_bf16_f32 v229, v222, v223
    v_mfma_f32_16x16x32_bf16 v[212:215], v[124:127], a[60:63], v[212:215]
    v_exp_f32_e64 v227, v227
    v_mfma_f32_16x16x32_bf16 v[216:219], v[128:131], a[48:51], v[188:191]
    v_cvt_pk_bf16_f32 v230, v224, v225
    v_cvt_pk_bf16_f32 v231, v226, v227
    v_mfma_f32_16x16x32_bf16 v[216:219], v[132:135], a[52:55], v[216:219]
    ds_read_b64_tr_b16 v[160:161], v2 offset:512
    ds_read_b64_tr_b16 v[162:163], v2 offset:4608
    v_mfma_f32_16x16x32_bf16 v[216:219], v[136:139], a[56:59], v[216:219]
    ds_read_b64_tr_b16 v[164:165], v2 offset:520
    ds_read_b64_tr_b16 v[166:167], v2 offset:4616
    v_mfma_f32_16x16x32_bf16 v[216:219], v[140:143], a[60:63], v[216:219]
    ds_read_b64_tr_b16 v[168:169], v2 offset:768
    ds_read_b64_tr_b16 v[170:171], v2 offset:4864
    ds_read_b64_tr_b16 v[172:173], v2 offset:776
    ds_read_b64_tr_b16 v[174:175], v2 offset:4872
    s_waitcnt vmcnt(0)
    v_mfma_f32_16x16x32_bf16 v[252:255], a[240:243], v[228:231], v[252:255]
    ds_read_b128 a[100:103], v1 offset:256
    ds_read_b128 a[104:107], v1 offset:512
    s_waitcnt lgkmcnt(10)
    v_mfma_f32_16x16x32_bf16 a[208:211], v[144:147], v[228:231], a[208:211]
    ds_read_b128 a[108:111], v1 offset:768
    v_add_u32_e64 v5, s101, v10
    v_mfma_f32_16x16x32_bf16 a[212:215], v[148:151], v[228:231], a[212:215]
    v_exp_f32_e64 v212, v212
    v_mfma_f32_16x16x32_bf16 a[216:219], v[152:155], v[228:231], a[216:219]
    v_exp_f32_e64 v213, v213
    v_mfma_f32_16x16x32_bf16 a[220:223], v[156:159], v[228:231], a[220:223]
    v_add_f32 v13, v254, v252
    v_cvt_pk_bf16_f32 v232, v212, v213
    s_waitcnt lgkmcnt(3)
    v_mfma_f32_16x16x32_bf16 a[224:227], v[160:163], v[228:231], a[224:227]
    ds_write_b128 v4, a[208:211] offset:32768
    v_mfma_f32_16x16x32_bf16 a[228:231], v[164:167], v[228:231], a[228:231]
    v_exp_f32_e64 v214, v214
    v_mfma_f32_16x16x32_bf16 a[232:235], v[168:171], v[228:231], a[232:235]
    v_exp_f32_e64 v215, v215
    v_mfma_f32_16x16x32_bf16 a[236:239], v[172:175], v[228:231], a[236:239]
    ds_write_b32 v5, v13 offset:32780
    v_mfma_f32_16x16x32_bf16 v[204:207], v[112:115], a[0:3], v[176:179]
    v_exp_f32_e64 v216, v216
    v_mfma_f32_16x16x32_bf16 v[204:207], v[116:119], a[4:7], v[204:207]
    ds_write_b128 v4, a[212:215] offset:33792
    v_mfma_f32_16x16x32_bf16 v[204:207], v[120:123], a[8:11], v[204:207]
    v_exp_f32_e64 v217, v217
    v_mfma_f32_16x16x32_bf16 v[204:207], v[124:127], a[12:15], v[204:207]
    v_exp_f32_e64 v218, v218
    v_mfma_f32_16x16x32_bf16 v[208:211], v[128:131], a[0:3], v[176:179]
    ds_write_b128 v4, a[216:219] offset:34816
    v_cvt_pk_bf16_f32 v233, v214, v215
    v_exp_f32_e64 v219, v219
    v_mfma_f32_16x16x32_bf16 v[208:211], v[132:135], a[4:7], v[208:211]
    v_cvt_pk_bf16_f32 v234, v216, v217
    v_cvt_pk_bf16_f32 v235, v218, v219
    v_mfma_f32_16x16x32_bf16 v[208:211], v[136:139], a[8:11], v[208:211]
    ds_write_b128 v4, a[220:223] offset:35840
    v_mfma_f32_16x16x32_bf16 v[208:211], v[140:143], a[12:15], v[208:211]
    v_exp_f32_e64 v204, v204
    v_mfma_f32_16x16x32_bf16 a[112:115], v[144:147], v[232:235], a[112:115]
    v_exp_f32_e64 v205, v205
    v_mfma_f32_16x16x32_bf16 a[116:119], v[148:151], v[232:235], a[116:119]
    ds_read_b128 a[208:211], v1 offset:4096
    ds_read_b128 a[212:215], v1 offset:4352
    v_mfma_f32_16x16x32_bf16 a[120:123], v[152:155], v[232:235], a[120:123]
    ds_read_b128 a[216:219], v1 offset:4608
    ds_read_b128 a[220:223], v1 offset:4864
    v_mfma_f32_16x16x32_bf16 a[124:127], v[156:159], v[232:235], a[124:127]
    v_exp_f32_e64 v206, v206
    v_mfma_f32_16x16x32_bf16 a[128:131], v[160:163], v[232:235], a[128:131]
    ds_write_b128 v4, a[224:227] offset:36864
    v_mfma_f32_16x16x32_bf16 a[132:135], v[164:167], v[232:235], a[132:135]
    v_add_u32_e64 v8, s96, v10
    v_add_u32 v9, 0x1000c, v10
    v_mfma_f32_16x16x32_bf16 a[136:139], v[168:171], v[232:235], a[136:139]
    v_exp_f32 v207, v207
    v_mfma_f32_16x16x32_bf16 a[140:143], v[172:175], v[232:235], a[140:143]
    ds_write_b128 v4, a[228:231] offset:37888
    s_waitcnt lgkmcnt(11)
    v_mfma_f32_16x16x32_bf16 v[212:215], a[96:99], a[48:51], v[188:191]
    v_xor_b32 v2, 0x2000, v2
    v_cvt_pk_bf16_f32 v228, v204, v205
    v_mfma_f32_16x16x32_bf16 v[212:215], a[100:103], a[52:55], v[212:215]
    v_exp_f32_e64 v208, v208
    v_mfma_f32_16x16x32_bf16 v[212:215], a[104:107], a[56:59], v[212:215]
    ds_write_b128 v4, a[232:235] offset:38912
    v_exp_f32_e64 v209, v209
    v_mfma_f32_16x16x32_bf16 v[212:215], a[108:111], a[60:63], v[212:215]
    v_exp_f32 v210, v210
    s_waitcnt lgkmcnt(3)
    v_mfma_f32_16x16x32_bf16 v[216:219], a[208:211], a[48:51], v[188:191]
    ds_write_b128 v4, a[236:239] offset:39936
    v_cvt_pk_bf16_f32 v229, v206, v207
    v_exp_f32_e64 v211, v211
    v_mfma_f32_16x16x32_bf16 v[216:219], a[212:215], a[52:55], v[216:219]
    v_cvt_pk_bf16_f32 v230, v208, v209
    v_cvt_pk_bf16_f32 v231, v210, v211
    v_mfma_f32_16x16x32_bf16 v[216:219], a[216:219], a[56:59], v[216:219]
    v_exp_f32_e64 v212, v212
    v_mfma_f32_16x16x32_bf16 v[216:219], a[220:223], a[60:63], v[216:219]
    v_exp_f32_e64 v213, v213
    v_smfmac_f32_16x16x64_bf16 v[240:243], a[240:243], v[228:235], v12
    ds_read_b64_tr_b16 a[224:225], v2
    v_mfma_f32_16x16x32_bf16 v[16:19], v[144:147], v[228:231], v[16:19]
    s_waitcnt lgkmcnt(1)
    s_barrier
    v_mfma_f32_16x16x32_bf16 v[20:23], v[148:151], v[228:231], v[20:23]
    ds_read2st64_b32 v[200:201], v9 offset0:0 offset1:32
    ds_read2st64_b32 v[202:203], v9 offset0:64 offset1:96
    v_mfma_f32_16x16x32_bf16 v[24:27], v[152:155], v[228:231], v[24:27]
    ds_read_b128 v[220:223], v8
    ds_read_b128 v[224:227], v8 offset:1024
    v_mfma_f32_16x16x32_bf16 v[28:31], v[156:159], v[228:231], v[28:31]
    ds_read_b128 v[236:239], v8 offset:9216
    ds_read_b64_tr_b16 a[226:227], v2 offset:4096
    v_mfma_f32_16x16x32_bf16 v[32:35], v[160:163], v[228:231], v[32:35]
    v_exp_f32_e64 v214, v214
    v_mfma_f32_16x16x32_bf16 v[36:39], v[164:167], v[228:231], v[36:39]
    ds_read_b64_tr_b16 a[228:229], v2 offset:8
    ds_read_b64_tr_b16 a[230:231], v2 offset:4104
    v_mfma_f32_16x16x32_bf16 v[40:43], v[168:171], v[228:231], v[40:43]
    v_exp_f32_e64 v215, v215
    v_mfma_f32_16x16x32_bf16 v[44:47], v[172:175], v[228:231], v[44:47]
    ds_read_b64_tr_b16 a[232:233], v2 offset:256
    ds_read_b64_tr_b16 a[234:235], v2 offset:4352
    v_mfma_f32_16x16x32_bf16 v[204:207], a[96:99], a[0:3], v[176:179]
    v_exp_f32_e64 v216, v216
    v_mfma_f32_16x16x32_bf16 v[204:207], a[100:103], a[4:7], v[204:207]
    ds_read_b64_tr_b16 a[236:237], v2 offset:264
    ds_read_b64_tr_b16 a[238:239], v2 offset:4360
    v_mfma_f32_16x16x32_bf16 v[204:207], a[104:107], a[8:11], v[204:207]
    s_waitcnt lgkmcnt(10)
    v_add_f32 v200, v200, v201
    v_add_f32 v202, v202, v203
    v_add_f32 v3, v200, v202
    v_exp_f32_e64 v217, v217
    ds_read_b64_tr_b16 a[48:49], v2 offset:512
    ds_read_b64_tr_b16 a[50:51], v2 offset:4608
    v_mfma_f32_16x16x32_bf16 v[204:207], a[108:111], a[12:15], v[204:207]
    ds_read_b128 v[200:203], v8 offset:8192
    v_exp_f32_e64 v218, v218
    ds_read_b64_tr_b16 a[52:53], v2 offset:520
    ds_read_b64_tr_b16 a[54:55], v2 offset:4616
    v_mfma_f32_16x16x32_bf16 v[208:211], a[208:211], a[0:3], v[176:179]
    v_cvt_pk_bf16_f32 v232, v212, v213
    v_cvt_pk_bf16_f32 v233, v214, v215
    v_exp_f32_e64 v219, v219
    ds_read_b64_tr_b16 a[56:57], v2 offset:768
    ds_read_b64_tr_b16 a[58:59], v2 offset:4864
    v_mfma_f32_16x16x32_bf16 v[208:211], a[212:215], a[4:7], v[208:211]
    v_cvt_pk_bf16_f32 v234, v216, v217
    v_cvt_pk_bf16_f32 v235, v218, v219
    ds_read_b64_tr_b16 a[60:61], v2 offset:776
    ds_read_b64_tr_b16 a[62:63], v2 offset:4872
    v_mfma_f32_16x16x32_bf16 v[208:211], a[216:219], a[8:11], v[208:211]
    v_exp_f32_e64 v204, v204
    v_mfma_f32_16x16x32_bf16 v[208:211], a[220:223], a[12:15], v[208:211]
    v_exp_f32 v205, v205
    s_waitcnt lgkmcnt(9)
    v_mfma_f32_16x16x32_bf16 a[112:115], a[224:227], v[232:235], a[112:115]
    v_exp_f32_e64 v206, v206
    v_mfma_f32_16x16x32_bf16 a[116:119], a[228:231], v[232:235], a[116:119]
    v_exp_f32 v207, v207
    v_cvt_pk_bf16_f32 v228, v204, v205
    v_xor_b32 v6, 0x4000, v4
    v_xor_b32 v7, 0x4000, v5
    s_waitcnt lgkmcnt(6)
    v_pk_add_f32 v[220:221], v[220:221], v[200:201]
    v_pk_add_f32 v[222:223], v[222:223], v[202:203]
    v_pk_add_f32 v[224:225], v[224:225], v[236:237]
    v_pk_add_f32 v[226:227], v[226:227], v[238:239]
    v_mfma_f32_16x16x32_bf16 a[120:123], a[232:235], v[232:235], a[120:123]
    ds_read_b128 v[200:203], v8 offset:16384
    ds_read_b128 v[236:239], v8 offset:17408
    v_mfma_f32_16x16x32_bf16 a[124:127], a[236:239], v[232:235], a[124:127]
    v_exp_f32 v208, v208
    s_waitcnt lgkmcnt(2)
    v_mfma_f32_16x16x32_bf16 a[128:131], a[48:51], v[232:235], a[128:131]
    ds_write_b128 v4, a[112:115]
    v_mfma_f32_16x16x32_bf16 a[132:135], a[52:55], v[232:235], a[132:135]
    v_exp_f32_e64 v209, v209
    v_mfma_f32_16x16x32_bf16 a[136:139], a[56:59], v[232:235], a[136:139]
    v_exp_f32 v210, v210
    v_mfma_f32_16x16x32_bf16 a[140:143], a[60:63], v[232:235], a[140:143]
    ds_write_b128 v4, a[116:119] offset:1024
    s_waitcnt lgkmcnt(2)
    v_pk_add_f32 v[220:221], v[220:221], v[200:201]
    v_pk_add_f32 v[222:223], v[222:223], v[202:203]
    v_pk_add_f32 v[224:225], v[224:225], v[236:237]
    v_pk_add_f32 v[226:227], v[226:227], v[238:239]
    v_mfma_f32_16x16x32_bf16 v[212:215], a[96:99], a[64:67], v[192:195]
    v_cvt_pk_bf16_f32 v229, v206, v207
    v_cvt_pk_bf16_f32 v230, v208, v209
    v_mfma_f32_16x16x32_bf16 v[212:215], a[100:103], a[68:71], v[212:215]
    ds_write_b128 v4, a[120:123] offset:2048
    v_mfma_f32_16x16x32_bf16 v[212:215], a[104:107], a[72:75], v[212:215]
    v_exp_f32_e64 v211, v211
    v_mfma_f32_16x16x32_bf16 v[212:215], a[108:111], a[76:79], v[212:215]
    v_cvt_pk_bf16_f32 v231, v210, v211
    v_cmp_nge_f32 s[64:65], s63, v3
    v_mfma_f32_16x16x32_bf16 v[216:219], a[208:211], a[64:67], v[192:195]
    v_rcp_f32_e64 v3, v3
    v_mfma_f32_16x16x32_bf16 v[216:219], a[212:215], a[68:71], v[216:219]
    ds_read_b128 v[200:203], v8 offset:24576
    ds_read_b128 v[236:239], v8 offset:25600
    v_mfma_f32_16x16x32_bf16 v[216:219], a[216:219], a[72:75], v[216:219]
    v_exp_f32_e64 v212, v212
    v_mfma_f32_16x16x32_bf16 v[216:219], a[220:223], a[76:79], v[216:219]
    ds_write_b128 v4, a[124:127] offset:3072
    v_smfmac_f32_16x16x64_bf16 v[240:243], a[240:243], v[228:235], v12
    v_mfma_f32_16x16x32_bf16 v[16:19], a[224:227], v[228:231], v[16:19]
    v_exp_f32_e64 v213, v213
    v_mfma_f32_16x16x32_bf16 v[20:23], a[228:231], v[228:231], v[20:23]
    ds_write_b128 v4, a[128:131] offset:4096
    v_mfma_f32_16x16x32_bf16 v[24:27], a[232:235], v[228:231], v[24:27]
    v_exp_f32_e64 v214, v214
    v_mfma_f32_16x16x32_bf16 v[28:31], a[236:239], v[228:231], v[28:31]
    v_exp_f32_e64 v215, v215
    v_add_f32 v240, v240, v241
    v_mfma_f32_16x16x32_bf16 v[32:35], a[48:51], v[228:231], v[32:35]
    ds_write_b128 v4, a[132:135] offset:5120
    s_waitcnt lgkmcnt(3)
    v_pk_add_f32 v[220:221], v[220:221], v[200:201]
    v_pk_add_f32 v[222:223], v[222:223], v[202:203]
    v_pk_add_f32 v[224:225], v[224:225], v[236:237]
    v_pk_add_f32 v[226:227], v[226:227], v[238:239]
    v_pk_mul_f32 v[220:221], v[220:221], v[2:3] op_sel:[0,1]
    v_pk_mul_f32 v[222:223], v[222:223], v[2:3] op_sel:[0,1]
    v_pk_mul_f32 v[224:225], v[224:225], v[2:3] op_sel:[0,1]
    v_pk_mul_f32 v[226:227], v[226:227], v[2:3] op_sel:[0,1]
    v_mfma_f32_16x16x32_bf16 v[36:39], a[52:55], v[228:231], v[36:39]
    ds_write_b128 v4, a[136:139] offset:6144
    v_mfma_f32_16x16x32_bf16 v[40:43], a[56:59], v[228:231], v[40:43]
    v_add_f32_e64 v14, v242, v243
    v_cvt_pk_bf16_f32 v232, v212, v213
    v_mfma_f32_16x16x32_bf16 v[44:47], a[60:63], v[228:231], v[44:47]
    v_exp_f32_e64 v216, v216
    v_mfma_f32_16x16x32_bf16 v[204:207], v[112:115], a[64:67], v[192:195]
    ds_write_b32 v5, v14 offset:32768
    v_mfma_f32_16x16x32_bf16 v[204:207], v[116:119], a[68:71], v[204:207]
    v_exp_f32_e64 v217, v217
    v_mfma_f32_16x16x32_bf16 v[204:207], v[120:123], a[72:75], v[204:207]
    ds_write_b128 v4, a[140:143] offset:7168
    v_mfma_f32_16x16x32_bf16 v[204:207], v[124:127], a[76:79], v[204:207]
    v_exp_f32_e64 v218, v218
    v_mfma_f32_16x16x32_bf16 v[208:211], v[128:131], a[64:67], v[192:195]
    v_cvt_pk_bf16_f32 v233, v214, v215
    v_cvt_pk_bf16_f32 v220, v220, v221
    v_cvt_pk_bf16_f32 v221, v222, v223
    v_cvt_pk_bf16_f32 v222, v224, v225
    v_cvt_pk_bf16_f32 v223, v226, v227
    v_exp_f32_e64 v219, v219
    v_mfma_f32_16x16x32_bf16 v[208:211], v[132:135], a[68:71], v[208:211]
    buffer_store_dwordx4 v[220:223], v11, s[32:35], s62 offen nt sc1
    s_waitcnt lgkmcnt(0)
    s_barrier
    v_cvt_pk_bf16_f32 v234, v216, v217
    v_cvt_pk_bf16_f32 v235, v218, v219
    v_mfma_f32_16x16x32_bf16 v[208:211], v[136:139], a[72:75], v[208:211]
    ds_read_b32 v252, v7 offset:32768
    ds_read_b128 v[220:223], v6
    ds_read_b128 v[224:227], v6 offset:1024
    v_mfma_f32_16x16x32_bf16 v[208:211], v[140:143], a[76:79], v[208:211]
    ds_read_b128 v[200:203], v6 offset:4096
    ds_read_b128 v[236:239], v6 offset:5120
    v_mfma_f32_16x16x32_bf16 a[144:147], a[224:227], v[232:235], a[144:147]
    ds_read_b128 v[188:191], v6 offset:2048
    ds_read_b128 v[192:195], v6 offset:3072
    v_mfma_f32_16x16x32_bf16 a[148:151], a[228:231], v[232:235], a[148:151]
    v_exp_f32_e64 v204, v204
    v_mfma_f32_16x16x32_bf16 a[152:155], a[232:235], v[232:235], a[152:155]
    v_exp_f32_e64 v205, v205
    v_mfma_f32_16x16x32_bf16 a[156:159], a[236:239], v[232:235], a[156:159]
    v_exp_f32_e64 v206, v206
    v_mfma_f32_16x16x32_bf16 a[160:163], a[48:51], v[232:235], a[160:163]
    v_exp_f32 v207, v207
    v_exp_f32 v208, v208
    s_waitcnt lgkmcnt(6)
    v_add_f32 v242, v240, v252
    v_cmp_nge_f32 s[4:5], s63, v242
    v_rcp_f32_e64 v242, v242
    s_waitcnt lgkmcnt(4)
    v_pk_add_f32 v[16:17], v[16:17], v[220:221]
    v_pk_add_f32 v[18:19], v[18:19], v[222:223]
    v_pk_add_f32 v[20:21], v[20:21], v[224:225]
    v_pk_add_f32 v[22:23], v[22:23], v[226:227]
    v_pk_mul_f32 v[16:17], v[16:17], v[242:243] op_sel_hi:[1,0]
    v_pk_mul_f32 v[18:19], v[18:19], v[242:243] op_sel_hi:[1,0]
    v_pk_mul_f32 v[20:21], v[20:21], v[242:243] op_sel_hi:[1,0]
    v_pk_mul_f32 v[22:23], v[22:23], v[242:243] op_sel_hi:[1,0]
    s_waitcnt lgkmcnt(0)
    v_pk_add_f32 v[24:25], v[24:25], v[188:189]
    v_pk_add_f32 v[26:27], v[26:27], v[190:191]
    v_pk_add_f32 v[28:29], v[28:29], v[192:193]
    v_pk_add_f32 v[30:31], v[30:31], v[194:195]
    v_pk_add_f32 v[32:33], v[32:33], v[200:201]
    v_pk_add_f32 v[34:35], v[34:35], v[202:203]
    v_pk_add_f32 v[36:37], v[36:37], v[236:237]
    v_pk_add_f32 v[38:39], v[38:39], v[238:239]
    v_pk_mul_f32 v[24:25], v[24:25], v[242:243] op_sel_hi:[1,0]
    v_pk_mul_f32 v[26:27], v[26:27], v[242:243] op_sel_hi:[1,0]
    v_pk_mul_f32 v[28:29], v[28:29], v[242:243] op_sel_hi:[1,0]
    v_pk_mul_f32 v[30:31], v[30:31], v[242:243] op_sel_hi:[1,0]
    v_pk_mul_f32 v[32:33], v[32:33], v[242:243] op_sel_hi:[1,0]
    v_pk_mul_f32 v[34:35], v[34:35], v[242:243] op_sel_hi:[1,0]
    v_pk_mul_f32 v[36:37], v[36:37], v[242:243] op_sel_hi:[1,0]
    v_pk_mul_f32 v[38:39], v[38:39], v[242:243] op_sel_hi:[1,0]
    v_mfma_f32_16x16x32_bf16 a[164:167], a[52:55], v[232:235], a[164:167]
    ds_read_b128 v[220:223], v6 offset:6144
    ds_read_b128 v[224:227], v6 offset:7168
    v_mfma_f32_16x16x32_bf16 a[168:171], a[56:59], v[232:235], a[168:171]
    v_exp_f32_e64 v209, v209
    v_mfma_f32_16x16x32_bf16 a[172:175], a[60:63], v[232:235], a[172:175]
    v_cvt_pk_bf16_f32 v16, v16, v17
    v_cvt_pk_bf16_f32 v17, v18, v19
    v_mfma_f32_16x16x32_bf16 v[212:215], v[112:115], a[16:19], v[180:183]
    v_cvt_pk_bf16_f32 v18, v20, v21
    v_cvt_pk_bf16_f32 v19, v22, v23
    v_mfma_f32_16x16x32_bf16 v[212:215], v[116:119], a[20:23], v[212:215]
    buffer_store_dwordx4 v[16:19], v11, s[32:35], s97 offen nt sc1
    v_exp_f32_e64 v210, v210
    v_mfma_f32_16x16x32_bf16 v[212:215], v[120:123], a[24:27], v[212:215]
    v_cvt_pk_bf16_f32 v228, v204, v205
    v_cvt_pk_bf16_f32 v229, v206, v207
    v_mfma_f32_16x16x32_bf16 v[212:215], v[124:127], a[28:31], v[212:215]
    v_exp_f32 v211, v211
    v_mfma_f32_16x16x32_bf16 v[216:219], v[128:131], a[16:19], v[180:183]
    v_cvt_pk_bf16_f32 v230, v208, v209
    v_cvt_pk_bf16_f32 v231, v210, v211
    v_cvt_pk_bf16_f32 v24, v24, v25
    v_cvt_pk_bf16_f32 v25, v26, v27
    v_cvt_pk_bf16_f32 v26, v28, v29
    s_waitcnt lgkmcnt(0)
    v_pk_add_f32 v[40:41], v[40:41], v[220:221]
    v_pk_add_f32 v[42:43], v[42:43], v[222:223]
    v_pk_add_f32 v[44:45], v[44:45], v[224:225]
    v_pk_add_f32 v[46:47], v[46:47], v[226:227]
    v_pk_mul_f32 v[40:41], v[40:41], v[242:243] op_sel_hi:[1,0]
    v_pk_mul_f32 v[42:43], v[42:43], v[242:243] op_sel_hi:[1,0]
    v_pk_mul_f32 v[44:45], v[44:45], v[242:243] op_sel_hi:[1,0]
    v_pk_mul_f32 v[46:47], v[46:47], v[242:243] op_sel_hi:[1,0]
    v_mfma_f32_16x16x32_bf16 v[216:219], v[132:135], a[20:23], v[216:219]
    v_cvt_pk_bf16_f32 v27, v30, v31
    v_cvt_pk_bf16_f32 v32, v32, v33
    v_mfma_f32_16x16x32_bf16 v[216:219], v[136:139], a[24:27], v[216:219]
    v_exp_f32_e64 v212, v212
    v_mfma_f32_16x16x32_bf16 v[216:219], v[140:143], a[28:31], v[216:219]
    v_exp_f32_e64 v213, v213
    v_smfmac_f32_16x16x64_bf16 v[244:247], a[248:251], v[228:235], v12
    v_cvt_pk_bf16_f32 v33, v34, v35
    v_mfma_f32_16x16x32_bf16 a[144:147], v[144:147], v[228:231], a[144:147]
    buffer_store_dwordx4 v[24:27], v11, s[32:35], s97 offen offset:64 nt sc1
    v_exp_f32_e64 v214, v214
    v_mfma_f32_16x16x32_bf16 a[148:151], v[148:151], v[228:231], a[148:151]
    v_exp_f32_e64 v215, v215
    v_mfma_f32_16x16x32_bf16 a[152:155], v[152:155], v[228:231], a[152:155]
    v_exp_f32_e64 v216, v216
    v_mfma_f32_16x16x32_bf16 a[156:159], v[156:159], v[228:231], a[156:159]
    v_add_f32_e64 v13, v246, v247
    v_cvt_pk_bf16_f32 v34, v36, v37
    v_mfma_f32_16x16x32_bf16 a[160:163], v[160:163], v[228:231], a[160:163]
    ds_write_b128 v4, a[144:147] offset:32768
    v_mfma_f32_16x16x32_bf16 a[164:167], v[164:167], v[228:231], a[164:167]
    v_exp_f32_e64 v217, v217
    v_mfma_f32_16x16x32_bf16 a[168:171], v[168:171], v[228:231], a[168:171]
    v_exp_f32_e64 v218, v218
    v_mfma_f32_16x16x32_bf16 a[172:175], v[172:175], v[228:231], a[172:175]
    ds_write_b32 v5, v13 offset:32772
    v_mfma_f32_16x16x32_bf16 v[204:207], a[96:99], a[16:19], v[180:183]
    v_cvt_pk_bf16_f32 v35, v38, v39
    v_cvt_pk_bf16_f32 v232, v212, v213
    v_mfma_f32_16x16x32_bf16 v[204:207], a[100:103], a[20:23], v[204:207]
    ds_write_b128 v4, a[148:151] offset:33792
    v_mfma_f32_16x16x32_bf16 v[204:207], a[104:107], a[24:27], v[204:207]
    buffer_store_dwordx4 v[32:35], v11, s[32:35], s97 offen offset:128 nt sc1
    v_cvt_pk_bf16_f32 v233, v214, v215
    v_cvt_pk_bf16_f32 v234, v216, v217
    v_mfma_f32_16x16x32_bf16 v[204:207], a[108:111], a[28:31], v[204:207]
    ds_write_b128 v4, a[152:155] offset:34816
    v_mfma_f32_16x16x32_bf16 v[208:211], a[208:211], a[16:19], v[180:183]
    v_exp_f32_e64 v219, v219
    v_mfma_f32_16x16x32_bf16 v[208:211], a[212:215], a[20:23], v[208:211]
    v_cvt_pk_bf16_f32 v235, v218, v219
    v_cvt_pk_bf16_f32 v40, v40, v41
    v_mfma_f32_16x16x32_bf16 v[208:211], a[216:219], a[24:27], v[208:211]
    ds_write_b128 v4, a[156:159] offset:35840
    v_mfma_f32_16x16x32_bf16 v[208:211], a[220:223], a[28:31], v[208:211]
    v_cvt_pk_bf16_f32 v41, v42, v43
    v_cvt_pk_bf16_f32 v42, v44, v45
    v_mfma_f32_16x16x32_bf16 v[48:51], v[144:147], v[232:235], v[48:51]
    v_exp_f32_e64 v204, v204
    v_mfma_f32_16x16x32_bf16 v[52:55], v[148:151], v[232:235], v[52:55]
    ds_write_b128 v4, a[160:163] offset:36864
    v_mfma_f32_16x16x32_bf16 v[56:59], v[152:155], v[232:235], v[56:59]
    v_exp_f32_e64 v205, v205
    v_mfma_f32_16x16x32_bf16 v[60:63], v[156:159], v[232:235], v[60:63]
    v_cvt_pk_bf16_f32 v43, v46, v47
    v_cvt_pk_bf16_f32 v228, v204, v205
    v_mfma_f32_16x16x32_bf16 v[64:67], v[160:163], v[232:235], v[64:67]
    buffer_store_dwordx4 v[40:43], v11, s[32:35], s97 offen offset:192 nt sc1
    ds_write_b128 v4, a[164:167] offset:37888
    v_mfma_f32_16x16x32_bf16 v[68:71], v[164:167], v[232:235], v[68:71]
    v_exp_f32_e64 v206, v206
    v_mfma_f32_16x16x32_bf16 v[72:75], v[168:171], v[232:235], v[72:75]
    v_exp_f32_e64 v207, v207
    v_mfma_f32_16x16x32_bf16 v[76:79], v[172:175], v[232:235], v[76:79]
    ds_write_b128 v4, a[168:171] offset:38912
    v_mfma_f32_16x16x32_bf16 v[212:215], a[96:99], a[80:83], v[196:199]
    v_exp_f32_e64 v208, v208
    v_mfma_f32_16x16x32_bf16 v[212:215], a[100:103], a[84:87], v[212:215]
    v_exp_f32_e64 v209, v209
    v_mfma_f32_16x16x32_bf16 v[212:215], a[104:107], a[88:91], v[212:215]
    ds_write_b128 v4, a[172:175] offset:39936
    v_mfma_f32_16x16x32_bf16 v[212:215], a[108:111], a[92:95], v[212:215]
    v_exp_f32_e64 v210, v210
    v_mfma_f32_16x16x32_bf16 v[216:219], a[208:211], a[80:83], v[196:199]
    v_cvt_pk_bf16_f32 v229, v206, v207
    v_exp_f32_e64 v211, v211
    v_mfma_f32_16x16x32_bf16 v[216:219], a[212:215], a[84:87], v[216:219]
    v_cvt_pk_bf16_f32 v230, v208, v209
    v_cvt_pk_bf16_f32 v231, v210, v211
    v_mfma_f32_16x16x32_bf16 v[216:219], a[216:219], a[88:91], v[216:219]
    v_exp_f32_e64 v212, v212
    v_mfma_f32_16x16x32_bf16 v[216:219], a[220:223], a[92:95], v[216:219]
    v_exp_f32_e64 v213, v213
    s_waitcnt lgkmcnt(0)
    s_barrier
    ds_read_b32 v253, v7 offset:32772
    ds_read_b128 v[16:19], v6 offset:32768
    ds_read_b128 v[20:23], v6 offset:33792
    v_smfmac_f32_16x16x64_bf16 v[244:247], a[244:247], v[228:235], v12
    ds_read_b128 v[24:27], v6 offset:34816
    ds_read_b128 v[28:31], v6 offset:35840
    v_mfma_f32_16x16x32_bf16 v[48:51], a[224:227], v[228:231], v[48:51]
    ds_read_b128 v[32:35], v6 offset:36864
    ds_read_b128 v[36:39], v6 offset:37888
    v_mfma_f32_16x16x32_bf16 v[52:55], a[228:231], v[228:231], v[52:55]
    ds_read_b128 v[40:43], v6 offset:38912
    ds_read_b128 v[44:47], v6 offset:39936
    v_mfma_f32_16x16x32_bf16 v[56:59], a[232:235], v[228:231], v[56:59]
    v_add_f32_e64 v244, v244, v245
    v_cvt_pk_bf16_f32 v232, v212, v213
    v_mfma_f32_16x16x32_bf16 v[60:63], a[236:239], v[228:231], v[60:63]
    v_exp_f32_e64 v214, v214
    v_mfma_f32_16x16x32_bf16 v[64:67], a[48:51], v[228:231], v[64:67]
    v_exp_f32 v215, v215
    v_exp_f32 v216, v216
    s_waitcnt lgkmcnt(8)
    v_add_f32 v246, v244, v253
    v_cmp_nge_f32 s[6:7], s63, v246
    v_rcp_f32_e64 v246, v246
    s_waitcnt lgkmcnt(6)
    v_pk_add_f32 v[48:49], v[48:49], v[16:17]
    v_pk_add_f32 v[50:51], v[50:51], v[18:19]
    v_pk_add_f32 v[52:53], v[52:53], v[20:21]
    v_pk_add_f32 v[54:55], v[54:55], v[22:23]
    v_pk_mul_f32 v[48:49], v[48:49], v[246:247] op_sel_hi:[1,0]
    v_pk_mul_f32 v[50:51], v[50:51], v[246:247] op_sel_hi:[1,0]
    v_pk_mul_f32 v[52:53], v[52:53], v[246:247] op_sel_hi:[1,0]
    v_pk_mul_f32 v[54:55], v[54:55], v[246:247] op_sel_hi:[1,0]
    s_waitcnt lgkmcnt(4)
    v_pk_add_f32 v[56:57], v[56:57], v[24:25]
    v_pk_add_f32 v[58:59], v[58:59], v[26:27]
    v_pk_add_f32 v[60:61], v[60:61], v[28:29]
    v_pk_add_f32 v[62:63], v[62:63], v[30:31]
    v_pk_mul_f32 v[56:57], v[56:57], v[246:247] op_sel_hi:[1,0]
    v_pk_mul_f32 v[58:59], v[58:59], v[246:247] op_sel_hi:[1,0]
    v_pk_mul_f32 v[60:61], v[60:61], v[246:247] op_sel_hi:[1,0]
    v_pk_mul_f32 v[62:63], v[62:63], v[246:247] op_sel_hi:[1,0]
    v_mfma_f32_16x16x32_bf16 v[68:71], a[52:55], v[228:231], v[68:71]
    v_exp_f32_e64 v217, v217
    v_mfma_f32_16x16x32_bf16 v[72:75], a[56:59], v[228:231], v[72:75]
    v_exp_f32_e64 v218, v218
    v_mfma_f32_16x16x32_bf16 v[76:79], a[60:63], v[228:231], v[76:79]
    v_cvt_pk_bf16_f32 v48, v48, v49
    v_cvt_pk_bf16_f32 v49, v50, v51
    v_mfma_f32_16x16x32_bf16 v[204:207], v[112:115], a[80:83], v[196:199]
    v_cvt_pk_bf16_f32 v50, v52, v53
    v_cvt_pk_bf16_f32 v51, v54, v55
    v_mfma_f32_16x16x32_bf16 v[204:207], v[116:119], a[84:87], v[204:207]
    buffer_store_dwordx4 v[48:51], v11, s[32:35], s60 offen nt sc1
    s_waitcnt lgkmcnt(2)
    v_pk_add_f32 v[64:65], v[64:65], v[32:33]
    v_pk_add_f32 v[66:67], v[66:67], v[34:35]
    v_pk_add_f32 v[68:69], v[68:69], v[36:37]
    v_pk_add_f32 v[70:71], v[70:71], v[38:39]
    s_waitcnt lgkmcnt(0)
    v_pk_add_f32 v[72:73], v[72:73], v[40:41]
    v_pk_add_f32 v[74:75], v[74:75], v[42:43]
    v_pk_add_f32 v[76:77], v[76:77], v[44:45]
    v_pk_add_f32 v[78:79], v[78:79], v[46:47]
    v_pk_mul_f32 v[64:65], v[64:65], v[246:247] op_sel_hi:[1,0]
    v_pk_mul_f32 v[66:67], v[66:67], v[246:247] op_sel_hi:[1,0]
    v_pk_mul_f32 v[68:69], v[68:69], v[246:247] op_sel_hi:[1,0]
    v_pk_mul_f32 v[70:71], v[70:71], v[246:247] op_sel_hi:[1,0]
    v_pk_mul_f32 v[72:73], v[72:73], v[246:247] op_sel_hi:[1,0]
    v_pk_mul_f32 v[74:75], v[74:75], v[246:247] op_sel_hi:[1,0]
    v_pk_mul_f32 v[76:77], v[76:77], v[246:247] op_sel_hi:[1,0]
    v_pk_mul_f32 v[78:79], v[78:79], v[246:247] op_sel_hi:[1,0]
    v_mfma_f32_16x16x32_bf16 v[204:207], v[120:123], a[88:91], v[204:207]
    v_cvt_pk_bf16_f32 v233, v214, v215
    v_cvt_pk_bf16_f32 v234, v216, v217
    v_mfma_f32_16x16x32_bf16 v[204:207], v[124:127], a[92:95], v[204:207]
    v_exp_f32_e64 v219, v219
    v_mfma_f32_16x16x32_bf16 v[208:211], v[128:131], a[80:83], v[196:199]
    v_cvt_pk_bf16_f32 v235, v218, v219
    v_cvt_pk_bf16_f32 v56, v56, v57
    v_mfma_f32_16x16x32_bf16 v[208:211], v[132:135], a[84:87], v[208:211]
    v_cvt_pk_bf16_f32 v57, v58, v59
    v_cvt_pk_bf16_f32 v58, v60, v61
    v_mfma_f32_16x16x32_bf16 v[208:211], v[136:139], a[88:91], v[208:211]
    v_cvt_pk_bf16_f32 v59, v62, v63
    v_cvt_pk_bf16_f32 v64, v64, v65
    v_mfma_f32_16x16x32_bf16 v[208:211], v[140:143], a[92:95], v[208:211]
    v_exp_f32_e64 v204, v204
    v_mfma_f32_16x16x32_bf16 a[176:179], a[224:227], v[232:235], a[176:179]
    v_exp_f32_e64 v205, v205
    v_mfma_f32_16x16x32_bf16 a[180:183], a[228:231], v[232:235], a[180:183]
    buffer_store_dwordx4 v[56:59], v11, s[32:35], s60 offen offset:64 nt sc1
    v_exp_f32_e64 v206, v206
    v_mfma_f32_16x16x32_bf16 a[184:187], a[232:235], v[232:235], a[184:187]
    v_exp_f32_e64 v207, v207
    v_mfma_f32_16x16x32_bf16 a[188:191], a[236:239], v[232:235], a[188:191]
    v_exp_f32_e64 v208, v208
    v_mfma_f32_16x16x32_bf16 a[192:195], a[48:51], v[232:235], a[192:195]
    v_exp_f32_e64 v209, v209
    v_mfma_f32_16x16x32_bf16 a[196:199], a[52:55], v[232:235], a[196:199]
    v_exp_f32_e64 v210, v210
    v_mfma_f32_16x16x32_bf16 a[200:203], a[56:59], v[232:235], a[200:203]
    v_cvt_pk_bf16_f32 v65, v66, v67
    v_cvt_pk_bf16_f32 v66, v68, v69
    v_mfma_f32_16x16x32_bf16 a[204:207], a[60:63], v[232:235], a[204:207]
    v_cvt_pk_bf16_f32 v67, v70, v71
    v_cvt_pk_bf16_f32 v228, v204, v205
    v_mfma_f32_16x16x32_bf16 v[212:215], v[112:115], a[32:35], v[184:187]
    v_cvt_pk_bf16_f32 v229, v206, v207
    v_cvt_pk_bf16_f32 v230, v208, v209
    v_mfma_f32_16x16x32_bf16 v[212:215], v[116:119], a[36:39], v[212:215]
    v_exp_f32_e64 v211, v211
    v_mfma_f32_16x16x32_bf16 v[212:215], v[120:123], a[40:43], v[212:215]
    v_cvt_pk_bf16_f32 v231, v210, v211
    v_cvt_pk_bf16_f32 v72, v72, v73
    v_mfma_f32_16x16x32_bf16 v[212:215], v[124:127], a[44:47], v[212:215]
    v_cvt_pk_bf16_f32 v73, v74, v75
    v_cvt_pk_bf16_f32 v74, v76, v77
    v_mfma_f32_16x16x32_bf16 v[216:219], v[128:131], a[32:35], v[184:187]
    v_cvt_pk_bf16_f32 v75, v78, v79
    s_or_b64 s[64:65], s[64:65], s[4:5]
    v_mfma_f32_16x16x32_bf16 v[216:219], v[132:135], a[36:39], v[216:219]
    buffer_store_dwordx4 v[64:67], v11, s[32:35], s60 offen offset:128 nt sc1
    s_or_b64 s[64:65], s[64:65], s[6:7]
    v_mfma_f32_16x16x32_bf16 v[216:219], v[136:139], a[40:43], v[216:219]
    v_exp_f32_e64 v212, v212
    v_mfma_f32_16x16x32_bf16 v[216:219], v[140:143], a[44:47], v[216:219]
    v_exp_f32_e64 v213, v213
    v_smfmac_f32_16x16x64_bf16 v[248:251], a[248:251], v[228:235], v12
    v_cvt_pk_bf16_f32 v232, v212, v213
    v_mfma_f32_16x16x32_bf16 a[176:179], v[144:147], v[228:231], a[176:179]
    v_exp_f32_e64 v214, v214
    v_mfma_f32_16x16x32_bf16 a[180:183], v[148:151], v[228:231], a[180:183]
    v_exp_f32_e64 v215, v215
    v_mfma_f32_16x16x32_bf16 a[184:187], v[152:155], v[228:231], a[184:187]
    v_exp_f32_e64 v216, v216
    v_mfma_f32_16x16x32_bf16 a[188:191], v[156:159], v[228:231], a[188:191]
    v_add_f32_e64 v14, v250, v251
    v_cvt_pk_bf16_f32 v233, v214, v215
    v_mfma_f32_16x16x32_bf16 a[192:195], v[160:163], v[228:231], a[192:195]
    ds_write_b128 v5, a[176:179]
    v_mfma_f32_16x16x32_bf16 a[196:199], v[164:167], v[228:231], a[196:199]
    v_exp_f32_e64 v217, v217
    v_mfma_f32_16x16x32_bf16 a[200:203], v[168:171], v[228:231], a[200:203]
    v_exp_f32_e64 v218, v218
    v_mfma_f32_16x16x32_bf16 a[204:207], v[172:175], v[228:231], a[204:207]
    buffer_store_dwordx4 v[72:75], v11, s[32:35], s60 offen offset:192 nt sc1
    ds_write_b32 v5, v14 offset:32776
    v_mfma_f32_16x16x32_bf16 v[204:207], a[96:99], a[32:35], v[184:187]
    v_exp_f32_e64 v219, v219
    v_mfma_f32_16x16x32_bf16 v[204:207], a[100:103], a[36:39], v[204:207]
    ds_write_b128 v5, a[180:183] offset:1024
    v_mfma_f32_16x16x32_bf16 v[204:207], a[104:107], a[40:43], v[204:207]
    v_cvt_pk_bf16_f32 v234, v216, v217
    v_cvt_pk_bf16_f32 v235, v218, v219
    v_mfma_f32_16x16x32_bf16 v[204:207], a[108:111], a[44:47], v[204:207]
    s_nop 0
    s_nop 0
    v_mfma_f32_16x16x32_bf16 v[208:211], a[208:211], a[32:35], v[184:187]
    ds_write_b128 v5, a[184:187] offset:2048
    v_mfma_f32_16x16x32_bf16 v[208:211], a[212:215], a[36:39], v[208:211]
    s_nop 0
    s_nop 0
    v_mfma_f32_16x16x32_bf16 v[208:211], a[216:219], a[40:43], v[208:211]
    v_exp_f32 v204, v204
    v_exp_f32 v205, v205
    v_mfma_f32_16x16x32_bf16 v[208:211], a[220:223], a[44:47], v[208:211]
    ds_write_b128 v5, a[188:191] offset:3072
    v_exp_f32_e64 v206, v206
    v_mfma_f32_16x16x32_bf16 v[80:83], v[144:147], v[232:235], v[80:83]
    v_exp_f32_e64 v207, v207
    v_mfma_f32_16x16x32_bf16 v[84:87], v[148:151], v[232:235], v[84:87]
    v_cvt_pk_bf16_f32 v228, v204, v205
    v_cvt_pk_bf16_f32 v229, v206, v207
    v_mfma_f32_16x16x32_bf16 v[88:91], v[152:155], v[232:235], v[88:91]
    ds_write_b128 v5, a[192:195] offset:4096
    v_exp_f32 v208, v208
    v_exp_f32 v209, v209
    v_mfma_f32_16x16x32_bf16 v[92:95], v[156:159], v[232:235], v[92:95]
    v_exp_f32_e64 v210, v210
    v_mfma_f32_16x16x32_bf16 v[96:99], v[160:163], v[232:235], v[96:99]
    ds_write_b128 v5, a[196:199] offset:5120
    v_exp_f32_e64 v211, v211
    v_mfma_f32_16x16x32_bf16 v[100:103], v[164:167], v[232:235], v[100:103]
    v_cvt_pk_bf16_f32 v230, v208, v209
    v_cvt_pk_bf16_f32 v231, v210, v211
    v_mfma_f32_16x16x32_bf16 v[104:107], v[168:171], v[232:235], v[104:107]
    s_nop 0
    s_nop 0
    v_mfma_f32_16x16x32_bf16 v[108:111], v[172:175], v[232:235], v[108:111]
    ds_write_b128 v5, a[200:203] offset:6144
    v_smfmac_f32_16x16x64_bf16 v[248:251], a[244:247], v[228:235], v12
    s_nop 0
    v_mfma_f32_16x16x32_bf16 v[80:83], a[224:227], v[228:231], v[80:83]
    s_nop 0
    s_nop 0
    v_mfma_f32_16x16x32_bf16 v[84:87], a[228:231], v[228:231], v[84:87]
    ds_write_b128 v5, a[204:207] offset:7168
    v_mfma_f32_16x16x32_bf16 v[88:91], a[232:235], v[228:231], v[88:91]
    s_nop 0
    v_add_f32_e64 v248, v248, v249
    v_mfma_f32_16x16x32_bf16 v[92:95], a[236:239], v[228:231], v[92:95]
    v_mfma_f32_16x16x32_bf16 v[96:99], a[48:51], v[228:231], v[96:99]
    v_mfma_f32_16x16x32_bf16 v[100:103], a[52:55], v[228:231], v[100:103]
    s_nop 0
    s_nop 0
    v_mfma_f32_16x16x32_bf16 v[104:107], a[56:59], v[228:231], v[104:107]
    s_nop 0
    s_nop 0
    s_waitcnt lgkmcnt(0)
    s_barrier
    ds_read_b32 v254, v7 offset:32776
    ds_read_b128 v[220:223], v7
    ds_read_b128 v[224:227], v7 offset:1024
    ds_read_b128 v[188:191], v7 offset:2048
    ds_read_b128 v[192:195], v7 offset:3072
    ds_read_b128 v[200:203], v7 offset:4096
    ds_read_b128 v[236:239], v7 offset:5120
    v_mfma_f32_16x16x32_bf16 v[108:111], a[60:63], v[228:231], v[108:111]
    ds_read_b128 v[16:19], v7 offset:6144
    ds_read_b128 v[20:23], v7 offset:7168
    s_waitcnt lgkmcnt(8)
    v_add_f32 v250, v248, v254
    v_cmp_nge_f32 s[8:9], s63, v250
    v_rcp_f32_e64 v250, v250
    s_nop 0
    s_or_b64 vcc, s[8:9], s[64:65]
    s_waitcnt lgkmcnt(6)
    v_pk_add_f32 v[80:81], v[80:81], v[220:221]
    v_pk_add_f32 v[82:83], v[82:83], v[222:223]
    v_pk_add_f32 v[84:85], v[84:85], v[224:225]
    v_pk_add_f32 v[86:87], v[86:87], v[226:227]
    v_cndmask_b32_e64 v255, 0, 1, vcc
    v_pk_mul_f32 v[80:81], v[80:81], v[250:251] op_sel_hi:[1,0]
    v_pk_mul_f32 v[82:83], v[82:83], v[250:251] op_sel_hi:[1,0]
    v_pk_mul_f32 v[84:85], v[84:85], v[250:251] op_sel_hi:[1,0]
    v_pk_mul_f32 v[86:87], v[86:87], v[250:251] op_sel_hi:[1,0]
    ds_write_b32 v5, v255 offset:32780
    s_waitcnt lgkmcnt(5)
    v_pk_add_f32 v[88:89], v[88:89], v[188:189]
    v_pk_add_f32 v[90:91], v[90:91], v[190:191]
    v_pk_add_f32 v[92:93], v[92:93], v[192:193]
    v_pk_add_f32 v[94:95], v[94:95], v[194:195]
    v_cvt_pk_bf16_f32 v80, v80, v81
    v_cvt_pk_bf16_f32 v81, v82, v83
    v_cvt_pk_bf16_f32 v82, v84, v85
    v_cvt_pk_bf16_f32 v83, v86, v87
    buffer_store_dwordx4 v[80:83], v11, s[32:35], s61 offen nt sc1
    s_waitcnt lgkmcnt(3)
    v_pk_add_f32 v[96:97], v[96:97], v[200:201]
    v_pk_add_f32 v[98:99], v[98:99], v[202:203]
    v_pk_add_f32 v[100:101], v[100:101], v[236:237]
    v_pk_add_f32 v[102:103], v[102:103], v[238:239]
    s_waitcnt lgkmcnt(1)
    v_pk_add_f32 v[104:105], v[104:105], v[16:17]
    v_pk_add_f32 v[106:107], v[106:107], v[18:19]
    v_pk_add_f32 v[108:109], v[108:109], v[20:21]
    v_pk_add_f32 v[110:111], v[110:111], v[22:23]
    v_pk_mul_f32 v[88:89], v[88:89], v[250:251] op_sel_hi:[1,0]
    v_pk_mul_f32 v[90:91], v[90:91], v[250:251] op_sel_hi:[1,0]
    v_pk_mul_f32 v[92:93], v[92:93], v[250:251] op_sel_hi:[1,0]
    v_pk_mul_f32 v[94:95], v[94:95], v[250:251] op_sel_hi:[1,0]
    v_cvt_pk_bf16_f32 v88, v88, v89
    v_cvt_pk_bf16_f32 v89, v90, v91
    v_cvt_pk_bf16_f32 v90, v92, v93
    v_cvt_pk_bf16_f32 v91, v94, v95
    buffer_store_dwordx4 v[88:91], v11, s[32:35], s61 offen offset:64 nt sc1
    v_pk_mul_f32 v[96:97], v[96:97], v[250:251] op_sel_hi:[1,0]
    v_pk_mul_f32 v[98:99], v[98:99], v[250:251] op_sel_hi:[1,0]
    v_pk_mul_f32 v[100:101], v[100:101], v[250:251] op_sel_hi:[1,0]
    v_pk_mul_f32 v[102:103], v[102:103], v[250:251] op_sel_hi:[1,0]
    v_cvt_pk_bf16_f32 v96, v96, v97
    v_cvt_pk_bf16_f32 v97, v98, v99
    v_cvt_pk_bf16_f32 v98, v100, v101
    v_cvt_pk_bf16_f32 v99, v102, v103
    buffer_store_dwordx4 v[96:99], v11, s[32:35], s61 offen offset:128 nt sc1
    v_pk_mul_f32 v[104:105], v[104:105], v[250:251] op_sel_hi:[1,0]
    v_pk_mul_f32 v[106:107], v[106:107], v[250:251] op_sel_hi:[1,0]
    v_pk_mul_f32 v[108:109], v[108:109], v[250:251] op_sel_hi:[1,0]
    v_pk_mul_f32 v[110:111], v[110:111], v[250:251] op_sel_hi:[1,0]
    v_cvt_pk_bf16_f32 v104, v104, v105
    v_cvt_pk_bf16_f32 v105, v106, v107
    v_cvt_pk_bf16_f32 v106, v108, v109
    v_cvt_pk_bf16_f32 v107, v110, v111
    buffer_store_dwordx4 v[104:107], v11, s[32:35], s61 offen offset:192 nt sc1
    s_waitcnt lgkmcnt(0)
    s_barrier
    ds_read2st64_b32 v[232:233], v9 offset0:0 offset1:32
    ds_read2st64_b32 v[234:235], v9 offset0:64 offset1:96
    s_waitcnt lgkmcnt(0)
    v_or3_b32 v232, v232, v233, v234
    v_or_b32 v232, v232, v235
    v_cmp_ne_u32 vcc, 0, v232
    s_nop 1
    s_and_b64 vcc, vcc, s[66:67]
X_end:
    s_endpgm
X_exact:
    s_and_b32 s94, s36, 1
    s_lshr_b32 s93, s36, 1
    s_lshl1_add_u32 s93, s94, s93
    s_xor_b32 s93, s93, 1
    s_mul_i32 s93, s93, 12288
    s_add_u32 s95, s97, 0
    buffer_load_dwordx4 v[48:51], v11, s[12:15], s95 offen
    buffer_load_dwordx4 v[52:55], v11, s[12:15], s95 offen offset:64
    buffer_load_dwordx4 v[56:59], v11, s[12:15], s95 offen offset:128
    buffer_load_dwordx4 v[60:63], v11, s[12:15], s95 offen offset:192
    s_add_u32 s95, s97, 4096
    buffer_load_dwordx4 v[64:67], v11, s[12:15], s95 offen
    buffer_load_dwordx4 v[68:71], v11, s[12:15], s95 offen offset:64
    buffer_load_dwordx4 v[72:75], v11, s[12:15], s95 offen offset:128
    buffer_load_dwordx4 v[76:79], v11, s[12:15], s95 offen offset:192
    s_add_u32 s95, s97, 8192
    buffer_load_dwordx4 v[80:83], v11, s[12:15], s95 offen
    buffer_load_dwordx4 v[84:87], v11, s[12:15], s95 offen offset:64
    buffer_load_dwordx4 v[88:91], v11, s[12:15], s95 offen offset:128
    buffer_load_dwordx4 v[92:95], v11, s[12:15], s95 offen offset:192
    s_add_u32 s95, s93, 0
    buffer_load_dwordx4 v[96:99], v11, s[12:15], s95 offen
    buffer_load_dwordx4 v[100:103], v11, s[12:15], s95 offen offset:64
    buffer_load_dwordx4 v[104:107], v11, s[12:15], s95 offen offset:128
    buffer_load_dwordx4 v[108:111], v11, s[12:15], s95 offen offset:192
    s_add_u32 s95, s93, 4096
    buffer_load_dwordx4 v[112:115], v11, s[12:15], s95 offen
    buffer_load_dwordx4 v[116:119], v11, s[12:15], s95 offen offset:64
    buffer_load_dwordx4 v[120:123], v11, s[12:15], s95 offen offset:128
    buffer_load_dwordx4 v[124:127], v11, s[12:15], s95 offen offset:192
    s_add_u32 s95, s93, 8192
    buffer_load_dwordx4 v[128:131], v11, s[12:15], s95 offen
    buffer_load_dwordx4 v[132:135], v11, s[12:15], s95 offen offset:64
    buffer_load_dwordx4 v[136:139], v11, s[12:15], s95 offen offset:128
    buffer_load_dwordx4 v[140:143], v11, s[12:15], s95 offen offset:192
    s_mov_b32 s95, 49152
    buffer_load_dwordx4 v[144:147], v11, s[12:15], s95 offen
    buffer_load_dwordx4 v[148:151], v11, s[12:15], s95 offen offset:64
    buffer_load_dwordx4 v[152:155], v11, s[12:15], s95 offen offset:128
    buffer_load_dwordx4 v[156:159], v11, s[12:15], s95 offen offset:192
    v_add_u32 v234, 0x25000, v234
    v_add_u32 v229, 0x25000, v10
    ds_write_b128 v229, v[240:243]
    s_waitcnt vmcnt(0)
    v_lshlrev_b32 v204, 16, v48
    v_and_b32 v205, 0xffff0000, v48
    v_lshlrev_b32 v206, 16, v49
    v_and_b32 v207, 0xffff0000, v49
    v_lshlrev_b32 v208, 16, v50
    v_and_b32 v209, 0xffff0000, v50
    v_lshlrev_b32 v210, 16, v51
    v_and_b32 v211, 0xffff0000, v51
    v_pk_mul_f32 v[204:205], v[204:205], s[98:99]
    v_pk_mul_f32 v[206:207], v[206:207], s[98:99]
    v_pk_mul_f32 v[208:209], v[208:209], s[98:99]
    v_pk_mul_f32 v[210:211], v[210:211], s[98:99]
    v_cvt_pk_bf16_f32 v48, v204, v205
    v_cvt_pk_bf16_f32 v49, v206, v207
    v_cvt_pk_bf16_f32 v50, v208, v209
    v_cvt_pk_bf16_f32 v51, v210, v211
    v_lshlrev_b32 v204, 16, v52
    v_and_b32 v205, 0xffff0000, v52
    v_lshlrev_b32 v206, 16, v53
    v_and_b32 v207, 0xffff0000, v53
    v_lshlrev_b32 v208, 16, v54
    v_and_b32 v209, 0xffff0000, v54
    v_lshlrev_b32 v210, 16, v55
    v_and_b32 v211, 0xffff0000, v55
    v_pk_mul_f32 v[204:205], v[204:205], s[98:99]
    v_pk_mul_f32 v[206:207], v[206:207], s[98:99]
    v_pk_mul_f32 v[208:209], v[208:209], s[98:99]
    v_pk_mul_f32 v[210:211], v[210:211], s[98:99]
    v_cvt_pk_bf16_f32 v52, v204, v205
    v_cvt_pk_bf16_f32 v53, v206, v207
    v_cvt_pk_bf16_f32 v54, v208, v209
    v_cvt_pk_bf16_f32 v55, v210, v211
    v_lshlrev_b32 v204, 16, v56
    v_and_b32 v205, 0xffff0000, v56
    v_lshlrev_b32 v206, 16, v57
    v_and_b32 v207, 0xffff0000, v57
    v_lshlrev_b32 v208, 16, v58
    v_and_b32 v209, 0xffff0000, v58
    v_lshlrev_b32 v210, 16, v59
    v_and_b32 v211, 0xffff0000, v59
    v_pk_mul_f32 v[204:205], v[204:205], s[98:99]
    v_pk_mul_f32 v[206:207], v[206:207], s[98:99]
    v_pk_mul_f32 v[208:209], v[208:209], s[98:99]
    v_pk_mul_f32 v[210:211], v[210:211], s[98:99]
    v_cvt_pk_bf16_f32 v56, v204, v205
    v_cvt_pk_bf16_f32 v57, v206, v207
    v_cvt_pk_bf16_f32 v58, v208, v209
    v_cvt_pk_bf16_f32 v59, v210, v211
    v_lshlrev_b32 v204, 16, v60
    v_and_b32 v205, 0xffff0000, v60
    v_lshlrev_b32 v206, 16, v61
    v_and_b32 v207, 0xffff0000, v61
    v_lshlrev_b32 v208, 16, v62
    v_and_b32 v209, 0xffff0000, v62
    v_lshlrev_b32 v210, 16, v63
    v_and_b32 v211, 0xffff0000, v63
    v_pk_mul_f32 v[204:205], v[204:205], s[98:99]
    v_pk_mul_f32 v[206:207], v[206:207], s[98:99]
    v_pk_mul_f32 v[208:209], v[208:209], s[98:99]
    v_pk_mul_f32 v[210:211], v[210:211], s[98:99]
    v_cvt_pk_bf16_f32 v60, v204, v205
    v_cvt_pk_bf16_f32 v61, v206, v207
    v_cvt_pk_bf16_f32 v62, v208, v209
    v_cvt_pk_bf16_f32 v63, v210, v211
    v_lshlrev_b32 v204, 16, v64
    v_and_b32 v205, 0xffff0000, v64
    v_lshlrev_b32 v206, 16, v65
    v_and_b32 v207, 0xffff0000, v65
    v_lshlrev_b32 v208, 16, v66
    v_and_b32 v209, 0xffff0000, v66
    v_lshlrev_b32 v210, 16, v67
    v_and_b32 v211, 0xffff0000, v67
    v_pk_mul_f32 v[204:205], v[204:205], s[98:99]
    v_pk_mul_f32 v[206:207], v[206:207], s[98:99]
    v_pk_mul_f32 v[208:209], v[208:209], s[98:99]
    v_pk_mul_f32 v[210:211], v[210:211], s[98:99]
    v_cvt_pk_bf16_f32 v64, v204, v205
    v_cvt_pk_bf16_f32 v65, v206, v207
    v_cvt_pk_bf16_f32 v66, v208, v209
    v_cvt_pk_bf16_f32 v67, v210, v211
    v_lshlrev_b32 v204, 16, v68
    v_and_b32 v205, 0xffff0000, v68
    v_lshlrev_b32 v206, 16, v69
    v_and_b32 v207, 0xffff0000, v69
    v_lshlrev_b32 v208, 16, v70
    v_and_b32 v209, 0xffff0000, v70
    v_lshlrev_b32 v210, 16, v71
    v_and_b32 v211, 0xffff0000, v71
    v_pk_mul_f32 v[204:205], v[204:205], s[98:99]
    v_pk_mul_f32 v[206:207], v[206:207], s[98:99]
    v_pk_mul_f32 v[208:209], v[208:209], s[98:99]
    v_pk_mul_f32 v[210:211], v[210:211], s[98:99]
    v_cvt_pk_bf16_f32 v68, v204, v205
    v_cvt_pk_bf16_f32 v69, v206, v207
    v_cvt_pk_bf16_f32 v70, v208, v209
    v_cvt_pk_bf16_f32 v71, v210, v211
    v_lshlrev_b32 v204, 16, v72
    v_and_b32 v205, 0xffff0000, v72
    v_lshlrev_b32 v206, 16, v73
    v_and_b32 v207, 0xffff0000, v73
    v_lshlrev_b32 v208, 16, v74
    v_and_b32 v209, 0xffff0000, v74
    v_lshlrev_b32 v210, 16, v75
    v_and_b32 v211, 0xffff0000, v75
    v_pk_mul_f32 v[204:205], v[204:205], s[98:99]
    v_pk_mul_f32 v[206:207], v[206:207], s[98:99]
    v_pk_mul_f32 v[208:209], v[208:209], s[98:99]
    v_pk_mul_f32 v[210:211], v[210:211], s[98:99]
    v_cvt_pk_bf16_f32 v72, v204, v205
    v_cvt_pk_bf16_f32 v73, v206, v207
    v_cvt_pk_bf16_f32 v74, v208, v209
    v_cvt_pk_bf16_f32 v75, v210, v211
    v_lshlrev_b32 v204, 16, v76
    v_and_b32 v205, 0xffff0000, v76
    v_lshlrev_b32 v206, 16, v77
    v_and_b32 v207, 0xffff0000, v77
    v_lshlrev_b32 v208, 16, v78
    v_and_b32 v209, 0xffff0000, v78
    v_lshlrev_b32 v210, 16, v79
    v_and_b32 v211, 0xffff0000, v79
    v_pk_mul_f32 v[204:205], v[204:205], s[98:99]
    v_pk_mul_f32 v[206:207], v[206:207], s[98:99]
    v_pk_mul_f32 v[208:209], v[208:209], s[98:99]
    v_pk_mul_f32 v[210:211], v[210:211], s[98:99]
    v_cvt_pk_bf16_f32 v76, v204, v205
    v_cvt_pk_bf16_f32 v77, v206, v207
    v_cvt_pk_bf16_f32 v78, v208, v209
    v_cvt_pk_bf16_f32 v79, v210, v211
    v_lshlrev_b32 v204, 16, v80
    v_and_b32 v205, 0xffff0000, v80
    v_lshlrev_b32 v206, 16, v81
    v_and_b32 v207, 0xffff0000, v81
    v_lshlrev_b32 v208, 16, v82
    v_and_b32 v209, 0xffff0000, v82
    v_lshlrev_b32 v210, 16, v83
    v_and_b32 v211, 0xffff0000, v83
    v_pk_mul_f32 v[204:205], v[204:205], s[98:99]
    v_pk_mul_f32 v[206:207], v[206:207], s[98:99]
    v_pk_mul_f32 v[208:209], v[208:209], s[98:99]
    v_pk_mul_f32 v[210:211], v[210:211], s[98:99]
    v_cvt_pk_bf16_f32 v80, v204, v205
    v_cvt_pk_bf16_f32 v81, v206, v207
    v_cvt_pk_bf16_f32 v82, v208, v209
    v_cvt_pk_bf16_f32 v83, v210, v211
    v_lshlrev_b32 v204, 16, v84
    v_and_b32 v205, 0xffff0000, v84
    v_lshlrev_b32 v206, 16, v85
    v_and_b32 v207, 0xffff0000, v85
    v_lshlrev_b32 v208, 16, v86
    v_and_b32 v209, 0xffff0000, v86
    v_lshlrev_b32 v210, 16, v87
    v_and_b32 v211, 0xffff0000, v87
    v_pk_mul_f32 v[204:205], v[204:205], s[98:99]
    v_pk_mul_f32 v[206:207], v[206:207], s[98:99]
    v_pk_mul_f32 v[208:209], v[208:209], s[98:99]
    v_pk_mul_f32 v[210:211], v[210:211], s[98:99]
    v_cvt_pk_bf16_f32 v84, v204, v205
    v_cvt_pk_bf16_f32 v85, v206, v207
    v_cvt_pk_bf16_f32 v86, v208, v209
    v_cvt_pk_bf16_f32 v87, v210, v211
    v_lshlrev_b32 v204, 16, v88
    v_and_b32 v205, 0xffff0000, v88
    v_lshlrev_b32 v206, 16, v89
    v_and_b32 v207, 0xffff0000, v89
    v_lshlrev_b32 v208, 16, v90
    v_and_b32 v209, 0xffff0000, v90
    v_lshlrev_b32 v210, 16, v91
    v_and_b32 v211, 0xffff0000, v91
    v_pk_mul_f32 v[204:205], v[204:205], s[98:99]
    v_pk_mul_f32 v[206:207], v[206:207], s[98:99]
    v_pk_mul_f32 v[208:209], v[208:209], s[98:99]
    v_pk_mul_f32 v[210:211], v[210:211], s[98:99]
    v_cvt_pk_bf16_f32 v88, v204, v205
    v_cvt_pk_bf16_f32 v89, v206, v207
    v_cvt_pk_bf16_f32 v90, v208, v209
    v_cvt_pk_bf16_f32 v91, v210, v211
    v_lshlrev_b32 v204, 16, v92
    v_and_b32 v205, 0xffff0000, v92
    v_lshlrev_b32 v206, 16, v93
    v_and_b32 v207, 0xffff0000, v93
    v_lshlrev_b32 v208, 16, v94
    v_and_b32 v209, 0xffff0000, v94
    v_lshlrev_b32 v210, 16, v95
    v_and_b32 v211, 0xffff0000, v95
    v_pk_mul_f32 v[204:205], v[204:205], s[98:99]
    v_pk_mul_f32 v[206:207], v[206:207], s[98:99]
    v_pk_mul_f32 v[208:209], v[208:209], s[98:99]
    v_pk_mul_f32 v[210:211], v[210:211], s[98:99]
    v_cvt_pk_bf16_f32 v92, v204, v205
    v_cvt_pk_bf16_f32 v93, v206, v207
    v_cvt_pk_bf16_f32 v94, v208, v209
    v_cvt_pk_bf16_f32 v95, v210, v211
    v_lshlrev_b32 v204, 16, v96
    v_and_b32 v205, 0xffff0000, v96
    v_lshlrev_b32 v206, 16, v97
    v_and_b32 v207, 0xffff0000, v97
    v_lshlrev_b32 v208, 16, v98
    v_and_b32 v209, 0xffff0000, v98
    v_lshlrev_b32 v210, 16, v99
    v_and_b32 v211, 0xffff0000, v99
    v_pk_mul_f32 v[204:205], v[204:205], s[98:99]
    v_pk_mul_f32 v[206:207], v[206:207], s[98:99]
    v_pk_mul_f32 v[208:209], v[208:209], s[98:99]
    v_pk_mul_f32 v[210:211], v[210:211], s[98:99]
    v_cvt_pk_bf16_f32 v96, v204, v205
    v_cvt_pk_bf16_f32 v97, v206, v207
    v_cvt_pk_bf16_f32 v98, v208, v209
    v_cvt_pk_bf16_f32 v99, v210, v211
    v_lshlrev_b32 v204, 16, v100
    v_and_b32 v205, 0xffff0000, v100
    v_lshlrev_b32 v206, 16, v101
    v_and_b32 v207, 0xffff0000, v101
    v_lshlrev_b32 v208, 16, v102
    v_and_b32 v209, 0xffff0000, v102
    v_lshlrev_b32 v210, 16, v103
    v_and_b32 v211, 0xffff0000, v103
    v_pk_mul_f32 v[204:205], v[204:205], s[98:99]
    v_pk_mul_f32 v[206:207], v[206:207], s[98:99]
    v_pk_mul_f32 v[208:209], v[208:209], s[98:99]
    v_pk_mul_f32 v[210:211], v[210:211], s[98:99]
    v_cvt_pk_bf16_f32 v100, v204, v205
    v_cvt_pk_bf16_f32 v101, v206, v207
    v_cvt_pk_bf16_f32 v102, v208, v209
    v_cvt_pk_bf16_f32 v103, v210, v211
    v_lshlrev_b32 v204, 16, v104
    v_and_b32 v205, 0xffff0000, v104
    v_lshlrev_b32 v206, 16, v105
    v_and_b32 v207, 0xffff0000, v105
    v_lshlrev_b32 v208, 16, v106
    v_and_b32 v209, 0xffff0000, v106
    v_lshlrev_b32 v210, 16, v107
    v_and_b32 v211, 0xffff0000, v107
    v_pk_mul_f32 v[204:205], v[204:205], s[98:99]
    v_pk_mul_f32 v[206:207], v[206:207], s[98:99]
    v_pk_mul_f32 v[208:209], v[208:209], s[98:99]
    v_pk_mul_f32 v[210:211], v[210:211], s[98:99]
    v_cvt_pk_bf16_f32 v104, v204, v205
    v_cvt_pk_bf16_f32 v105, v206, v207
    v_cvt_pk_bf16_f32 v106, v208, v209
    v_cvt_pk_bf16_f32 v107, v210, v211
    v_lshlrev_b32 v204, 16, v108
    v_and_b32 v205, 0xffff0000, v108
    v_lshlrev_b32 v206, 16, v109
    v_and_b32 v207, 0xffff0000, v109
    v_lshlrev_b32 v208, 16, v110
    v_and_b32 v209, 0xffff0000, v110
    v_lshlrev_b32 v210, 16, v111
    v_and_b32 v211, 0xffff0000, v111
    v_pk_mul_f32 v[204:205], v[204:205], s[98:99]
    v_pk_mul_f32 v[206:207], v[206:207], s[98:99]
    v_pk_mul_f32 v[208:209], v[208:209], s[98:99]
    v_pk_mul_f32 v[210:211], v[210:211], s[98:99]
    v_cvt_pk_bf16_f32 v108, v204, v205
    v_cvt_pk_bf16_f32 v109, v206, v207
    v_cvt_pk_bf16_f32 v110, v208, v209
    v_cvt_pk_bf16_f32 v111, v210, v211
    v_lshlrev_b32 v204, 16, v112
    v_and_b32 v205, 0xffff0000, v112
    v_lshlrev_b32 v206, 16, v113
    v_and_b32 v207, 0xffff0000, v113
    v_lshlrev_b32 v208, 16, v114
    v_and_b32 v209, 0xffff0000, v114
    v_lshlrev_b32 v210, 16, v115
    v_and_b32 v211, 0xffff0000, v115
    v_pk_mul_f32 v[204:205], v[204:205], s[98:99]
    v_pk_mul_f32 v[206:207], v[206:207], s[98:99]
    v_pk_mul_f32 v[208:209], v[208:209], s[98:99]
    v_pk_mul_f32 v[210:211], v[210:211], s[98:99]
    v_cvt_pk_bf16_f32 v112, v204, v205
    v_cvt_pk_bf16_f32 v113, v206, v207
    v_cvt_pk_bf16_f32 v114, v208, v209
    v_cvt_pk_bf16_f32 v115, v210, v211
    v_lshlrev_b32 v204, 16, v116
    v_and_b32 v205, 0xffff0000, v116
    v_lshlrev_b32 v206, 16, v117
    v_and_b32 v207, 0xffff0000, v117
    v_lshlrev_b32 v208, 16, v118
    v_and_b32 v209, 0xffff0000, v118
    v_lshlrev_b32 v210, 16, v119
    v_and_b32 v211, 0xffff0000, v119
    v_pk_mul_f32 v[204:205], v[204:205], s[98:99]
    v_pk_mul_f32 v[206:207], v[206:207], s[98:99]
    v_pk_mul_f32 v[208:209], v[208:209], s[98:99]
    v_pk_mul_f32 v[210:211], v[210:211], s[98:99]
    v_cvt_pk_bf16_f32 v116, v204, v205
    v_cvt_pk_bf16_f32 v117, v206, v207
    v_cvt_pk_bf16_f32 v118, v208, v209
    v_cvt_pk_bf16_f32 v119, v210, v211
    v_lshlrev_b32 v204, 16, v120
    v_and_b32 v205, 0xffff0000, v120
    v_lshlrev_b32 v206, 16, v121
    v_and_b32 v207, 0xffff0000, v121
    v_lshlrev_b32 v208, 16, v122
    v_and_b32 v209, 0xffff0000, v122
    v_lshlrev_b32 v210, 16, v123
    v_and_b32 v211, 0xffff0000, v123
    v_pk_mul_f32 v[204:205], v[204:205], s[98:99]
    v_pk_mul_f32 v[206:207], v[206:207], s[98:99]
    v_pk_mul_f32 v[208:209], v[208:209], s[98:99]
    v_pk_mul_f32 v[210:211], v[210:211], s[98:99]
    v_cvt_pk_bf16_f32 v120, v204, v205
    v_cvt_pk_bf16_f32 v121, v206, v207
    v_cvt_pk_bf16_f32 v122, v208, v209
    v_cvt_pk_bf16_f32 v123, v210, v211
    v_lshlrev_b32 v204, 16, v124
    v_and_b32 v205, 0xffff0000, v124
    v_lshlrev_b32 v206, 16, v125
    v_and_b32 v207, 0xffff0000, v125
    v_lshlrev_b32 v208, 16, v126
    v_and_b32 v209, 0xffff0000, v126
    v_lshlrev_b32 v210, 16, v127
    v_and_b32 v211, 0xffff0000, v127
    v_pk_mul_f32 v[204:205], v[204:205], s[98:99]
    v_pk_mul_f32 v[206:207], v[206:207], s[98:99]
    v_pk_mul_f32 v[208:209], v[208:209], s[98:99]
    v_pk_mul_f32 v[210:211], v[210:211], s[98:99]
    v_cvt_pk_bf16_f32 v124, v204, v205
    v_cvt_pk_bf16_f32 v125, v206, v207
    v_cvt_pk_bf16_f32 v126, v208, v209
    v_cvt_pk_bf16_f32 v127, v210, v211
    v_lshlrev_b32 v204, 16, v128
    v_and_b32 v205, 0xffff0000, v128
    v_lshlrev_b32 v206, 16, v129
    v_and_b32 v207, 0xffff0000, v129
    v_lshlrev_b32 v208, 16, v130
    v_and_b32 v209, 0xffff0000, v130
    v_lshlrev_b32 v210, 16, v131
    v_and_b32 v211, 0xffff0000, v131
    v_pk_mul_f32 v[204:205], v[204:205], s[98:99]
    v_pk_mul_f32 v[206:207], v[206:207], s[98:99]
    v_pk_mul_f32 v[208:209], v[208:209], s[98:99]
    v_pk_mul_f32 v[210:211], v[210:211], s[98:99]
    v_cvt_pk_bf16_f32 v128, v204, v205
    v_cvt_pk_bf16_f32 v129, v206, v207
    v_cvt_pk_bf16_f32 v130, v208, v209
    v_cvt_pk_bf16_f32 v131, v210, v211
    v_lshlrev_b32 v204, 16, v132
    v_and_b32 v205, 0xffff0000, v132
    v_lshlrev_b32 v206, 16, v133
    v_and_b32 v207, 0xffff0000, v133
    v_lshlrev_b32 v208, 16, v134
    v_and_b32 v209, 0xffff0000, v134
    v_lshlrev_b32 v210, 16, v135
    v_and_b32 v211, 0xffff0000, v135
    v_pk_mul_f32 v[204:205], v[204:205], s[98:99]
    v_pk_mul_f32 v[206:207], v[206:207], s[98:99]
    v_pk_mul_f32 v[208:209], v[208:209], s[98:99]
    v_pk_mul_f32 v[210:211], v[210:211], s[98:99]
    v_cvt_pk_bf16_f32 v132, v204, v205
    v_cvt_pk_bf16_f32 v133, v206, v207
    v_cvt_pk_bf16_f32 v134, v208, v209
    v_cvt_pk_bf16_f32 v135, v210, v211
    v_lshlrev_b32 v204, 16, v136
    v_and_b32 v205, 0xffff0000, v136
    v_lshlrev_b32 v206, 16, v137
    v_and_b32 v207, 0xffff0000, v137
    v_lshlrev_b32 v208, 16, v138
    v_and_b32 v209, 0xffff0000, v138
    v_lshlrev_b32 v210, 16, v139
    v_and_b32 v211, 0xffff0000, v139
    v_pk_mul_f32 v[204:205], v[204:205], s[98:99]
    v_pk_mul_f32 v[206:207], v[206:207], s[98:99]
    v_pk_mul_f32 v[208:209], v[208:209], s[98:99]
    v_pk_mul_f32 v[210:211], v[210:211], s[98:99]
    v_cvt_pk_bf16_f32 v136, v204, v205
    v_cvt_pk_bf16_f32 v137, v206, v207
    v_cvt_pk_bf16_f32 v138, v208, v209
    v_cvt_pk_bf16_f32 v139, v210, v211
    v_lshlrev_b32 v204, 16, v140
    v_and_b32 v205, 0xffff0000, v140
    v_lshlrev_b32 v206, 16, v141
    v_and_b32 v207, 0xffff0000, v141
    v_lshlrev_b32 v208, 16, v142
    v_and_b32 v209, 0xffff0000, v142
    v_lshlrev_b32 v210, 16, v143
    v_and_b32 v211, 0xffff0000, v143
    v_pk_mul_f32 v[204:205], v[204:205], s[98:99]
    v_pk_mul_f32 v[206:207], v[206:207], s[98:99]
    v_pk_mul_f32 v[208:209], v[208:209], s[98:99]
    v_pk_mul_f32 v[210:211], v[210:211], s[98:99]
    v_cvt_pk_bf16_f32 v140, v204, v205
    v_cvt_pk_bf16_f32 v141, v206, v207
    v_cvt_pk_bf16_f32 v142, v208, v209
    v_cvt_pk_bf16_f32 v143, v210, v211
    v_lshlrev_b32 v204, 16, v144
    v_and_b32 v205, 0xffff0000, v144
    v_lshlrev_b32 v206, 16, v145
    v_and_b32 v207, 0xffff0000, v145
    v_lshlrev_b32 v208, 16, v146
    v_and_b32 v209, 0xffff0000, v146
    v_lshlrev_b32 v210, 16, v147
    v_and_b32 v211, 0xffff0000, v147
    v_pk_mul_f32 v[204:205], v[204:205], s[98:99]
    v_pk_mul_f32 v[206:207], v[206:207], s[98:99]
    v_pk_mul_f32 v[208:209], v[208:209], s[98:99]
    v_pk_mul_f32 v[210:211], v[210:211], s[98:99]
    v_cvt_pk_bf16_f32 v144, v204, v205
    v_cvt_pk_bf16_f32 v145, v206, v207
    v_cvt_pk_bf16_f32 v146, v208, v209
    v_cvt_pk_bf16_f32 v147, v210, v211
    v_lshlrev_b32 v204, 16, v148
    v_and_b32 v205, 0xffff0000, v148
    v_lshlrev_b32 v206, 16, v149
    v_and_b32 v207, 0xffff0000, v149
    v_lshlrev_b32 v208, 16, v150
    v_and_b32 v209, 0xffff0000, v150
    v_lshlrev_b32 v210, 16, v151
    v_and_b32 v211, 0xffff0000, v151
    v_pk_mul_f32 v[204:205], v[204:205], s[98:99]
    v_pk_mul_f32 v[206:207], v[206:207], s[98:99]
    v_pk_mul_f32 v[208:209], v[208:209], s[98:99]
    v_pk_mul_f32 v[210:211], v[210:211], s[98:99]
    v_cvt_pk_bf16_f32 v148, v204, v205
    v_cvt_pk_bf16_f32 v149, v206, v207
    v_cvt_pk_bf16_f32 v150, v208, v209
    v_cvt_pk_bf16_f32 v151, v210, v211
    v_lshlrev_b32 v204, 16, v152
    v_and_b32 v205, 0xffff0000, v152
    v_lshlrev_b32 v206, 16, v153
    v_and_b32 v207, 0xffff0000, v153
    v_lshlrev_b32 v208, 16, v154
    v_and_b32 v209, 0xffff0000, v154
    v_lshlrev_b32 v210, 16, v155
    v_and_b32 v211, 0xffff0000, v155
    v_pk_mul_f32 v[204:205], v[204:205], s[98:99]
    v_pk_mul_f32 v[206:207], v[206:207], s[98:99]
    v_pk_mul_f32 v[208:209], v[208:209], s[98:99]
    v_pk_mul_f32 v[210:211], v[210:211], s[98:99]
    v_cvt_pk_bf16_f32 v152, v204, v205
    v_cvt_pk_bf16_f32 v153, v206, v207
    v_cvt_pk_bf16_f32 v154, v208, v209
    v_cvt_pk_bf16_f32 v155, v210, v211
    v_lshlrev_b32 v204, 16, v156
    v_and_b32 v205, 0xffff0000, v156
    v_lshlrev_b32 v206, 16, v157
    v_and_b32 v207, 0xffff0000, v157
    v_lshlrev_b32 v208, 16, v158
    v_and_b32 v209, 0xffff0000, v158
    v_lshlrev_b32 v210, 16, v159
    v_and_b32 v211, 0xffff0000, v159
    v_pk_mul_f32 v[204:205], v[204:205], s[98:99]
    v_pk_mul_f32 v[206:207], v[206:207], s[98:99]
    v_pk_mul_f32 v[208:209], v[208:209], s[98:99]
    v_pk_mul_f32 v[210:211], v[210:211], s[98:99]
    v_cvt_pk_bf16_f32 v156, v204, v205
    v_cvt_pk_bf16_f32 v157, v206, v207
    v_cvt_pk_bf16_f32 v158, v208, v209
    v_cvt_pk_bf16_f32 v159, v210, v211
    v_mov_b32 v204, 0xff800000
    v_mov_b32 v205, 0xff800000
    v_mov_b32 v206, 0xff800000
    v_mov_b32 v207, 0xff800000
    v_mov_b32 v208, 0xff800000
    v_mov_b32 v209, 0xff800000
    v_mov_b32 v210, 0xff800000
    s_mov_b32 s95, 0
X_fbloop:
    buffer_load_dwordx4 v[160:163], v11, s[88:91], s95 offen
    buffer_load_dwordx4 v[164:167], v11, s[88:91], s95 offen offset:64
    buffer_load_dwordx4 v[168:171], v11, s[88:91], s95 offen offset:128
    buffer_load_dwordx4 v[172:175], v11, s[88:91], s95 offen offset:192
    s_waitcnt vmcnt(0)
    v_mfma_f32_16x16x32_bf16 v[176:179], v[160:163], v[48:51], 0
    v_mfma_f32_16x16x32_bf16 v[176:179], v[164:167], v[52:55], v[176:179]
    v_mfma_f32_16x16x32_bf16 v[176:179], v[168:171], v[56:59], v[176:179]
    v_mfma_f32_16x16x32_bf16 v[176:179], v[172:175], v[60:63], v[176:179]
    v_mfma_f32_16x16x32_bf16 v[180:183], v[160:163], v[64:67], 0
    v_mfma_f32_16x16x32_bf16 v[180:183], v[164:167], v[68:71], v[180:183]
    v_mfma_f32_16x16x32_bf16 v[180:183], v[168:171], v[72:75], v[180:183]
    v_mfma_f32_16x16x32_bf16 v[180:183], v[172:175], v[76:79], v[180:183]
    v_mfma_f32_16x16x32_bf16 v[184:187], v[160:163], v[80:83], 0
    v_mfma_f32_16x16x32_bf16 v[184:187], v[164:167], v[84:87], v[184:187]
    v_mfma_f32_16x16x32_bf16 v[184:187], v[168:171], v[88:91], v[184:187]
    v_mfma_f32_16x16x32_bf16 v[184:187], v[172:175], v[92:95], v[184:187]
    v_mfma_f32_16x16x32_bf16 v[188:191], v[160:163], v[96:99], 0
    v_mfma_f32_16x16x32_bf16 v[188:191], v[164:167], v[100:103], v[188:191]
    v_mfma_f32_16x16x32_bf16 v[188:191], v[168:171], v[104:107], v[188:191]
    v_mfma_f32_16x16x32_bf16 v[188:191], v[172:175], v[108:111], v[188:191]
    v_mfma_f32_16x16x32_bf16 v[192:195], v[160:163], v[112:115], 0
    v_mfma_f32_16x16x32_bf16 v[192:195], v[164:167], v[116:119], v[192:195]
    v_mfma_f32_16x16x32_bf16 v[192:195], v[168:171], v[120:123], v[192:195]
    v_mfma_f32_16x16x32_bf16 v[192:195], v[172:175], v[124:127], v[192:195]
    v_mfma_f32_16x16x32_bf16 v[196:199], v[160:163], v[128:131], 0
    v_mfma_f32_16x16x32_bf16 v[196:199], v[164:167], v[132:135], v[196:199]
    v_mfma_f32_16x16x32_bf16 v[196:199], v[168:171], v[136:139], v[196:199]
    v_mfma_f32_16x16x32_bf16 v[196:199], v[172:175], v[140:143], v[196:199]
    v_mfma_f32_16x16x32_bf16 v[200:203], v[160:163], v[144:147], 0
    v_mfma_f32_16x16x32_bf16 v[200:203], v[164:167], v[148:151], v[200:203]
    v_mfma_f32_16x16x32_bf16 v[200:203], v[168:171], v[152:155], v[200:203]
    v_mfma_f32_16x16x32_bf16 v[200:203], v[172:175], v[156:159], v[200:203]
    v_max3_f32 v204, v204, v176, v177
    v_max3_f32 v204, v204, v178, v179
    v_max3_f32 v205, v205, v180, v181
    v_max3_f32 v205, v205, v182, v183
    v_max3_f32 v206, v206, v184, v185
    v_max3_f32 v206, v206, v186, v187
    v_max3_f32 v207, v207, v188, v189
    v_max3_f32 v207, v207, v190, v191
    v_max3_f32 v208, v208, v192, v193
    v_max3_f32 v208, v208, v194, v195
    v_max3_f32 v209, v209, v196, v197
    v_max3_f32 v209, v209, v198, v199
    v_max3_f32 v210, v210, v200, v201
    v_max3_f32 v210, v210, v202, v203
    s_add_u32 s95, s95, 4096
    s_cmp_lt_u32 s95, 524288
    s_nop 7
    s_cbranch_scc1 X_fbloop
    v_mov_b32 v212, v204
    v_mov_b32 v213, v205
    v_mov_b32 v214, v206
    v_mov_b32 v215, v207
    v_mov_b32 v216, v208
    v_mov_b32 v217, v209
    v_mov_b32 v218, v210
    v_permlane32_swap_b32 v204, v212
    v_permlane32_swap_b32 v205, v213
    v_permlane32_swap_b32 v206, v214
    v_permlane32_swap_b32 v207, v215
    v_permlane32_swap_b32 v208, v216
    v_permlane32_swap_b32 v209, v217
    v_permlane32_swap_b32 v210, v218
    v_max_f32 v204, v204, v212
    v_max_f32 v205, v205, v213
    v_max_f32 v206, v206, v214
    v_max_f32 v207, v207, v215
    v_max_f32 v208, v208, v216
    v_max_f32 v209, v209, v217
    v_max_f32 v210, v210, v218
    v_mov_b32 v212, v204
    v_mov_b32 v213, v205
    v_mov_b32 v214, v206
    v_mov_b32 v215, v207
    v_mov_b32 v216, v208
    v_mov_b32 v217, v209
    v_mov_b32 v218, v210
    v_permlane16_swap_b32 v204, v212
    v_permlane16_swap_b32 v205, v213
    v_permlane16_swap_b32 v206, v214
    v_permlane16_swap_b32 v207, v215
    v_permlane16_swap_b32 v208, v216
    v_permlane16_swap_b32 v209, v217
    v_permlane16_swap_b32 v210, v218
    v_max_f32 v204, v204, v212
    v_max_f32 v205, v205, v213
    v_max_f32 v206, v206, v214
    v_max_f32 v207, v207, v215
    v_max_f32 v208, v208, v216
    v_max_f32 v209, v209, v217
    v_max_f32 v210, v210, v218
    v_sub_f32 v176, 0, v204
    v_sub_f32 v177, 0, v204
    v_sub_f32 v178, 0, v204
    v_sub_f32 v179, 0, v204
    v_sub_f32 v180, 0, v205
    v_sub_f32 v181, 0, v205
    v_sub_f32 v182, 0, v205
    v_sub_f32 v183, 0, v205
    v_sub_f32 v184, 0, v206
    v_sub_f32 v185, 0, v206
    v_sub_f32 v186, 0, v206
    v_sub_f32 v187, 0, v206
    v_sub_f32 v188, 0, v207
    v_sub_f32 v189, 0, v207
    v_sub_f32 v190, 0, v207
    v_sub_f32 v191, 0, v207
    v_sub_f32 v192, 0, v208
    v_sub_f32 v193, 0, v208
    v_sub_f32 v194, 0, v208
    v_sub_f32 v195, 0, v208
    v_sub_f32 v196, 0, v209
    v_sub_f32 v197, 0, v209
    v_sub_f32 v198, 0, v209
    v_sub_f32 v199, 0, v209
    v_sub_f32 v200, 0, v210
    v_sub_f32 v201, 0, v210
    v_sub_f32 v202, 0, v210
    v_sub_f32 v203, 0, v210
    s_waitcnt lgkmcnt(0)
    s_nop 7
    s_branch X_enter
.section .rodata,"a"
.p2align 6
.amdhsa_kernel standalone__gqa_softmax__near_ridge_kernel
  .amdhsa_next_free_vgpr 512
  .amdhsa_next_free_sgpr 102
  .amdhsa_accum_offset 256
  .amdhsa_group_segment_fixed_size 0
  .amdhsa_kernarg_size 48
  .amdhsa_user_sgpr_count 2
  .amdhsa_user_sgpr_kernarg_segment_ptr 1
  .amdhsa_system_sgpr_workgroup_id_x 1
.end_amdhsa_kernel
```
